```python
import torch

def _softmax(x, axis=-1):
    return torch.softmax(x, dim=axis)
def _gelu(x):
    return torch.nn.functional.gelu(x, approximate="tanh")
def _silu(x):
    return torch.nn.functional.silu(x)
def _sigmoid(x):
    return torch.sigmoid(x)
def _layernorm(x, axis=-1, eps=1e-5):
    m = x.mean(dim=axis, keepdim=True)
    v = x.var(dim=axis, keepdim=True, unbiased=False)
    return (x - m) / torch.sqrt(v + eps)
def _scatter_add(tgt, idx, src, axis=0):
    return tgt.clone().index_add_(axis, idx, src)
def _segment_sum(src, seg, n):
    out = torch.zeros((n,) + src.shape[1:], dtype=src.dtype)
    return out.index_add_(0, seg, src)
def _pad(x, pw):
    flat = tuple(v for pair in reversed(pw) for v in pair)
    return torch.nn.functional.pad(x, flat)

kernel_name = 'parallel_sum__linear_attn_block__dense_activation_silu__prompt'

def setup_inputs():

    _w = (lambda a: (lambda t: t.to(torch.bfloat16) if t.is_floating_point() else t)(torch.as_tensor(a)))
    def _A_setup():
        B, S, D = 1, 2048, 576
        return {
            "x": _w((lambda *s: torch.randn(*s, dtype=torch.bfloat16) * 0.05)(B, S, D)),
            "wqkv": _w((lambda *s: torch.randn(*s, dtype=torch.bfloat16) * 0.1)(D, 3 * D)),
            "wo": _w((lambda *s: torch.randn(*s, dtype=torch.bfloat16) * 0.05)(D, D)),
        }
    _A_in = _A_setup()

    def _B_setup():
        B, S, D, F = 1, 2048, 576, 4608
        return {
            "x": _w((lambda *s: torch.randn(*s, dtype=torch.bfloat16) * 0.05)(B, S, D)),
            "w1": _w((lambda *s: torch.randn(*s, dtype=torch.bfloat16) * 0.8)(D, F) * (D ** -0.5)),
            "w2": _w((lambda *s: torch.randn(*s, dtype=torch.bfloat16) * 0.1)(F, D) * (F ** -0.5)),
        }
    _B_in = _B_setup()

    return {
        "A_x": _A_in["x"],
        "A_wqkv": _A_in["wqkv"],
        "A_wo": _A_in["wo"],
        "B_x": _B_in["x"],
        "B_w1": _B_in["w1"],
        "B_w2": _B_in["w2"],
    }

def reference(A_x, A_wqkv, A_wo, B_x, B_w1, B_w2):
    def _A_ref(x, wqkv, wo):
        B, S, D = x.shape
        H = 32; Dh = D // H
        qkv = (lambda x, *d: x.permute(*d))((x @ wqkv).reshape(B, S, 3, H, Dh), 2, 0, 3, 1, 4)
        q, k, v = qkv[0], qkv[1], qkv[2]
        phi = lambda t: torch.where(t > 0, t + 1, torch.exp(t)) + 1e-6
        pq, pk = phi(q), phi(k)
        kv = torch.einsum("bhsd,bhse->bhde", pk, v)
        z = torch.einsum("bhsd->bhd", pk)
        num = torch.einsum("bhqd,bhde->bhqe", pq, kv)
        den = torch.einsum("bhqd,bhd->bhq", pq, z)[..., None] + 1e-6
        o = num / den
        return (lambda x, *d: x.permute(*d))(o, 0, 2, 1, 3).reshape(B, S, D) @ wo

    def _B_ref(x, w1, w2):
        h = torch.einsum("bsd,df->bsf", x, w1)
        h = _silu(h)
        out = torch.einsum("bsf,fd->bsd", h, w2)
        return out

    x = A_x
    xn = _layernorm(x, axis=-1)
    return x + _A_ref(xn, A_wqkv, A_wo) + _B_ref(xn, B_w1, B_w2)
```

```asm
; @launch grid=(256,1,1) block=(256,1,1) lds=163840
.amdgcn_target "amdgcn-amd-amdhsa--gfx950"
.text
.globl parallel_sum__linear_attn_block__dense_activation_silu__prompt_kernel
.p2align 8
.type parallel_sum__linear_attn_block__dense_activation_silu__prompt_kernel,@function
parallel_sum__linear_attn_block__dense_activation_silu__prompt_kernel:
s_cmp_ge_u32 s2, 256
s_cbranch_scc1 L_end
s_load_dwordx4 s[8:11], s[0:1], 0
s_load_dwordx2 s[28:29], s[0:1], 16
s_load_dwordx4 s[32:35], s[0:1], 32
s_load_dwordx4 s[20:23], s[0:1], 56
s_load_dwordx2 s[16:17], s[0:1], 48
v_and_b32 v1, 63, v0
v_lshrrev_b32 v2, 6, v0
s_lshr_b32 s3, s2, 3
s_and_b32 s4, s2, 7
v_readfirstlane_b32 s5, v2
s_mov_b32 s6, s2
s_memrealtime s[40:41]
s_waitcnt lgkmcnt(0)
s_mov_b32 s36, s34
s_mov_b32 s37, s35
s_mov_b32 s34, s32
s_mov_b32 s35, s33
s_mov_b32 s32, s10
s_mov_b32 s33, s11
s_mov_b32 s10, 2359296
s_mov_b32 s11, 0x20000
s_mov_b32 s24, s20
s_mov_b32 s25, s21
s_mov_b32 s26, 256
s_mov_b32 s27, 0x20000
s_mov_b32 s20, s22
s_mov_b32 s21, s23
s_mov_b32 s22, 268435456
s_mov_b32 s23, 0x20000
s_mov_b32 s30, 663552
s_mov_b32 s31, 0x20000
s_mov_b32 s15, 0x20000
s_mov_b32 s12, s32
s_mov_b32 s13, s33
s_mov_b32 s14, 1990656
s_mov_b32 s15, 0x20000
s_lshl_b32 s92, s5, 6
v_add_u32 v40, s92, v1
v_mul_u32_u24 v41, 5462, v40
v_lshrrev_b32 v41, 16, v41
v_mul_u32_u24 v42, 12, v41
v_sub_u32 v42, v40, v42
v_lshrrev_b32 v43, 2, v42
v_mul_u32_u24 v43, 1152, v43
v_and_b32 v42, 3, v42
v_lshl_add_u32 v43, v42, 6, v43
v_mul_u32_u24 v41, 3456, v41
v_add_u32 v41, v41, v43
s_mul_i32 s92, s4, 144
s_andn2_b32 s92, s92, 127
s_mul_i32 s93, s3, 62208
s_add_u32 s92, s92, s93
v_cmp_le_u32 vcc, 216, v40
v_mov_b32 v42, 0x7f000000
s_nop 0
v_cndmask_b32 v41, v41, v42, vcc
buffer_load_dword v168, v41, s[12:15], s92 offen
v_lshrrev_b32 v2, 2, v1
s_lshl_b32 s92, s3, 6
s_lshl_b32 s93, s5, 4
s_add_u32 s92, s92, s93
v_add_u32 v2, s92, v2
v_mul_u32_u24 v2, 1152, v2
v_and_b32 v3, 3, v1
v_lshl_add_u32 v2, v3, 4, v2
buffer_load_dwordx4 v[88:91], v2, s[8:11], 0 offen offset:0
buffer_load_dwordx4 v[92:95], v2, s[8:11], 0 offen offset:64
buffer_load_dwordx4 v[96:99], v2, s[8:11], 0 offen offset:128
buffer_load_dwordx4 v[100:103], v2, s[8:11], 0 offen offset:192
buffer_load_dwordx4 v[104:107], v2, s[8:11], 0 offen offset:256
buffer_load_dwordx4 v[108:111], v2, s[8:11], 0 offen offset:320
buffer_load_dwordx4 v[112:115], v2, s[8:11], 0 offen offset:384
buffer_load_dwordx4 v[116:119], v2, s[8:11], 0 offen offset:448
buffer_load_dwordx4 v[120:123], v2, s[8:11], 0 offen offset:512
buffer_load_dwordx4 v[124:127], v2, s[8:11], 0 offen offset:576
buffer_load_dwordx4 v[128:131], v2, s[8:11], 0 offen offset:640
buffer_load_dwordx4 v[132:135], v2, s[8:11], 0 offen offset:704
buffer_load_dwordx4 v[136:139], v2, s[8:11], 0 offen offset:768
buffer_load_dwordx4 v[140:143], v2, s[8:11], 0 offen offset:832
buffer_load_dwordx4 v[144:147], v2, s[8:11], 0 offen offset:896
buffer_load_dwordx4 v[148:151], v2, s[8:11], 0 offen offset:960
buffer_load_dwordx4 v[184:187], v2, s[8:11], 0 offen offset:1024
buffer_load_dwordx4 v[188:191], v2, s[8:11], 0 offen offset:1088
s_or_b32 s92, s6, s5
s_cmp_lg_u32 s92, 0
s_cbranch_scc1 L_nononce
s_or_b32 s40, s40, 1
v_mov_b32 v21, s40
v_mov_b32 v22, 0
v_cmp_eq_u32 vcc, 0, v1
s_and_saveexec_b64 s[0:1], vcc
buffer_store_dword v21, v22, s[24:27], 0 offen sc1
s_mov_b64 exec, s[0:1]
L_nononce:
v_lshrrev_b32 v18, 3, v1
v_bfe_u32 v21, v1, 4, 1
v_lshlrev_b32 v21, 2, v21
v_and_b32 v20, 7, v1
v_xor_b32 v20, v20, v21
v_lshlrev_b32 v19, 4, v20
v_lshlrev_b32 v17, 4, v1
s_mul_i32 s38, s5, 12288
v_bfe_u32 v21, v1, 2, 2
v_lshlrev_b32 v22, 7, v21
v_bfe_u32 v23, v1, 3, 1
v_lshl_add_u32 v22, v23, 6, v22
v_bfe_u32 v23, v1, 4, 1
v_lshl_add_u32 v22, v23, 5, v22
v_and_b32 v23, 3, v1
v_lshl_add_u32 v22, v23, 3, v22
v_add_u32 v22, s38, v22
v_lshrrev_b32 v23, 5, v1
v_lshl_add_u32 v6, v23, 10, v22
v_xor_b32 v7, 64, v6
v_lshl_add_u32 v8, v23, 9, v22
v_xor_b32 v9, 64, v8
s_mul_i32 s7, s4, 663552
s_mul_i32 s2, s4, 82944
s_mov_b32 s96, s16
s_mov_b32 s97, s17
s_mov_b32 s16, s32
s_mov_b32 s17, s33
s_mov_b32 s18, 1990656
s_mov_b32 s19, 0x20000
s_lshl_b32 s92, s5, 3
v_add_u32 v21, s92, v20
v_mul_u32_u24 v22, 57, v21
v_lshrrev_b32 v22, 9, v22
v_mul_u32_u24 v23, 9, v22
v_sub_u32 v23, v21, v23
v_lshlrev_b32 v23, 4, v23
v_add_u32 v22, 1, v22
v_cmp_eq_u32 vcc, 3, v22
v_mul_u32_u24 v22, 1152, v22
s_nop 0
v_cndmask_b32_e64 v22, v22, 0, vcc
s_mul_i32 s92, s4, 144
v_add3_u32 v22, v22, v23, s92
v_mul_u32_u24 v4, 3456, v18
v_add_u32 v4, v4, v22
v_cmp_le_u32 vcc, 27, v21
v_mov_b32 v23, 0x7f000000
s_nop 0
v_cndmask_b32 v4, v4, v23, vcc
v_add_u32 v5, 26624, v4
s_mov_b32 s12, s16
s_mov_b32 s13, s17
s_mov_b32 s14, s18
v_mov_b32 v2, v4
v_mov_b32 v3, v5
s_mov_b32 s40, 0
s_mov_b32 s41, 55296
s_mov_b32 s42, 110592
s_mov_b32 s43, 165888
s_mov_b32 s44, 221184
s_mov_b32 s45, 276480
s_mov_b32 s46, 331776
s_mov_b32 s47, 387072
s_mov_b32 s48, 442368
s_mov_b32 s49, 497664
s_mov_b32 s50, 552960
s_mov_b32 s51, 608256
s_mov_b32 s52, 663552
s_mov_b32 s53, 718848
s_mov_b32 s54, 774144
s_mov_b32 s55, 829440
s_mov_b32 s56, 884736
s_mov_b32 s57, 940032
s_mov_b32 s58, 995328
s_mov_b32 s59, 1050624
s_mov_b32 s60, 1105920
s_mov_b32 s61, 1161216
s_mov_b32 s62, 1216512
s_mov_b32 s63, 1271808
s_mov_b32 s64, 1327104
s_mov_b32 s65, 1382400
s_mov_b32 s66, 1437696
s_mov_b32 s67, 1492992
s_mov_b32 s68, 1548288
s_mov_b32 s69, 1603584
s_mov_b32 s70, 1658880
s_mov_b32 s71, 1714176
s_mov_b32 s72, 1769472
s_mov_b32 s73, 1824768
s_mov_b32 s74, 1880064
s_mov_b32 s75, 1935360
s_mov_b32 s89, s96
s_mov_b32 s90, s97
s_mov_b32 s16, s34
s_mov_b32 s17, s35
s_mov_b32 s18, 5308416
s_mov_b32 s19, 0x20000
s_mul_i32 s92, s4, 1152
s_lshl_b32 s93, s5, 7
s_add_u32 s92, s92, s93
v_mul_u32_u24 v4, 9216, v18
v_add3_u32 v4, v4, v19, s92
v_add_u32 v5, 72704, v4
s_mov_b32 s81, 0
s_mov_b32 s82, 147456
s_mov_b32 s83, 294912
s_mov_b32 s84, 442368
s_mov_b32 s85, 589824
s_mov_b32 s86, 737280
s_lshl_b32 s33, s5, 13
s_add_u32 s33, s33, 49152
s_sub_u32 s92, s33, s38
v_add_u32 v172, s92, v6
v_add_u32 v173, s92, v7
s_mov_b32 s96, s36
s_mov_b32 s97, s37
s_mov_b32 s98, 5308416
s_mov_b32 s99, 0x20000
s_mul_i32 s100, s4, 1152
s_mul_i32 s93, s3, 165888
s_add_u32 s100, s100, s93
s_mul_i32 s101, s3, 20736
s_add_u32 s101, s101, s7
s_lshl_b32 s93, s5, 6
v_add_u32 v40, s93, v1
v_add_u32 v40, 0, v40
v_mul_u32_u24 v41, 116509, v40
v_lshrrev_b32 v41, 20, v41
v_mul_u32_u24 v42, 9, v41
v_sub_u32 v42, v40, v42
v_mul_u32_u24 v42, 128, v42
v_cmp_le_u32 vcc, 162, v40
v_mov_b32 v43, 0x7f000000
v_mul_u32_u24 v44, 9216, v41
v_add_u32 v44, v44, v42
v_cndmask_b32 v44, v44, v43, vcc
v_mov_b32 v48, v44
v_mul_u32_u24 v45, 1152, v41
v_add_u32 v45, v45, v42
v_cndmask_b32 v49, v45, v43, vcc
s_mul_i32 s88, s3, 2688
s_add_u32 s88, s88, s2
v_mul_u32_u24 v41, 128, v1
v_cmp_le_u32 vcc, 21, v1
v_mov_b32 v43, 0x7f000000
s_nop 0
v_cndmask_b32 v56, v41, v43, vcc
v_mov_b32 v24, 0
v_mov_b32 v25, 0
v_mov_b32 v26, 0
v_mov_b32 v27, 0
s_lshl_b32 s93, s5, 10
s_add_u32 s93, s93, 122880
v_add_u32 v28, s93, v17
ds_write_b128 v28, v[24:27] offset:0
ds_write_b128 v28, v[24:27] offset:4096
ds_write_b128 v28, v[24:27] offset:8192
ds_write_b128 v28, v[24:27] offset:12288
ds_write_b128 v28, v[24:27] offset:16384
ds_write_b128 v28, v[24:27] offset:20480
ds_write_b128 v28, v[24:27] offset:24576
ds_write_b128 v28, v[24:27] offset:28672
ds_write_b128 v28, v[24:27] offset:32768
v_cmp_gt_u32 vcc, 126464, v28
s_and_saveexec_b64 s[0:1], vcc
ds_write_b128 v28, v[24:27] offset:36864
s_mov_b64 exec, s[0:1]
s_lshr_b32 s92, s5, 1
s_mul_i32 s92, s92, 36864
s_add_u32 s92, s92, 49152
s_and_b32 s93, s5, 1
s_lshl_b32 s93, s93, 4
v_lshrrev_b32 v29, 2, v1
v_add_u32 v29, s93, v29
v_and_b32 v30, 3, v1
v_lshlrev_b32 v31, 1, v30
v_xor_b32 v31, v29, v31
v_lshlrev_b32 v31, 4, v31
v_lshl_add_u32 v28, v30, 9, v31
v_add_u32 v28, s92, v28
v_and_b32 v29, 31, v1
v_lshrrev_b32 v30, 5, v1
v_lshlrev_b32 v31, 1, v30
v_xor_b32 v31, v29, v31
v_lshlrev_b32 v32, 4, v31
v_lshl_add_u32 v32, v30, 9, v32
v_add_u32 v176, 49152, v32
v_xor_b32 v177, 64, v176
v_add_u32 v178, 36864, v176
v_add_u32 v179, 36864, v177
s_mov_b32 s92, 0x3f803f80
s_mov_b32 s94, 0x00003f80
s_mov_b32 s95, 0x3f800000
v_mov_b32 v24, 0
v_mov_b32 v25, 0
v_mov_b32 v26, 0
v_mov_b32 v27, 0
s_waitcnt vmcnt(18)
s_add_u32 m0, s38, 0
s_nop 0
buffer_load_dwordx4 v2, s[12:15], s40 offen lds
buffer_load_dwordx4 v3, s[12:15], s40 offen offset:1024 lds
s_add_u32 m0, s38, 2048
s_nop 0
buffer_load_dwordx4 v2, s[12:15], s41 offen lds
buffer_load_dwordx4 v3, s[12:15], s41 offen offset:1024 lds
s_add_u32 m0, s38, 4096
s_nop 0
buffer_load_dwordx4 v2, s[12:15], s42 offen lds
buffer_load_dwordx4 v3, s[12:15], s42 offen offset:1024 lds
s_add_u32 m0, s38, 6144
s_nop 0
buffer_load_dwordx4 v2, s[12:15], s43 offen lds
buffer_load_dwordx4 v3, s[12:15], s43 offen offset:1024 lds
s_add_u32 m0, s38, 8192
s_nop 0
buffer_load_dwordx4 v2, s[12:15], s44 offen lds
buffer_load_dwordx4 v3, s[12:15], s44 offen offset:1024 lds
s_add_u32 m0, s38, 10240
s_nop 0
buffer_load_dwordx4 v2, s[12:15], s45 offen lds
buffer_load_dwordx4 v3, s[12:15], s45 offen offset:1024 lds
buffer_load_dword v168, v48, s[16:19], s100 offen
s_getpc_b64 s[96:97]
L_pc0:
s_sub_u32 s96, s96, L_pc0-parallel_sum__linear_attn_block__dense_activation_silu__prompt_kernel
s_subb_u32 s97, s97, 0
s_lshl_b32 s100, s3, 11
v_lshlrev_b32 v57, 7, v1
v_add_u32 v57, s100, v57
v_cmp_gt_u32 vcc, 16, v1
s_mov_b64 s[0:1], vcc
s_mov_b32 s100, L_code_end-parallel_sum__linear_attn_block__dense_activation_silu__prompt_kernel
v_cmp_gt_u32 vcc, s100, v57
s_and_b64 vcc, vcc, s[0:1]
s_and_saveexec_b64 s[0:1], vcc
s_cbranch_execz L_nocpf
s_cmp_lg_u32 s5, 1
s_cbranch_scc1 L_nocpf
global_load_dword v171, v57, s[96:97]
L_nocpf:
s_mov_b64 exec, s[0:1]
s_waitcnt vmcnt(13)
v_dot2_f32_bf16 v24, v88, s92, v24
v_dot2_f32_bf16 v25, v89, s92, v25
v_dot2_f32_bf16 v26, v90, s92, v26
v_dot2_f32_bf16 v27, v91, s92, v27
v_dot2_f32_bf16 v24, v92, s92, v24
v_dot2_f32_bf16 v25, v93, s92, v25
v_dot2_f32_bf16 v26, v94, s92, v26
v_dot2_f32_bf16 v27, v95, s92, v27
v_dot2_f32_bf16 v24, v96, s92, v24
v_dot2_f32_bf16 v25, v97, s92, v25
v_dot2_f32_bf16 v26, v98, s92, v26
v_dot2_f32_bf16 v27, v99, s92, v27
v_dot2_f32_bf16 v24, v100, s92, v24
v_dot2_f32_bf16 v25, v101, s92, v25
v_dot2_f32_bf16 v26, v102, s92, v26
v_dot2_f32_bf16 v27, v103, s92, v27
v_dot2_f32_bf16 v24, v104, s92, v24
v_dot2_f32_bf16 v25, v105, s92, v25
v_dot2_f32_bf16 v26, v106, s92, v26
v_dot2_f32_bf16 v27, v107, s92, v27
v_dot2_f32_bf16 v24, v108, s92, v24
v_dot2_f32_bf16 v25, v109, s92, v25
v_dot2_f32_bf16 v26, v110, s92, v26
v_dot2_f32_bf16 v27, v111, s92, v27
v_dot2_f32_bf16 v24, v112, s92, v24
v_dot2_f32_bf16 v25, v113, s92, v25
v_dot2_f32_bf16 v26, v114, s92, v26
v_dot2_f32_bf16 v27, v115, s92, v27
v_dot2_f32_bf16 v24, v116, s92, v24
v_dot2_f32_bf16 v25, v117, s92, v25
v_dot2_f32_bf16 v26, v118, s92, v26
v_dot2_f32_bf16 v27, v119, s92, v27
v_dot2_f32_bf16 v24, v120, s92, v24
v_dot2_f32_bf16 v25, v121, s92, v25
v_dot2_f32_bf16 v26, v122, s92, v26
v_dot2_f32_bf16 v27, v123, s92, v27
v_dot2_f32_bf16 v24, v124, s92, v24
v_dot2_f32_bf16 v25, v125, s92, v25
v_dot2_f32_bf16 v26, v126, s92, v26
v_dot2_f32_bf16 v27, v127, s92, v27
v_dot2_f32_bf16 v24, v128, s92, v24
v_dot2_f32_bf16 v25, v129, s92, v25
v_dot2_f32_bf16 v26, v130, s92, v26
v_dot2_f32_bf16 v27, v131, s92, v27
v_dot2_f32_bf16 v24, v132, s92, v24
v_dot2_f32_bf16 v25, v133, s92, v25
v_dot2_f32_bf16 v26, v134, s92, v26
v_dot2_f32_bf16 v27, v135, s92, v27
v_dot2_f32_bf16 v24, v136, s92, v24
v_dot2_f32_bf16 v25, v137, s92, v25
v_dot2_f32_bf16 v26, v138, s92, v26
v_dot2_f32_bf16 v27, v139, s92, v27
v_dot2_f32_bf16 v24, v140, s92, v24
v_dot2_f32_bf16 v25, v141, s92, v25
v_dot2_f32_bf16 v26, v142, s92, v26
v_dot2_f32_bf16 v27, v143, s92, v27
v_dot2_f32_bf16 v24, v144, s92, v24
v_dot2_f32_bf16 v25, v145, s92, v25
v_dot2_f32_bf16 v26, v146, s92, v26
v_dot2_f32_bf16 v27, v147, s92, v27
v_dot2_f32_bf16 v24, v148, s92, v24
v_dot2_f32_bf16 v25, v149, s92, v25
v_dot2_f32_bf16 v26, v150, s92, v26
v_dot2_f32_bf16 v27, v151, s92, v27
v_dot2_f32_bf16 v24, v184, s92, v24
v_dot2_f32_bf16 v25, v185, s92, v25
v_dot2_f32_bf16 v26, v186, s92, v26
v_dot2_f32_bf16 v27, v187, s92, v27
v_dot2_f32_bf16 v24, v188, s92, v24
v_dot2_f32_bf16 v25, v189, s92, v25
v_dot2_f32_bf16 v26, v190, s92, v26
v_dot2_f32_bf16 v27, v191, s92, v27
s_nop 3
v_add_f32 v24, v24, v25
v_add_f32 v26, v26, v27
s_nop 0
v_add_f32 v24, v24, v26
s_nop 1
v_add_f32_dpp v24, v24, v24 quad_perm:[1,0,3,2] row_mask:0xf bank_mask:0xf
s_nop 1
v_add_f32_dpp v24, v24, v24 quad_perm:[2,3,0,1] row_mask:0xf bank_mask:0xf
v_mul_f32 v24, 0x3ae38e39, v24
v_cvt_pk_bf16_f32 v25, v24, v24
v_lshlrev_b32 v25, 16, v25
v_sub_f32 v180, v24, v25
v_xor_b32 v25, 0x80000000, v25
v_dot2_f32_bf16 v32, v88, s94, v25
v_dot2_f32_bf16 v33, v88, s95, v25
v_dot2_f32_bf16 v34, v89, s94, v25
v_dot2_f32_bf16 v35, v89, s95, v25
v_dot2_f32_bf16 v36, v90, s94, v25
v_dot2_f32_bf16 v37, v90, s95, v25
v_dot2_f32_bf16 v38, v91, s94, v25
v_dot2_f32_bf16 v39, v91, s95, v25
v_dot2_f32_bf16 v40, v92, s94, v25
v_dot2_f32_bf16 v41, v92, s95, v25
v_cvt_pk_bf16_f32 v88, v32, v33
v_dot2_f32_bf16 v42, v93, s94, v25
v_dot2_f32_bf16 v43, v93, s95, v25
v_cvt_pk_bf16_f32 v89, v34, v35
v_dot2_f32_bf16 v44, v94, s94, v25
v_dot2_f32_bf16 v45, v94, s95, v25
v_cvt_pk_bf16_f32 v90, v36, v37
v_dot2_f32_bf16 v46, v95, s94, v25
v_dot2_f32_bf16 v47, v95, s95, v25
v_cvt_pk_bf16_f32 v91, v38, v39
ds_write_b128 v28, v[88:91] offset:0
v_dot2_f32_bf16 v32, v96, s94, v25
v_dot2_f32_bf16 v33, v96, s95, v25
v_cvt_pk_bf16_f32 v92, v40, v41
v_dot2_f32_bf16 v34, v97, s94, v25
v_dot2_f32_bf16 v35, v97, s95, v25
v_cvt_pk_bf16_f32 v93, v42, v43
v_dot2_f32_bf16 v36, v98, s94, v25
v_dot2_f32_bf16 v37, v98, s95, v25
v_cvt_pk_bf16_f32 v94, v44, v45
v_dot2_f32_bf16 v38, v99, s94, v25
v_dot2_f32_bf16 v39, v99, s95, v25
v_cvt_pk_bf16_f32 v95, v46, v47
ds_write_b128 v28, v[92:95] offset:2048
v_dot2_f32_bf16 v40, v100, s94, v25
v_dot2_f32_bf16 v41, v100, s95, v25
v_cvt_pk_bf16_f32 v96, v32, v33
v_dot2_f32_bf16 v42, v101, s94, v25
v_dot2_f32_bf16 v43, v101, s95, v25
v_cvt_pk_bf16_f32 v97, v34, v35
v_dot2_f32_bf16 v44, v102, s94, v25
v_dot2_f32_bf16 v45, v102, s95, v25
v_cvt_pk_bf16_f32 v98, v36, v37
v_dot2_f32_bf16 v46, v103, s94, v25
v_dot2_f32_bf16 v47, v103, s95, v25
v_cvt_pk_bf16_f32 v99, v38, v39
ds_write_b128 v28, v[96:99] offset:4096
v_dot2_f32_bf16 v32, v104, s94, v25
v_dot2_f32_bf16 v33, v104, s95, v25
v_cvt_pk_bf16_f32 v100, v40, v41
v_dot2_f32_bf16 v34, v105, s94, v25
v_dot2_f32_bf16 v35, v105, s95, v25
v_cvt_pk_bf16_f32 v101, v42, v43
v_dot2_f32_bf16 v36, v106, s94, v25
v_dot2_f32_bf16 v37, v106, s95, v25
v_cvt_pk_bf16_f32 v102, v44, v45
v_dot2_f32_bf16 v38, v107, s94, v25
v_dot2_f32_bf16 v39, v107, s95, v25
v_cvt_pk_bf16_f32 v103, v46, v47
ds_write_b128 v28, v[100:103] offset:6144
v_dot2_f32_bf16 v40, v108, s94, v25
v_dot2_f32_bf16 v41, v108, s95, v25
v_cvt_pk_bf16_f32 v104, v32, v33
v_dot2_f32_bf16 v42, v109, s94, v25
v_dot2_f32_bf16 v43, v109, s95, v25
v_cvt_pk_bf16_f32 v105, v34, v35
v_dot2_f32_bf16 v44, v110, s94, v25
v_dot2_f32_bf16 v45, v110, s95, v25
v_cvt_pk_bf16_f32 v106, v36, v37
v_dot2_f32_bf16 v46, v111, s94, v25
v_dot2_f32_bf16 v47, v111, s95, v25
v_cvt_pk_bf16_f32 v107, v38, v39
ds_write_b128 v28, v[104:107] offset:8192
v_dot2_f32_bf16 v32, v112, s94, v25
v_dot2_f32_bf16 v33, v112, s95, v25
v_cvt_pk_bf16_f32 v108, v40, v41
v_dot2_f32_bf16 v34, v113, s94, v25
v_dot2_f32_bf16 v35, v113, s95, v25
v_cvt_pk_bf16_f32 v109, v42, v43
v_dot2_f32_bf16 v36, v114, s94, v25
v_dot2_f32_bf16 v37, v114, s95, v25
v_cvt_pk_bf16_f32 v110, v44, v45
v_dot2_f32_bf16 v38, v115, s94, v25
v_dot2_f32_bf16 v39, v115, s95, v25
v_cvt_pk_bf16_f32 v111, v46, v47
ds_write_b128 v28, v[108:111] offset:10240
v_dot2_f32_bf16 v40, v116, s94, v25
v_dot2_f32_bf16 v41, v116, s95, v25
v_cvt_pk_bf16_f32 v112, v32, v33
v_dot2_f32_bf16 v42, v117, s94, v25
v_dot2_f32_bf16 v43, v117, s95, v25
v_cvt_pk_bf16_f32 v113, v34, v35
v_dot2_f32_bf16 v44, v118, s94, v25
v_dot2_f32_bf16 v45, v118, s95, v25
v_cvt_pk_bf16_f32 v114, v36, v37
v_dot2_f32_bf16 v46, v119, s94, v25
v_dot2_f32_bf16 v47, v119, s95, v25
v_cvt_pk_bf16_f32 v115, v38, v39
ds_write_b128 v28, v[112:115] offset:12288
v_dot2_f32_bf16 v32, v120, s94, v25
v_dot2_f32_bf16 v33, v120, s95, v25
v_cvt_pk_bf16_f32 v116, v40, v41
v_dot2_f32_bf16 v34, v121, s94, v25
v_dot2_f32_bf16 v35, v121, s95, v25
v_cvt_pk_bf16_f32 v117, v42, v43
v_dot2_f32_bf16 v36, v122, s94, v25
v_dot2_f32_bf16 v37, v122, s95, v25
v_cvt_pk_bf16_f32 v118, v44, v45
v_dot2_f32_bf16 v38, v123, s94, v25
v_dot2_f32_bf16 v39, v123, s95, v25
v_cvt_pk_bf16_f32 v119, v46, v47
ds_write_b128 v28, v[116:119] offset:14336
v_dot2_f32_bf16 v40, v124, s94, v25
v_dot2_f32_bf16 v41, v124, s95, v25
v_cvt_pk_bf16_f32 v120, v32, v33
v_dot2_f32_bf16 v42, v125, s94, v25
v_dot2_f32_bf16 v43, v125, s95, v25
v_cvt_pk_bf16_f32 v121, v34, v35
v_dot2_f32_bf16 v44, v126, s94, v25
v_dot2_f32_bf16 v45, v126, s95, v25
v_cvt_pk_bf16_f32 v122, v36, v37
v_dot2_f32_bf16 v46, v127, s94, v25
v_dot2_f32_bf16 v47, v127, s95, v25
v_cvt_pk_bf16_f32 v123, v38, v39
ds_write_b128 v28, v[120:123] offset:16384
v_dot2_f32_bf16 v32, v128, s94, v25
v_dot2_f32_bf16 v33, v128, s95, v25
v_cvt_pk_bf16_f32 v124, v40, v41
v_dot2_f32_bf16 v34, v129, s94, v25
v_dot2_f32_bf16 v35, v129, s95, v25
v_cvt_pk_bf16_f32 v125, v42, v43
v_dot2_f32_bf16 v36, v130, s94, v25
v_dot2_f32_bf16 v37, v130, s95, v25
v_cvt_pk_bf16_f32 v126, v44, v45
v_dot2_f32_bf16 v38, v131, s94, v25
v_dot2_f32_bf16 v39, v131, s95, v25
v_cvt_pk_bf16_f32 v127, v46, v47
ds_write_b128 v28, v[124:127] offset:18432
v_dot2_f32_bf16 v40, v132, s94, v25
v_dot2_f32_bf16 v41, v132, s95, v25
v_cvt_pk_bf16_f32 v128, v32, v33
v_dot2_f32_bf16 v42, v133, s94, v25
v_dot2_f32_bf16 v43, v133, s95, v25
v_cvt_pk_bf16_f32 v129, v34, v35
v_dot2_f32_bf16 v44, v134, s94, v25
v_dot2_f32_bf16 v45, v134, s95, v25
v_cvt_pk_bf16_f32 v130, v36, v37
v_dot2_f32_bf16 v46, v135, s94, v25
v_dot2_f32_bf16 v47, v135, s95, v25
v_cvt_pk_bf16_f32 v131, v38, v39
ds_write_b128 v28, v[128:131] offset:20480
v_dot2_f32_bf16 v32, v136, s94, v25
v_dot2_f32_bf16 v33, v136, s95, v25
v_cvt_pk_bf16_f32 v132, v40, v41
v_dot2_f32_bf16 v34, v137, s94, v25
v_dot2_f32_bf16 v35, v137, s95, v25
v_cvt_pk_bf16_f32 v133, v42, v43
v_dot2_f32_bf16 v36, v138, s94, v25
v_dot2_f32_bf16 v37, v138, s95, v25
v_cvt_pk_bf16_f32 v134, v44, v45
v_dot2_f32_bf16 v38, v139, s94, v25
v_dot2_f32_bf16 v39, v139, s95, v25
v_cvt_pk_bf16_f32 v135, v46, v47
ds_write_b128 v28, v[132:135] offset:22528
v_dot2_f32_bf16 v40, v140, s94, v25
v_dot2_f32_bf16 v41, v140, s95, v25
v_cvt_pk_bf16_f32 v136, v32, v33
v_dot2_f32_bf16 v42, v141, s94, v25
v_dot2_f32_bf16 v43, v141, s95, v25
v_cvt_pk_bf16_f32 v137, v34, v35
v_dot2_f32_bf16 v44, v142, s94, v25
v_dot2_f32_bf16 v45, v142, s95, v25
v_cvt_pk_bf16_f32 v138, v36, v37
v_dot2_f32_bf16 v46, v143, s94, v25
v_dot2_f32_bf16 v47, v143, s95, v25
v_cvt_pk_bf16_f32 v139, v38, v39
ds_write_b128 v28, v[136:139] offset:24576
v_dot2_f32_bf16 v32, v144, s94, v25
v_dot2_f32_bf16 v33, v144, s95, v25
v_cvt_pk_bf16_f32 v140, v40, v41
v_dot2_f32_bf16 v34, v145, s94, v25
v_dot2_f32_bf16 v35, v145, s95, v25
v_cvt_pk_bf16_f32 v141, v42, v43
v_dot2_f32_bf16 v36, v146, s94, v25
v_dot2_f32_bf16 v37, v146, s95, v25
v_cvt_pk_bf16_f32 v142, v44, v45
v_dot2_f32_bf16 v38, v147, s94, v25
v_dot2_f32_bf16 v39, v147, s95, v25
v_cvt_pk_bf16_f32 v143, v46, v47
ds_write_b128 v28, v[140:143] offset:26624
v_dot2_f32_bf16 v40, v148, s94, v25
v_dot2_f32_bf16 v41, v148, s95, v25
v_cvt_pk_bf16_f32 v144, v32, v33
v_dot2_f32_bf16 v42, v149, s94, v25
v_dot2_f32_bf16 v43, v149, s95, v25
v_cvt_pk_bf16_f32 v145, v34, v35
v_dot2_f32_bf16 v44, v150, s94, v25
v_dot2_f32_bf16 v45, v150, s95, v25
v_cvt_pk_bf16_f32 v146, v36, v37
v_dot2_f32_bf16 v46, v151, s94, v25
v_dot2_f32_bf16 v47, v151, s95, v25
v_cvt_pk_bf16_f32 v147, v38, v39
ds_write_b128 v28, v[144:147] offset:28672
v_dot2_f32_bf16 v32, v184, s94, v25
v_dot2_f32_bf16 v33, v184, s95, v25
v_cvt_pk_bf16_f32 v148, v40, v41
v_dot2_f32_bf16 v34, v185, s94, v25
v_dot2_f32_bf16 v35, v185, s95, v25
v_cvt_pk_bf16_f32 v149, v42, v43
v_dot2_f32_bf16 v36, v186, s94, v25
v_dot2_f32_bf16 v37, v186, s95, v25
v_cvt_pk_bf16_f32 v150, v44, v45
v_dot2_f32_bf16 v38, v187, s94, v25
v_dot2_f32_bf16 v39, v187, s95, v25
v_cvt_pk_bf16_f32 v151, v46, v47
ds_write_b128 v28, v[148:151] offset:30720
v_dot2_f32_bf16 v40, v188, s94, v25
v_dot2_f32_bf16 v41, v188, s95, v25
v_cvt_pk_bf16_f32 v184, v32, v33
v_dot2_f32_bf16 v42, v189, s94, v25
v_dot2_f32_bf16 v43, v189, s95, v25
v_cvt_pk_bf16_f32 v185, v34, v35
v_dot2_f32_bf16 v44, v190, s94, v25
v_dot2_f32_bf16 v45, v190, s95, v25
v_cvt_pk_bf16_f32 v186, v36, v37
v_dot2_f32_bf16 v46, v191, s94, v25
v_dot2_f32_bf16 v47, v191, s95, v25
v_cvt_pk_bf16_f32 v187, v38, v39
ds_write_b128 v28, v[184:187] offset:32768
v_cvt_pk_bf16_f32 v188, v40, v41
v_cvt_pk_bf16_f32 v189, v42, v43
v_cvt_pk_bf16_f32 v190, v44, v45
v_cvt_pk_bf16_f32 v191, v46, v47
ds_write_b128 v28, v[188:191] offset:34816
v_mov_b32 v21, 0
buffer_load_dword v174, v21, s[24:27], 0 offen sc1
s_waitcnt lgkmcnt(0)
s_barrier
ds_read_b128 a[0:3], v176 offset:0
ds_read_b128 a[4:7], v178 offset:0
ds_read_b128 a[8:11], v177 offset:1024
ds_read_b128 a[12:15], v179 offset:1024
s_waitcnt vmcnt(12)
ds_read_b64_tr_b16 v[152:153], v6 offset:0
ds_read_b64_tr_b16 v[154:155], v6 offset:512
ds_read_b64_tr_b16 v[156:157], v7 offset:0
ds_read_b64_tr_b16 v[158:159], v7 offset:512
s_waitcnt vmcnt(8) lgkmcnt(0)
ds_read_b64_tr_b16 v[160:161], v6 offset:2048
ds_read_b64_tr_b16 v[162:163], v6 offset:2560
s_add_u32 m0, s38, 0
v_mfma_f32_32x32x16_bf16 v[24:39], v[152:155], a[0:3], 0
ds_read_b64_tr_b16 v[164:165], v7 offset:2048
buffer_load_dwordx4 v2, s[12:15], s46 offen lds
v_mov_b32 v192, 0
v_mfma_f32_32x32x16_bf16 v[40:55], v[152:155], a[4:7], 0
ds_read_b64_tr_b16 v[166:167], v7 offset:2560
buffer_load_dwordx4 v3, s[12:15], s46 offen offset:1024 lds
v_mov_b32 v193, 0
v_mfma_f32_32x32x16_bf16 v[56:71], v[156:159], a[0:3], 0
ds_read_b128 a[16:19], v176 offset:2048
ds_read_b128 a[20:23], v178 offset:2048
v_mov_b32 v194, 0
v_mov_b32 v195, 0
v_mfma_f32_32x32x16_bf16 v[72:87], v[156:159], a[4:7], 0
v_dot2_f32_bf16 v192, v88, v88, v192
s_waitcnt vmcnt(8) lgkmcnt(2)
ds_read_b64_tr_b16 v[152:153], v6 offset:4096
ds_read_b64_tr_b16 v[154:155], v6 offset:4608
s_add_u32 m0, s38, 2048
v_mfma_f32_32x32x16_bf16 v[24:39], v[160:163], a[8:11], v[24:39]
ds_read_b64_tr_b16 v[156:157], v7 offset:4096
buffer_load_dwordx4 v2, s[12:15], s47 offen lds
v_dot2_f32_bf16 v193, v89, v89, v193
v_mfma_f32_32x32x16_bf16 v[40:55], v[160:163], a[12:15], v[40:55]
ds_read_b64_tr_b16 v[158:159], v7 offset:4608
buffer_load_dwordx4 v3, s[12:15], s47 offen offset:1024 lds
v_dot2_f32_bf16 v194, v90, v90, v194
v_mfma_f32_32x32x16_bf16 v[56:71], v[164:167], a[8:11], v[56:71]
ds_read_b128 a[24:27], v177 offset:3072
ds_read_b128 a[28:31], v179 offset:3072
v_dot2_f32_bf16 v195, v91, v91, v195
v_dot2_f32_bf16 v192, v92, v92, v192
v_mfma_f32_32x32x16_bf16 v[72:87], v[164:167], a[12:15], v[72:87]
v_dot2_f32_bf16 v193, v93, v93, v193
s_waitcnt vmcnt(8) lgkmcnt(2)
ds_read_b64_tr_b16 v[160:161], v6 offset:6144
ds_read_b64_tr_b16 v[162:163], v6 offset:6656
s_add_u32 m0, s38, 4096
v_mfma_f32_32x32x16_bf16 v[24:39], v[152:155], a[16:19], v[24:39]
ds_read_b64_tr_b16 v[164:165], v7 offset:6144
buffer_load_dwordx4 v2, s[12:15], s48 offen lds
v_dot2_f32_bf16 v194, v94, v94, v194
v_mfma_f32_32x32x16_bf16 v[40:55], v[152:155], a[20:23], v[40:55]
ds_read_b64_tr_b16 v[166:167], v7 offset:6656
buffer_load_dwordx4 v3, s[12:15], s48 offen offset:1024 lds
v_dot2_f32_bf16 v195, v95, v95, v195
v_mfma_f32_32x32x16_bf16 v[56:71], v[156:159], a[16:19], v[56:71]
ds_read_b128 a[32:35], v176 offset:4096
ds_read_b128 a[36:39], v178 offset:4096
v_dot2_f32_bf16 v192, v96, v96, v192
v_dot2_f32_bf16 v193, v97, v97, v193
v_mfma_f32_32x32x16_bf16 v[72:87], v[156:159], a[20:23], v[72:87]
v_dot2_f32_bf16 v194, v98, v98, v194
s_waitcnt vmcnt(8) lgkmcnt(2)
ds_read_b64_tr_b16 v[152:153], v6 offset:8192
ds_read_b64_tr_b16 v[154:155], v6 offset:8704
s_add_u32 m0, s38, 6144
v_mfma_f32_32x32x16_bf16 v[24:39], v[160:163], a[24:27], v[24:39]
ds_read_b64_tr_b16 v[156:157], v7 offset:8192
buffer_load_dwordx4 v2, s[12:15], s49 offen lds
v_dot2_f32_bf16 v195, v99, v99, v195
v_mfma_f32_32x32x16_bf16 v[40:55], v[160:163], a[28:31], v[40:55]
ds_read_b64_tr_b16 v[158:159], v7 offset:8704
buffer_load_dwordx4 v3, s[12:15], s49 offen offset:1024 lds
v_dot2_f32_bf16 v192, v100, v100, v192
v_mfma_f32_32x32x16_bf16 v[56:71], v[164:167], a[24:27], v[56:71]
ds_read_b128 a[40:43], v177 offset:5120
ds_read_b128 a[44:47], v179 offset:5120
v_dot2_f32_bf16 v193, v101, v101, v193
v_dot2_f32_bf16 v194, v102, v102, v194
v_mfma_f32_32x32x16_bf16 v[72:87], v[164:167], a[28:31], v[72:87]
v_dot2_f32_bf16 v195, v103, v103, v195
s_waitcnt vmcnt(8) lgkmcnt(2)
ds_read_b64_tr_b16 v[160:161], v6 offset:10240
ds_read_b64_tr_b16 v[162:163], v6 offset:10752
s_add_u32 m0, s38, 8192
v_mfma_f32_32x32x16_bf16 v[24:39], v[152:155], a[32:35], v[24:39]
ds_read_b64_tr_b16 v[164:165], v7 offset:10240
buffer_load_dwordx4 v2, s[12:15], s50 offen lds
v_dot2_f32_bf16 v192, v104, v104, v192
v_mfma_f32_32x32x16_bf16 v[40:55], v[152:155], a[36:39], v[40:55]
ds_read_b64_tr_b16 v[166:167], v7 offset:10752
buffer_load_dwordx4 v3, s[12:15], s50 offen offset:1024 lds
v_dot2_f32_bf16 v193, v105, v105, v193
v_mfma_f32_32x32x16_bf16 v[56:71], v[156:159], a[32:35], v[56:71]
ds_read_b128 a[48:51], v176 offset:6144
ds_read_b128 a[52:55], v178 offset:6144
v_dot2_f32_bf16 v194, v106, v106, v194
v_dot2_f32_bf16 v195, v107, v107, v195
v_mfma_f32_32x32x16_bf16 v[72:87], v[156:159], a[36:39], v[72:87]
v_dot2_f32_bf16 v192, v108, v108, v192
s_waitcnt vmcnt(8) lgkmcnt(2)
ds_read_b64_tr_b16 v[152:153], v6 offset:0
ds_read_b64_tr_b16 v[154:155], v6 offset:512
s_add_u32 m0, s38, 10240
v_mfma_f32_32x32x16_bf16 v[24:39], v[160:163], a[40:43], v[24:39]
ds_read_b64_tr_b16 v[156:157], v7 offset:0
buffer_load_dwordx4 v2, s[12:15], s51 offen lds
v_dot2_f32_bf16 v193, v109, v109, v193
v_mfma_f32_32x32x16_bf16 v[40:55], v[160:163], a[44:47], v[40:55]
ds_read_b64_tr_b16 v[158:159], v7 offset:512
buffer_load_dwordx4 v3, s[12:15], s51 offen offset:1024 lds
v_dot2_f32_bf16 v194, v110, v110, v194
v_mfma_f32_32x32x16_bf16 v[56:71], v[164:167], a[40:43], v[56:71]
ds_read_b128 a[56:59], v177 offset:7168
ds_read_b128 a[60:63], v179 offset:7168
v_dot2_f32_bf16 v195, v111, v111, v195
v_dot2_f32_bf16 v192, v112, v112, v192
v_mfma_f32_32x32x16_bf16 v[72:87], v[164:167], a[44:47], v[72:87]
v_dot2_f32_bf16 v193, v113, v113, v193
s_waitcnt vmcnt(8) lgkmcnt(2)
ds_read_b64_tr_b16 v[160:161], v6 offset:2048
ds_read_b64_tr_b16 v[162:163], v6 offset:2560
s_add_u32 m0, s38, 0
v_mfma_f32_32x32x16_bf16 v[24:39], v[152:155], a[48:51], v[24:39]
ds_read_b64_tr_b16 v[164:165], v7 offset:2048
buffer_load_dwordx4 v2, s[12:15], s52 offen lds
v_dot2_f32_bf16 v194, v114, v114, v194
v_mfma_f32_32x32x16_bf16 v[40:55], v[152:155], a[52:55], v[40:55]
ds_read_b64_tr_b16 v[166:167], v7 offset:2560
buffer_load_dwordx4 v3, s[12:15], s52 offen offset:1024 lds
v_dot2_f32_bf16 v195, v115, v115, v195
v_mfma_f32_32x32x16_bf16 v[56:71], v[156:159], a[48:51], v[56:71]
ds_read_b128 a[64:67], v176 offset:8192
ds_read_b128 a[68:71], v178 offset:8192
v_dot2_f32_bf16 v192, v116, v116, v192
v_dot2_f32_bf16 v193, v117, v117, v193
v_mfma_f32_32x32x16_bf16 v[72:87], v[156:159], a[52:55], v[72:87]
v_dot2_f32_bf16 v194, v118, v118, v194
s_waitcnt vmcnt(8) lgkmcnt(2)
ds_read_b64_tr_b16 v[152:153], v6 offset:4096
ds_read_b64_tr_b16 v[154:155], v6 offset:4608
s_add_u32 m0, s38, 2048
v_mfma_f32_32x32x16_bf16 v[24:39], v[160:163], a[56:59], v[24:39]
ds_read_b64_tr_b16 v[156:157], v7 offset:4096
buffer_load_dwordx4 v2, s[12:15], s53 offen lds
v_dot2_f32_bf16 v195, v119, v119, v195
v_mfma_f32_32x32x16_bf16 v[40:55], v[160:163], a[60:63], v[40:55]
ds_read_b64_tr_b16 v[158:159], v7 offset:4608
buffer_load_dwordx4 v3, s[12:15], s53 offen offset:1024 lds
v_dot2_f32_bf16 v192, v120, v120, v192
v_mfma_f32_32x32x16_bf16 v[56:71], v[164:167], a[56:59], v[56:71]
ds_read_b128 a[72:75], v177 offset:9216
ds_read_b128 a[76:79], v179 offset:9216
v_dot2_f32_bf16 v193, v121, v121, v193
v_dot2_f32_bf16 v194, v122, v122, v194
v_mfma_f32_32x32x16_bf16 v[72:87], v[164:167], a[60:63], v[72:87]
v_dot2_f32_bf16 v195, v123, v123, v195
v_dot2_f32_bf16 v192, v124, v124, v192
s_waitcnt vmcnt(8) lgkmcnt(2)
ds_read_b64_tr_b16 v[160:161], v6 offset:6144
ds_read_b64_tr_b16 v[162:163], v6 offset:6656
s_add_u32 m0, s38, 4096
v_mfma_f32_32x32x16_bf16 v[24:39], v[152:155], a[64:67], v[24:39]
ds_read_b64_tr_b16 v[164:165], v7 offset:6144
buffer_load_dwordx4 v2, s[12:15], s54 offen lds
v_mfma_f32_32x32x16_bf16 v[40:55], v[152:155], a[68:71], v[40:55]
ds_read_b64_tr_b16 v[166:167], v7 offset:6656
buffer_load_dwordx4 v3, s[12:15], s54 offen offset:1024 lds
v_dot2_f32_bf16 v193, v125, v125, v193
v_mfma_f32_32x32x16_bf16 v[56:71], v[156:159], a[64:67], v[56:71]
ds_read_b128 a[80:83], v176 offset:10240
ds_read_b128 a[84:87], v178 offset:10240
v_dot2_f32_bf16 v194, v126, v126, v194
v_dot2_f32_bf16 v195, v127, v127, v195
v_dot2_f32_bf16 v192, v128, v128, v192
v_mfma_f32_32x32x16_bf16 v[72:87], v[156:159], a[68:71], v[72:87]
v_dot2_f32_bf16 v193, v129, v129, v193
s_waitcnt vmcnt(8) lgkmcnt(2)
ds_read_b64_tr_b16 v[152:153], v6 offset:8192
ds_read_b64_tr_b16 v[154:155], v6 offset:8704
s_add_u32 m0, s38, 6144
v_mfma_f32_32x32x16_bf16 v[24:39], v[160:163], a[72:75], v[24:39]
ds_read_b64_tr_b16 v[156:157], v7 offset:8192
buffer_load_dwordx4 v2, s[12:15], s55 offen lds
v_mfma_f32_32x32x16_bf16 v[40:55], v[160:163], a[76:79], v[40:55]
ds_read_b64_tr_b16 v[158:159], v7 offset:8704
buffer_load_dwordx4 v3, s[12:15], s55 offen offset:1024 lds
v_dot2_f32_bf16 v194, v130, v130, v194
v_mfma_f32_32x32x16_bf16 v[56:71], v[164:167], a[72:75], v[56:71]
ds_read_b128 a[88:91], v177 offset:11264
ds_read_b128 a[92:95], v179 offset:11264
v_dot2_f32_bf16 v195, v131, v131, v195
v_dot2_f32_bf16 v192, v132, v132, v192
v_dot2_f32_bf16 v193, v133, v133, v193
v_mfma_f32_32x32x16_bf16 v[72:87], v[164:167], a[76:79], v[72:87]
v_dot2_f32_bf16 v194, v134, v134, v194
s_waitcnt vmcnt(8) lgkmcnt(2)
ds_read_b64_tr_b16 v[160:161], v6 offset:10240
ds_read_b64_tr_b16 v[162:163], v6 offset:10752
s_add_u32 m0, s38, 8192
v_mfma_f32_32x32x16_bf16 v[24:39], v[152:155], a[80:83], v[24:39]
ds_read_b64_tr_b16 v[164:165], v7 offset:10240
buffer_load_dwordx4 v2, s[12:15], s56 offen lds
v_mfma_f32_32x32x16_bf16 v[40:55], v[152:155], a[84:87], v[40:55]
ds_read_b64_tr_b16 v[166:167], v7 offset:10752
buffer_load_dwordx4 v3, s[12:15], s56 offen offset:1024 lds
v_dot2_f32_bf16 v195, v135, v135, v195
v_mfma_f32_32x32x16_bf16 v[56:71], v[156:159], a[80:83], v[56:71]
ds_read_b128 a[96:99], v176 offset:12288
ds_read_b128 a[100:103], v178 offset:12288
v_dot2_f32_bf16 v192, v136, v136, v192
v_dot2_f32_bf16 v193, v137, v137, v193
v_dot2_f32_bf16 v194, v138, v138, v194
v_mfma_f32_32x32x16_bf16 v[72:87], v[156:159], a[84:87], v[72:87]
v_dot2_f32_bf16 v195, v139, v139, v195
s_waitcnt vmcnt(8) lgkmcnt(2)
ds_read_b64_tr_b16 v[152:153], v6 offset:0
ds_read_b64_tr_b16 v[154:155], v6 offset:512
s_add_u32 m0, s38, 10240
v_mfma_f32_32x32x16_bf16 v[24:39], v[160:163], a[88:91], v[24:39]
ds_read_b64_tr_b16 v[156:157], v7 offset:0
buffer_load_dwordx4 v2, s[12:15], s57 offen lds
v_mfma_f32_32x32x16_bf16 v[40:55], v[160:163], a[92:95], v[40:55]
ds_read_b64_tr_b16 v[158:159], v7 offset:512
buffer_load_dwordx4 v3, s[12:15], s57 offen offset:1024 lds
v_dot2_f32_bf16 v192, v140, v140, v192
v_dot2_f32_bf16 v193, v141, v141, v193
v_mfma_f32_32x32x16_bf16 v[56:71], v[164:167], a[88:91], v[56:71]
ds_read_b128 a[104:107], v177 offset:13312
ds_read_b128 a[108:111], v179 offset:13312
v_dot2_f32_bf16 v194, v142, v142, v194
v_dot2_f32_bf16 v195, v143, v143, v195
v_mfma_f32_32x32x16_bf16 v[72:87], v[164:167], a[92:95], v[72:87]
v_dot2_f32_bf16 v192, v144, v144, v192
s_waitcnt vmcnt(8) lgkmcnt(2)
ds_read_b64_tr_b16 v[160:161], v6 offset:2048
ds_read_b64_tr_b16 v[162:163], v6 offset:2560
s_add_u32 m0, s38, 0
v_mfma_f32_32x32x16_bf16 v[24:39], v[152:155], a[96:99], v[24:39]
ds_read_b64_tr_b16 v[164:165], v7 offset:2048
buffer_load_dwordx4 v2, s[12:15], s58 offen lds
v_dot2_f32_bf16 v193, v145, v145, v193
v_mfma_f32_32x32x16_bf16 v[40:55], v[152:155], a[100:103], v[40:55]
ds_read_b64_tr_b16 v[166:167], v7 offset:2560
buffer_load_dwordx4 v3, s[12:15], s58 offen offset:1024 lds
v_dot2_f32_bf16 v194, v146, v146, v194
v_mfma_f32_32x32x16_bf16 v[56:71], v[156:159], a[96:99], v[56:71]
ds_read_b128 a[112:115], v176 offset:14336
ds_read_b128 a[116:119], v178 offset:14336
v_dot2_f32_bf16 v195, v147, v147, v195
v_dot2_f32_bf16 v192, v148, v148, v192
v_mfma_f32_32x32x16_bf16 v[72:87], v[156:159], a[100:103], v[72:87]
v_dot2_f32_bf16 v193, v149, v149, v193
s_waitcnt vmcnt(8) lgkmcnt(2)
ds_read_b64_tr_b16 v[152:153], v6 offset:4096
ds_read_b64_tr_b16 v[154:155], v6 offset:4608
s_add_u32 m0, s38, 2048
v_mfma_f32_32x32x16_bf16 v[24:39], v[160:163], a[104:107], v[24:39]
ds_read_b64_tr_b16 v[156:157], v7 offset:4096
buffer_load_dwordx4 v2, s[12:15], s59 offen lds
v_dot2_f32_bf16 v194, v150, v150, v194
v_mfma_f32_32x32x16_bf16 v[40:55], v[160:163], a[108:111], v[40:55]
ds_read_b64_tr_b16 v[158:159], v7 offset:4608
buffer_load_dwordx4 v3, s[12:15], s59 offen offset:1024 lds
v_dot2_f32_bf16 v195, v151, v151, v195
v_mfma_f32_32x32x16_bf16 v[56:71], v[164:167], a[104:107], v[56:71]
ds_read_b128 a[120:123], v177 offset:15360
ds_read_b128 a[124:127], v179 offset:15360
v_dot2_f32_bf16 v192, v184, v184, v192
v_dot2_f32_bf16 v193, v185, v185, v193
v_mfma_f32_32x32x16_bf16 v[72:87], v[164:167], a[108:111], v[72:87]
v_dot2_f32_bf16 v194, v186, v186, v194
s_waitcnt vmcnt(8) lgkmcnt(2)
ds_read_b64_tr_b16 v[160:161], v6 offset:6144
ds_read_b64_tr_b16 v[162:163], v6 offset:6656
s_add_u32 m0, s38, 4096
v_mfma_f32_32x32x16_bf16 v[24:39], v[152:155], a[112:115], v[24:39]
ds_read_b64_tr_b16 v[164:165], v7 offset:6144
buffer_load_dwordx4 v2, s[12:15], s60 offen lds
v_dot2_f32_bf16 v195, v187, v187, v195
v_mfma_f32_32x32x16_bf16 v[40:55], v[152:155], a[116:119], v[40:55]
ds_read_b64_tr_b16 v[166:167], v7 offset:6656
buffer_load_dwordx4 v3, s[12:15], s60 offen offset:1024 lds
v_dot2_f32_bf16 v192, v188, v188, v192
v_mfma_f32_32x32x16_bf16 v[56:71], v[156:159], a[112:115], v[56:71]
ds_read_b128 a[128:131], v176 offset:16384
ds_read_b128 a[132:135], v178 offset:16384
v_dot2_f32_bf16 v193, v189, v189, v193
v_dot2_f32_bf16 v194, v190, v190, v194
v_mfma_f32_32x32x16_bf16 v[72:87], v[156:159], a[116:119], v[72:87]
v_dot2_f32_bf16 v195, v191, v191, v195
s_waitcnt vmcnt(8) lgkmcnt(2)
ds_read_b64_tr_b16 v[152:153], v6 offset:8192
ds_read_b64_tr_b16 v[154:155], v6 offset:8704
s_add_u32 m0, s38, 6144
v_mfma_f32_32x32x16_bf16 v[24:39], v[160:163], a[120:123], v[24:39]
ds_read_b64_tr_b16 v[156:157], v7 offset:8192
buffer_load_dwordx4 v2, s[12:15], s61 offen lds
v_mfma_f32_32x32x16_bf16 v[40:55], v[160:163], a[124:127], v[40:55]
ds_read_b64_tr_b16 v[158:159], v7 offset:8704
buffer_load_dwordx4 v3, s[12:15], s61 offen offset:1024 lds
v_mfma_f32_32x32x16_bf16 v[56:71], v[164:167], a[120:123], v[56:71]
ds_read_b128 a[136:139], v177 offset:17408
ds_read_b128 a[140:143], v179 offset:17408
v_mfma_f32_32x32x16_bf16 v[72:87], v[164:167], a[124:127], v[72:87]
s_waitcnt vmcnt(8) lgkmcnt(2)
ds_read_b64_tr_b16 v[160:161], v6 offset:10240
ds_read_b64_tr_b16 v[162:163], v6 offset:10752
s_add_u32 m0, s38, 8192
v_mfma_f32_32x32x16_bf16 v[24:39], v[152:155], a[128:131], v[24:39]
ds_read_b64_tr_b16 v[164:165], v7 offset:10240
buffer_load_dwordx4 v2, s[12:15], s62 offen lds
v_mfma_f32_32x32x16_bf16 v[40:55], v[152:155], a[132:135], v[40:55]
ds_read_b64_tr_b16 v[166:167], v7 offset:10752
buffer_load_dwordx4 v3, s[12:15], s62 offen offset:1024 lds
v_add_f32 v192, v192, v193
v_mfma_f32_32x32x16_bf16 v[56:71], v[156:159], a[128:131], v[56:71]
ds_read_b128 a[144:147], v176 offset:18432
ds_read_b128 a[148:151], v178 offset:18432
v_add_f32 v194, v194, v195
v_mfma_f32_32x32x16_bf16 v[72:87], v[156:159], a[132:135], v[72:87]
s_nop 0
v_add_f32 v192, v192, v194
s_nop 1
s_waitcnt vmcnt(8) lgkmcnt(2)
ds_read_b64_tr_b16 v[152:153], v6 offset:0
ds_read_b64_tr_b16 v[154:155], v6 offset:512
s_add_u32 m0, s38, 10240
v_mfma_f32_32x32x16_bf16 v[24:39], v[160:163], a[136:139], v[24:39]
ds_read_b64_tr_b16 v[156:157], v7 offset:0
buffer_load_dwordx4 v2, s[12:15], s63 offen lds
v_mfma_f32_32x32x16_bf16 v[40:55], v[160:163], a[140:143], v[40:55]
ds_read_b64_tr_b16 v[158:159], v7 offset:512
buffer_load_dwordx4 v3, s[12:15], s63 offen offset:1024 lds
v_add_f32_dpp v192, v192, v192 quad_perm:[1,0,3,2] row_mask:0xf bank_mask:0xf
s_nop 1
v_mfma_f32_32x32x16_bf16 v[56:71], v[164:167], a[136:139], v[56:71]
ds_read_b128 a[152:155], v177 offset:19456
ds_read_b128 a[156:159], v179 offset:19456
v_add_f32_dpp v192, v192, v192 quad_perm:[2,3,0,1] row_mask:0xf bank_mask:0xf
v_mfma_f32_32x32x16_bf16 v[72:87], v[164:167], a[140:143], v[72:87]
v_mul_f32 v192, 0x3ae38e39, v192
s_waitcnt vmcnt(8) lgkmcnt(2)
ds_read_b64_tr_b16 v[160:161], v6 offset:2048
ds_read_b64_tr_b16 v[162:163], v6 offset:2560
s_add_u32 m0, s38, 0
v_mfma_f32_32x32x16_bf16 v[24:39], v[152:155], a[144:147], v[24:39]
ds_read_b64_tr_b16 v[164:165], v7 offset:2048
buffer_load_dwordx4 v2, s[12:15], s64 offen lds
v_mfma_f32_32x32x16_bf16 v[40:55], v[152:155], a[148:151], v[40:55]
ds_read_b64_tr_b16 v[166:167], v7 offset:2560
buffer_load_dwordx4 v3, s[12:15], s64 offen offset:1024 lds
v_fma_f32 v192, -v180, v180, v192
v_mfma_f32_32x32x16_bf16 v[56:71], v[156:159], a[144:147], v[56:71]
ds_read_b128 a[160:163], v176 offset:20480
ds_read_b128 a[164:167], v178 offset:20480
v_max_f32 v192, 0, v192
v_mfma_f32_32x32x16_bf16 v[72:87], v[156:159], a[148:151], v[72:87]
v_cvt_pk_bf16_f32 v192, v192, v192
v_lshlrev_b32 v192, 16, v192
s_waitcnt vmcnt(8) lgkmcnt(2)
ds_read_b64_tr_b16 v[152:153], v6 offset:4096
ds_read_b64_tr_b16 v[154:155], v6 offset:4608
s_add_u32 m0, s38, 2048
v_mfma_f32_32x32x16_bf16 v[24:39], v[160:163], a[152:155], v[24:39]
ds_read_b64_tr_b16 v[156:157], v7 offset:4096
buffer_load_dwordx4 v2, s[12:15], s65 offen lds
v_mfma_f32_32x32x16_bf16 v[40:55], v[160:163], a[156:159], v[40:55]
ds_read_b64_tr_b16 v[158:159], v7 offset:4608
buffer_load_dwordx4 v3, s[12:15], s65 offen offset:1024 lds
v_add_f32 v192, 0x3727c5ac, v192
v_mfma_f32_32x32x16_bf16 v[56:71], v[164:167], a[152:155], v[56:71]
ds_read_b128 a[168:171], v177 offset:21504
ds_read_b128 a[172:175], v179 offset:21504
v_cvt_pk_bf16_f32 v192, v192, v192
v_lshlrev_b32 v192, 16, v192
v_mfma_f32_32x32x16_bf16 v[72:87], v[164:167], a[156:159], v[72:87]
v_sqrt_f32 v192, v192
s_nop 0
s_waitcnt vmcnt(8) lgkmcnt(2)
ds_read_b64_tr_b16 v[160:161], v6 offset:6144
ds_read_b64_tr_b16 v[162:163], v6 offset:6656
s_add_u32 m0, s38, 4096
v_mfma_f32_32x32x16_bf16 v[24:39], v[152:155], a[160:163], v[24:39]
ds_read_b64_tr_b16 v[164:165], v7 offset:6144
buffer_load_dwordx4 v2, s[12:15], s66 offen lds
v_mfma_f32_32x32x16_bf16 v[40:55], v[152:155], a[164:167], v[40:55]
ds_read_b64_tr_b16 v[166:167], v7 offset:6656
buffer_load_dwordx4 v3, s[12:15], s66 offen offset:1024 lds
v_cvt_pk_bf16_f32 v192, v192, v192
v_lshlrev_b32 v192, 16, v192
v_mfma_f32_32x32x16_bf16 v[56:71], v[156:159], a[160:163], v[56:71]
ds_read_b128 a[176:179], v176 offset:22528
ds_read_b128 a[180:183], v178 offset:22528
s_lshl_b32 s92, s5, 6
s_add_u32 s92, s92, 163328
v_lshrrev_b32 v193, 2, v1
v_lshlrev_b32 v193, 2, v193
v_add_u32 v193, s92, v193
v_mfma_f32_32x32x16_bf16 v[72:87], v[156:159], a[164:167], v[72:87]
s_waitcnt vmcnt(8) lgkmcnt(2)
ds_read_b64_tr_b16 v[152:153], v6 offset:8192
ds_read_b64_tr_b16 v[154:155], v6 offset:8704
s_add_u32 m0, s38, 6144
v_mfma_f32_32x32x16_bf16 v[24:39], v[160:163], a[168:171], v[24:39]
ds_read_b64_tr_b16 v[156:157], v7 offset:8192
buffer_load_dwordx4 v2, s[12:15], s67 offen lds
v_mfma_f32_32x32x16_bf16 v[40:55], v[160:163], a[172:175], v[40:55]
ds_read_b64_tr_b16 v[158:159], v7 offset:8704
buffer_load_dwordx4 v3, s[12:15], s67 offen offset:1024 lds
v_mfma_f32_32x32x16_bf16 v[56:71], v[164:167], a[168:171], v[56:71]
ds_read_b128 a[184:187], v177 offset:23552
ds_read_b128 a[188:191], v179 offset:23552
ds_write_b32 v193, v192
v_mfma_f32_32x32x16_bf16 v[72:87], v[164:167], a[172:175], v[72:87]
s_waitcnt vmcnt(8) lgkmcnt(3)
ds_read_b64_tr_b16 v[160:161], v6 offset:10240
ds_read_b64_tr_b16 v[162:163], v6 offset:10752
s_add_u32 m0, s38, 8192
v_mfma_f32_32x32x16_bf16 v[24:39], v[152:155], a[176:179], v[24:39]
ds_read_b64_tr_b16 v[164:165], v7 offset:10240
buffer_load_dwordx4 v2, s[12:15], s68 offen lds
v_mfma_f32_32x32x16_bf16 v[40:55], v[152:155], a[180:183], v[40:55]
ds_read_b64_tr_b16 v[166:167], v7 offset:10752
buffer_load_dwordx4 v3, s[12:15], s68 offen offset:1024 lds
v_mfma_f32_32x32x16_bf16 v[56:71], v[156:159], a[176:179], v[56:71]
ds_read_b128 a[192:195], v176 offset:24576
ds_read_b128 a[196:199], v178 offset:24576
v_mfma_f32_32x32x16_bf16 v[72:87], v[156:159], a[180:183], v[72:87]
s_waitcnt vmcnt(8) lgkmcnt(2)
ds_read_b64_tr_b16 v[152:153], v6 offset:0
ds_read_b64_tr_b16 v[154:155], v6 offset:512
s_add_u32 m0, s38, 10240
v_mfma_f32_32x32x16_bf16 v[24:39], v[160:163], a[184:187], v[24:39]
ds_read_b64_tr_b16 v[156:157], v7 offset:0
buffer_load_dwordx4 v2, s[12:15], s69 offen lds
v_mfma_f32_32x32x16_bf16 v[40:55], v[160:163], a[188:191], v[40:55]
ds_read_b64_tr_b16 v[158:159], v7 offset:512
buffer_load_dwordx4 v3, s[12:15], s69 offen offset:1024 lds
v_mfma_f32_32x32x16_bf16 v[56:71], v[164:167], a[184:187], v[56:71]
ds_read_b128 a[200:203], v177 offset:25600
ds_read_b128 a[204:207], v179 offset:25600
v_mfma_f32_32x32x16_bf16 v[72:87], v[164:167], a[188:191], v[72:87]
s_waitcnt vmcnt(8) lgkmcnt(2)
ds_read_b64_tr_b16 v[160:161], v6 offset:2048
ds_read_b64_tr_b16 v[162:163], v6 offset:2560
s_add_u32 m0, s38, 0
v_mfma_f32_32x32x16_bf16 v[24:39], v[152:155], a[192:195], v[24:39]
ds_read_b64_tr_b16 v[164:165], v7 offset:2048
buffer_load_dwordx4 v2, s[12:15], s70 offen lds
v_mfma_f32_32x32x16_bf16 v[40:55], v[152:155], a[196:199], v[40:55]
ds_read_b64_tr_b16 v[166:167], v7 offset:2560
buffer_load_dwordx4 v3, s[12:15], s70 offen offset:1024 lds
v_mfma_f32_32x32x16_bf16 v[56:71], v[156:159], a[192:195], v[56:71]
ds_read_b128 a[208:211], v176 offset:26624
ds_read_b128 a[212:215], v178 offset:26624
v_mfma_f32_32x32x16_bf16 v[72:87], v[156:159], a[196:199], v[72:87]
s_waitcnt vmcnt(8) lgkmcnt(2)
ds_read_b64_tr_b16 v[152:153], v6 offset:4096
ds_read_b64_tr_b16 v[154:155], v6 offset:4608
s_add_u32 m0, s38, 2048
v_mfma_f32_32x32x16_bf16 v[24:39], v[160:163], a[200:203], v[24:39]
ds_read_b64_tr_b16 v[156:157], v7 offset:4096
buffer_load_dwordx4 v2, s[12:15], s71 offen lds
v_mfma_f32_32x32x16_bf16 v[40:55], v[160:163], a[204:207], v[40:55]
ds_read_b64_tr_b16 v[158:159], v7 offset:4608
buffer_load_dwordx4 v3, s[12:15], s71 offen offset:1024 lds
v_mfma_f32_32x32x16_bf16 v[56:71], v[164:167], a[200:203], v[56:71]
ds_read_b128 a[216:219], v177 offset:27648
ds_read_b128 a[220:223], v179 offset:27648
v_mfma_f32_32x32x16_bf16 v[72:87], v[164:167], a[204:207], v[72:87]
s_waitcnt vmcnt(8) lgkmcnt(2)
ds_read_b64_tr_b16 v[160:161], v6 offset:6144
ds_read_b64_tr_b16 v[162:163], v6 offset:6656
s_add_u32 m0, s38, 4096
v_mfma_f32_32x32x16_bf16 v[24:39], v[152:155], a[208:211], v[24:39]
ds_read_b64_tr_b16 v[164:165], v7 offset:6144
buffer_load_dwordx4 v2, s[12:15], s72 offen lds
v_mfma_f32_32x32x16_bf16 v[40:55], v[152:155], a[212:215], v[40:55]
ds_read_b64_tr_b16 v[166:167], v7 offset:6656
buffer_load_dwordx4 v3, s[12:15], s72 offen offset:1024 lds
v_mfma_f32_32x32x16_bf16 v[56:71], v[156:159], a[208:211], v[56:71]
ds_read_b128 a[224:227], v176 offset:28672
ds_read_b128 a[228:231], v178 offset:28672
v_mfma_f32_32x32x16_bf16 v[72:87], v[156:159], a[212:215], v[72:87]
s_waitcnt vmcnt(8) lgkmcnt(2)
ds_read_b64_tr_b16 v[152:153], v6 offset:8192
ds_read_b64_tr_b16 v[154:155], v6 offset:8704
s_add_u32 m0, s38, 6144
v_mfma_f32_32x32x16_bf16 v[24:39], v[160:163], a[216:219], v[24:39]
ds_read_b64_tr_b16 v[156:157], v7 offset:8192
buffer_load_dwordx4 v2, s[12:15], s73 offen lds
v_mfma_f32_32x32x16_bf16 v[40:55], v[160:163], a[220:223], v[40:55]
ds_read_b64_tr_b16 v[158:159], v7 offset:8704
buffer_load_dwordx4 v3, s[12:15], s73 offen offset:1024 lds
v_mfma_f32_32x32x16_bf16 v[56:71], v[164:167], a[216:219], v[56:71]
ds_read_b128 a[232:235], v177 offset:29696
ds_read_b128 a[236:239], v179 offset:29696
v_mfma_f32_32x32x16_bf16 v[72:87], v[164:167], a[220:223], v[72:87]
s_waitcnt vmcnt(8) lgkmcnt(2)
ds_read_b64_tr_b16 v[160:161], v6 offset:10240
ds_read_b64_tr_b16 v[162:163], v6 offset:10752
s_add_u32 m0, s38, 8192
v_mfma_f32_32x32x16_bf16 v[24:39], v[152:155], a[224:227], v[24:39]
ds_read_b64_tr_b16 v[164:165], v7 offset:10240
buffer_load_dwordx4 v2, s[12:15], s74 offen lds
v_mfma_f32_32x32x16_bf16 v[40:55], v[152:155], a[228:231], v[40:55]
ds_read_b64_tr_b16 v[166:167], v7 offset:10752
buffer_load_dwordx4 v3, s[12:15], s74 offen offset:1024 lds
v_mfma_f32_32x32x16_bf16 v[56:71], v[156:159], a[224:227], v[56:71]
ds_read_b128 a[240:243], v176 offset:30720
ds_read_b128 a[244:247], v178 offset:30720
v_mfma_f32_32x32x16_bf16 v[72:87], v[156:159], a[228:231], v[72:87]
s_waitcnt vmcnt(8) lgkmcnt(2)
ds_read_b64_tr_b16 v[152:153], v6 offset:0
ds_read_b64_tr_b16 v[154:155], v6 offset:512
s_add_u32 m0, s38, 10240
v_mfma_f32_32x32x16_bf16 v[24:39], v[160:163], a[232:235], v[24:39]
ds_read_b64_tr_b16 v[156:157], v7 offset:0
buffer_load_dwordx4 v2, s[12:15], s75 offen lds
v_mfma_f32_32x32x16_bf16 v[40:55], v[160:163], a[236:239], v[40:55]
ds_read_b64_tr_b16 v[158:159], v7 offset:512
buffer_load_dwordx4 v3, s[12:15], s75 offen offset:1024 lds
v_mfma_f32_32x32x16_bf16 v[56:71], v[164:167], a[232:235], v[56:71]
ds_read_b128 a[248:251], v177 offset:31744
ds_read_b128 a[252:255], v179 offset:31744
v_mfma_f32_32x32x16_bf16 v[72:87], v[164:167], a[236:239], v[72:87]
s_waitcnt vmcnt(8) lgkmcnt(2)
ds_read_b64_tr_b16 v[160:161], v6 offset:2048
ds_read_b64_tr_b16 v[162:163], v6 offset:2560
s_add_u32 m0, s38, 0
v_mfma_f32_32x32x16_bf16 v[24:39], v[152:155], a[240:243], v[24:39]
ds_read_b64_tr_b16 v[164:165], v7 offset:2048
buffer_load_dwordx4 v4, s[16:19], s81 offen lds
v_mfma_f32_32x32x16_bf16 v[40:55], v[152:155], a[244:247], v[40:55]
ds_read_b64_tr_b16 v[166:167], v7 offset:2560
buffer_load_dwordx4 v5, s[16:19], s81 offen offset:1024 lds
v_mfma_f32_32x32x16_bf16 v[56:71], v[156:159], a[240:243], v[56:71]
ds_read_b128 v[224:227], v176 offset:32768
ds_read_b128 v[228:231], v178 offset:32768
v_mfma_f32_32x32x16_bf16 v[72:87], v[156:159], a[244:247], v[72:87]
s_waitcnt vmcnt(8) lgkmcnt(2)
ds_read_b64_tr_b16 v[152:153], v6 offset:4096
ds_read_b64_tr_b16 v[154:155], v6 offset:4608
s_add_u32 m0, s38, 2048
v_mfma_f32_32x32x16_bf16 v[24:39], v[160:163], a[248:251], v[24:39]
ds_read_b64_tr_b16 v[156:157], v7 offset:4096
buffer_load_dwordx4 v4, s[16:19], s82 offen lds
v_mfma_f32_32x32x16_bf16 v[40:55], v[160:163], a[252:255], v[40:55]
ds_read_b64_tr_b16 v[158:159], v7 offset:4608
buffer_load_dwordx4 v5, s[16:19], s82 offen offset:1024 lds
v_mfma_f32_32x32x16_bf16 v[56:71], v[164:167], a[248:251], v[56:71]
ds_read_b128 v[232:235], v177 offset:33792
ds_read_b128 v[236:239], v179 offset:33792
v_mfma_f32_32x32x16_bf16 v[72:87], v[164:167], a[252:255], v[72:87]
s_waitcnt lgkmcnt(0)
s_barrier
s_waitcnt vmcnt(8) lgkmcnt(2)
ds_read_b64_tr_b16 v[160:161], v6 offset:6144
ds_read_b64_tr_b16 v[162:163], v6 offset:6656
s_add_u32 m0, s38, 4096
v_mfma_f32_32x32x16_bf16 v[24:39], v[152:155], v[224:227], v[24:39]
ds_read_b64_tr_b16 v[164:165], v7 offset:6144
buffer_load_dwordx4 v4, s[16:19], s83 offen lds
v_mfma_f32_32x32x16_bf16 v[40:55], v[152:155], v[228:231], v[40:55]
ds_read_b64_tr_b16 v[166:167], v7 offset:6656
buffer_load_dwordx4 v5, s[16:19], s83 offen offset:1024 lds
v_and_b32 v193, 31, v1
v_lshlrev_b32 v193, 2, v193
v_add_u32 v193, 163328, v193
v_mfma_f32_32x32x16_bf16 v[56:71], v[156:159], v[224:227], v[56:71]
ds_read_b128 v[240:243], v176 offset:34816
ds_read_b128 v[244:247], v178 offset:34816
ds_read_b32 v12, v193
ds_read_b32 v13, v193 offset:128
v_mfma_f32_32x32x16_bf16 v[72:87], v[156:159], v[228:231], v[72:87]
s_waitcnt vmcnt(8) lgkmcnt(4)
ds_read_b64_tr_b16 v[152:153], v6 offset:8192
ds_read_b64_tr_b16 v[154:155], v6 offset:8704
s_add_u32 m0, s38, 6144
v_mfma_f32_32x32x16_bf16 v[24:39], v[160:163], v[232:235], v[24:39]
ds_read_b64_tr_b16 v[156:157], v7 offset:8192
buffer_load_dwordx4 v4, s[16:19], s84 offen lds
v_mfma_f32_32x32x16_bf16 v[40:55], v[160:163], v[236:239], v[40:55]
ds_read_b64_tr_b16 v[158:159], v7 offset:8704
buffer_load_dwordx4 v5, s[16:19], s84 offen offset:1024 lds
v_mfma_f32_32x32x16_bf16 v[56:71], v[164:167], v[232:235], v[56:71]
ds_read_b128 v[248:251], v177 offset:35840
ds_read_b128 v[252:255], v179 offset:35840
v_mfma_f32_32x32x16_bf16 v[72:87], v[164:167], v[236:239], v[72:87]
s_waitcnt vmcnt(8) lgkmcnt(2)
ds_read_b64_tr_b16 v[160:161], v6 offset:10240
ds_read_b64_tr_b16 v[162:163], v6 offset:10752
s_add_u32 m0, s38, 8192
v_mfma_f32_32x32x16_bf16 v[24:39], v[152:155], v[240:243], v[24:39]
ds_read_b64_tr_b16 v[164:165], v7 offset:10240
buffer_load_dwordx4 v4, s[16:19], s85 offen lds
v_mfma_f32_32x32x16_bf16 v[40:55], v[152:155], v[244:247], v[40:55]
ds_read_b64_tr_b16 v[166:167], v7 offset:10752
buffer_load_dwordx4 v5, s[16:19], s85 offen offset:1024 lds
v_mfma_f32_32x32x16_bf16 v[56:71], v[156:159], v[240:243], v[56:71]
v_rcp_f32 v14, v12
v_rcp_f32 v15, v13
v_mfma_f32_32x32x16_bf16 v[72:87], v[156:159], v[244:247], v[72:87]
v_mul_f32 v10, 0xbfb8aa3b, v14
v_mul_f32 v11, 0xbfb8aa3b, v15
s_waitcnt vmcnt(8) lgkmcnt(0)
ds_read_b64_tr_b16 v[152:153], v6 offset:0
ds_read_b64_tr_b16 v[154:155], v6 offset:512
s_add_u32 m0, s38, 10240
v_mfma_f32_32x32x16_bf16 v[88:103], v[160:163], v[248:251], v[24:39]
ds_read_b64_tr_b16 v[156:157], v7 offset:0
buffer_load_dwordx4 v4, s[16:19], s86 offen lds
v_mfma_f32_32x32x16_bf16 v[104:119], v[160:163], v[252:255], v[40:55]
ds_read_b64_tr_b16 v[158:159], v7 offset:512
buffer_load_dwordx4 v5, s[16:19], s86 offen offset:1024 lds
v_mfma_f32_32x32x16_bf16 v[120:135], v[164:167], v[248:251], v[56:71]
v_mfma_f32_32x32x16_bf16 v[136:151], v[164:167], v[252:255], v[72:87]
s_barrier
s_lshl_b32 s100, s5, 3
v_and_b32 v21, 31, v1
v_mul_u32_u24 v21, 456, v21
v_lshrrev_b32 v22, 5, v1
v_lshl_add_u32 v21, v22, 3, v21
v_add_u32 v16, 122880, v21
s_mov_b32 s12, s16
s_mov_b32 s13, s17
s_mov_b32 s14, s18
v_mov_b32 v2, v4
v_mov_b32 v3, v5
s_mov_b32 s40, 0
s_mov_b32 s41, 147456
s_mov_b32 s42, 294912
s_mov_b32 s43, 442368
s_mov_b32 s44, 589824
s_mov_b32 s45, 737280
s_mov_b32 s46, 884736
s_mov_b32 s47, 1032192
s_mov_b32 s48, 1179648
s_mov_b32 s49, 1327104
s_mov_b32 s50, 1474560
s_mov_b32 s51, 1622016
s_mov_b32 s52, 1769472
s_mov_b32 s53, 1916928
s_mov_b32 s54, 2064384
s_mov_b32 s55, 2211840
s_mov_b32 s56, 2359296
s_mov_b32 s57, 2506752
s_mov_b32 s58, 2654208
s_mov_b32 s59, 2801664
s_mov_b32 s60, 2949120
s_mov_b32 s61, 3096576
s_mov_b32 s62, 3244032
s_mov_b32 s63, 3391488
s_mov_b32 s64, 3538944
s_mov_b32 s65, 3686400
s_mov_b32 s66, 3833856
s_mov_b32 s67, 3981312
s_mov_b32 s68, 4128768
s_mov_b32 s69, 4276224
s_mov_b32 s70, 4423680
s_mov_b32 s71, 4571136
s_mov_b32 s72, 4718592
s_mov_b32 s73, 4866048
s_mov_b32 s74, 5013504
s_mov_b32 s75, 5160960
s_add_u32 s95, s5, 4
s_mov_b32 s16, s34
s_mov_b32 s17, s35
s_mov_b32 s18, 5308416
s_mov_b32 s19, 0x20000
s_mul_i32 s92, s4, 1152
s_lshl_b32 s93, s95, 7
s_add_u32 s92, s92, s93
v_mul_u32_u24 v4, 9216, v18
v_add3_u32 v4, v4, v19, s92
v_add_u32 v5, 72704, v4
s_waitcnt vmcnt(8) lgkmcnt(0)
ds_read_b64_tr_b16 v[160:161], v6 offset:2048
ds_read_b64_tr_b16 v[162:163], v6 offset:2560
s_add_u32 m0, s38, 0
v_mfma_f32_32x32x16_bf16 v[24:39], v[152:155], a[0:3], 0
ds_read_b64_tr_b16 v[164:165], v7 offset:2048
buffer_load_dwordx4 v2, s[12:15], s46 offen lds
s_add_u32 s93, s100, 4294967287
s_cmp_lt_u32 s93, 9
s_cselect_b32 s96, 0xff800000, 0
s_cselect_b32 s97, 0, 1.0
s_cselect_b32 s98, 0, 0x358637bd
v_mfma_f32_32x32x16_bf16 v[40:55], v[152:155], a[4:7], 0
ds_read_b64_tr_b16 v[166:167], v7 offset:2560
buffer_load_dwordx4 v3, s[12:15], s46 offen offset:1024 lds
v_mul_f32 v176, v88, v14
v_mul_f32 v177, v89, v14
v_mul_f32 v178, v90, v14
v_mfma_f32_32x32x16_bf16 v[56:71], v[156:159], a[0:3], 0
v_mul_f32 v179, v91, v14
v_mul_f32 v180, 0x3fb8aa3b, v176
v_mul_f32 v181, 0x3fb8aa3b, v177
v_mul_f32 v182, 0x3fb8aa3b, v178
v_mul_f32 v183, 0x3fb8aa3b, v179
v_min_f32 v180, 0, v180
v_min_f32 v181, 0, v181
v_mfma_f32_32x32x16_bf16 v[72:87], v[156:159], a[4:7], 0
v_min_f32 v182, 0, v182
v_min_f32 v183, 0, v183
v_exp_f32 v180, v180
s_waitcnt vmcnt(8) lgkmcnt(0)
ds_read_b64_tr_b16 v[152:153], v6 offset:4096
ds_read_b64_tr_b16 v[154:155], v6 offset:4608
s_add_u32 m0, s38, 2048
v_mfma_f32_32x32x16_bf16 v[24:39], v[160:163], a[8:11], v[24:39]
ds_read_b64_tr_b16 v[156:157], v7 offset:4096
buffer_load_dwordx4 v2, s[12:15], s47 offen lds
v_exp_f32 v181, v181
v_mfma_f32_32x32x16_bf16 v[40:55], v[160:163], a[12:15], v[40:55]
ds_read_b64_tr_b16 v[158:159], v7 offset:4608
buffer_load_dwordx4 v3, s[12:15], s47 offen offset:1024 lds
v_exp_f32 v182, v182
v_exp_f32 v183, v183
v_mfma_f32_32x32x16_bf16 v[56:71], v[164:167], a[8:11], v[56:71]
v_max_f32 v176, s96, v176
v_max_f32 v177, s96, v177
v_max_f32 v178, s96, v178
v_max_f32 v179, s96, v179
v_fma_f32 v176, v180, s97, v176
v_fma_f32 v177, v181, s97, v177
v_mfma_f32_32x32x16_bf16 v[72:87], v[164:167], a[12:15], v[72:87]
v_fma_f32 v178, v182, s97, v178
v_fma_f32 v179, v183, s97, v179
v_add_f32 v176, s98, v176
s_waitcnt vmcnt(8) lgkmcnt(0)
ds_read_b64_tr_b16 v[160:161], v6 offset:6144
ds_read_b64_tr_b16 v[162:163], v6 offset:6656
s_add_u32 m0, s38, 4096
v_mfma_f32_32x32x16_bf16 v[24:39], v[152:155], a[16:19], v[24:39]
ds_read_b64_tr_b16 v[164:165], v7 offset:6144
buffer_load_dwordx4 v2, s[12:15], s48 offen lds
v_add_f32 v177, s98, v177
v_add_f32 v178, s98, v178
v_add_f32 v179, s98, v179
v_mfma_f32_32x32x16_bf16 v[40:55], v[152:155], a[20:23], v[40:55]
ds_read_b64_tr_b16 v[166:167], v7 offset:6656
buffer_load_dwordx4 v3, s[12:15], s48 offen offset:1024 lds
v_cvt_pk_bf16_f32 v192, v176, v177
v_cvt_pk_bf16_f32 v193, v178, v179
v_mul_f32 v184, v104, v15
v_mfma_f32_32x32x16_bf16 v[56:71], v[156:159], a[16:19], v[56:71]
v_mul_f32 v185, v105, v15
v_mul_f32 v186, v106, v15
v_mul_f32 v187, v107, v15
v_mul_f32 v188, 0x3fb8aa3b, v184
v_mul_f32 v189, 0x3fb8aa3b, v185
v_mul_f32 v190, 0x3fb8aa3b, v186
v_mul_f32 v191, 0x3fb8aa3b, v187
v_mfma_f32_32x32x16_bf16 v[72:87], v[156:159], a[20:23], v[72:87]
v_min_f32 v188, 0, v188
v_min_f32 v189, 0, v189
v_min_f32 v190, 0, v190
v_min_f32 v191, 0, v191
s_waitcnt vmcnt(8) lgkmcnt(0)
ds_read_b64_tr_b16 v[152:153], v6 offset:8192
ds_read_b64_tr_b16 v[154:155], v6 offset:8704
s_add_u32 m0, s38, 6144
v_mfma_f32_32x32x16_bf16 v[24:39], v[160:163], a[24:27], v[24:39]
ds_read_b64_tr_b16 v[156:157], v7 offset:8192
buffer_load_dwordx4 v2, s[12:15], s49 offen lds
v_exp_f32 v188, v188
v_mfma_f32_32x32x16_bf16 v[40:55], v[160:163], a[28:31], v[40:55]
ds_read_b64_tr_b16 v[158:159], v7 offset:8704
buffer_load_dwordx4 v3, s[12:15], s49 offen offset:1024 lds
v_exp_f32 v189, v189
v_exp_f32 v190, v190
v_mfma_f32_32x32x16_bf16 v[56:71], v[164:167], a[24:27], v[56:71]
v_exp_f32 v191, v191
v_max_f32 v184, s96, v184
v_max_f32 v185, s96, v185
v_max_f32 v186, s96, v186
v_max_f32 v187, s96, v187
v_mfma_f32_32x32x16_bf16 v[72:87], v[164:167], a[28:31], v[72:87]
v_fma_f32 v184, v188, s97, v184
v_fma_f32 v185, v189, s97, v185
v_fma_f32 v186, v190, s97, v186
v_fma_f32 v187, v191, s97, v187
s_waitcnt vmcnt(8) lgkmcnt(0)
ds_read_b64_tr_b16 v[160:161], v6 offset:10240
ds_read_b64_tr_b16 v[162:163], v6 offset:10752
s_add_u32 m0, s38, 8192
v_mfma_f32_32x32x16_bf16 v[24:39], v[152:155], a[32:35], v[24:39]
ds_read_b64_tr_b16 v[164:165], v7 offset:10240
buffer_load_dwordx4 v2, s[12:15], s50 offen lds
v_add_f32 v184, s98, v184
v_add_f32 v185, s98, v185
v_mfma_f32_32x32x16_bf16 v[40:55], v[152:155], a[36:39], v[40:55]
ds_read_b64_tr_b16 v[166:167], v7 offset:10752
buffer_load_dwordx4 v3, s[12:15], s50 offen offset:1024 lds
v_add_f32 v186, s98, v186
v_add_f32 v187, s98, v187
v_cvt_pk_bf16_f32 v194, v184, v185
v_cvt_pk_bf16_f32 v195, v186, v187
v_mfma_f32_32x32x16_bf16 v[56:71], v[156:159], a[32:35], v[56:71]
s_add_u32 s93, s100, 4294967288
s_cmp_lt_u32 s93, 9
s_cselect_b32 s96, 0xff800000, 0
s_cselect_b32 s97, 0, 1.0
s_cselect_b32 s98, 0, 0x358637bd
v_mul_f32 v176, v92, v14
v_mul_f32 v177, v93, v14
v_mul_f32 v178, v94, v14
v_mul_f32 v179, v95, v14
v_mfma_f32_32x32x16_bf16 v[72:87], v[156:159], a[36:39], v[72:87]
v_mul_f32 v180, 0x3fb8aa3b, v176
v_mul_f32 v181, 0x3fb8aa3b, v177
v_mul_f32 v182, 0x3fb8aa3b, v178
s_waitcnt vmcnt(8) lgkmcnt(0)
ds_read_b64_tr_b16 v[152:153], v6 offset:0
ds_read_b64_tr_b16 v[154:155], v6 offset:512
s_add_u32 m0, s38, 10240
v_mfma_f32_32x32x16_bf16 v[24:39], v[160:163], a[40:43], v[24:39]
ds_read_b64_tr_b16 v[156:157], v7 offset:0
buffer_load_dwordx4 v2, s[12:15], s51 offen lds
v_mul_f32 v183, 0x3fb8aa3b, v179
v_min_f32 v180, 0, v180
v_mfma_f32_32x32x16_bf16 v[40:55], v[160:163], a[44:47], v[40:55]
ds_read_b64_tr_b16 v[158:159], v7 offset:512
buffer_load_dwordx4 v3, s[12:15], s51 offen offset:1024 lds
v_min_f32 v181, 0, v181
v_min_f32 v182, 0, v182
v_min_f32 v183, 0, v183
v_mfma_f32_32x32x16_bf16 v[56:71], v[164:167], a[40:43], v[56:71]
v_exp_f32 v180, v180
v_exp_f32 v181, v181
v_exp_f32 v182, v182
v_exp_f32 v183, v183
v_mfma_f32_32x32x16_bf16 v[72:87], v[164:167], a[44:47], v[72:87]
v_max_f32 v176, s96, v176
v_max_f32 v177, s96, v177
v_max_f32 v178, s96, v178
s_waitcnt vmcnt(8) lgkmcnt(0)
ds_read_b64_tr_b16 v[160:161], v6 offset:2048
ds_read_b64_tr_b16 v[162:163], v6 offset:2560
s_add_u32 m0, s38, 0
v_mfma_f32_32x32x16_bf16 v[24:39], v[152:155], a[48:51], v[24:39]
ds_read_b64_tr_b16 v[164:165], v7 offset:2048
buffer_load_dwordx4 v2, s[12:15], s52 offen lds
v_max_f32 v179, s96, v179
v_fma_f32 v176, v180, s97, v176
v_fma_f32 v177, v181, s97, v177
v_mfma_f32_32x32x16_bf16 v[40:55], v[152:155], a[52:55], v[40:55]
ds_read_b64_tr_b16 v[166:167], v7 offset:2560
buffer_load_dwordx4 v3, s[12:15], s52 offen offset:1024 lds
v_fma_f32 v178, v182, s97, v178
v_fma_f32 v179, v183, s97, v179
v_add_f32 v176, s98, v176
v_mfma_f32_32x32x16_bf16 v[56:71], v[156:159], a[48:51], v[56:71]
v_add_f32 v177, s98, v177
v_add_f32 v178, s98, v178
v_add_f32 v179, s98, v179
v_cvt_pk_bf16_f32 v196, v176, v177
v_cvt_pk_bf16_f32 v197, v178, v179
v_mul_f32 v184, v108, v15
v_mul_f32 v185, v109, v15
v_mfma_f32_32x32x16_bf16 v[72:87], v[156:159], a[52:55], v[72:87]
v_mul_f32 v186, v110, v15
v_mul_f32 v187, v111, v15
v_mul_f32 v188, 0x3fb8aa3b, v184
v_mul_f32 v189, 0x3fb8aa3b, v185
s_waitcnt vmcnt(8) lgkmcnt(0)
ds_read_b64_tr_b16 v[152:153], v6 offset:4096
ds_read_b64_tr_b16 v[154:155], v6 offset:4608
s_add_u32 m0, s38, 2048
v_mfma_f32_32x32x16_bf16 v[24:39], v[160:163], a[56:59], v[24:39]
ds_read_b64_tr_b16 v[156:157], v7 offset:4096
buffer_load_dwordx4 v2, s[12:15], s53 offen lds
v_mul_f32 v190, 0x3fb8aa3b, v186
v_mul_f32 v191, 0x3fb8aa3b, v187
v_mfma_f32_32x32x16_bf16 v[40:55], v[160:163], a[60:63], v[40:55]
ds_read_b64_tr_b16 v[158:159], v7 offset:4608
buffer_load_dwordx4 v3, s[12:15], s53 offen offset:1024 lds
v_min_f32 v188, 0, v188
v_min_f32 v189, 0, v189
v_min_f32 v190, 0, v190
v_mfma_f32_32x32x16_bf16 v[56:71], v[164:167], a[56:59], v[56:71]
v_min_f32 v191, 0, v191
v_exp_f32 v188, v188
v_exp_f32 v189, v189
v_exp_f32 v190, v190
v_mfma_f32_32x32x16_bf16 v[72:87], v[164:167], a[60:63], v[72:87]
v_exp_f32 v191, v191
v_max_f32 v184, s96, v184
v_max_f32 v185, s96, v185
s_waitcnt vmcnt(8) lgkmcnt(0)
ds_read_b64_tr_b16 v[160:161], v6 offset:6144
ds_read_b64_tr_b16 v[162:163], v6 offset:6656
s_add_u32 m0, s38, 4096
v_mfma_f32_32x32x16_bf16 v[24:39], v[152:155], a[64:67], v[24:39]
ds_read_b64_tr_b16 v[164:165], v7 offset:6144
buffer_load_dwordx4 v2, s[12:15], s54 offen lds
v_max_f32 v186, s96, v186
v_max_f32 v187, s96, v187
v_mfma_f32_32x32x16_bf16 v[40:55], v[152:155], a[68:71], v[40:55]
ds_read_b64_tr_b16 v[166:167], v7 offset:6656
buffer_load_dwordx4 v3, s[12:15], s54 offen offset:1024 lds
v_fma_f32 v184, v188, s97, v184
v_fma_f32 v185, v189, s97, v185
v_fma_f32 v186, v190, s97, v186
v_fma_f32 v187, v191, s97, v187
v_mfma_f32_32x32x16_bf16 v[56:71], v[156:159], a[64:67], v[56:71]
v_add_f32 v184, s98, v184
v_add_f32 v185, s98, v185
v_add_f32 v186, s98, v186
v_add_f32 v187, s98, v187
v_cvt_pk_bf16_f32 v198, v184, v185
v_cvt_pk_bf16_f32 v199, v186, v187
v_mfma_f32_32x32x16_bf16 v[72:87], v[156:159], a[68:71], v[72:87]
s_add_u32 s93, s100, 4294967289
s_cmp_lt_u32 s93, 9
s_cselect_b32 s96, 0xff800000, 0
s_cselect_b32 s97, 0, 1.0
s_cselect_b32 s98, 0, 0x358637bd
v_mul_f32 v176, v96, v14
s_waitcnt vmcnt(8) lgkmcnt(0)
ds_read_b64_tr_b16 v[152:153], v6 offset:8192
ds_read_b64_tr_b16 v[154:155], v6 offset:8704
s_add_u32 m0, s38, 6144
v_mfma_f32_32x32x16_bf16 v[24:39], v[160:163], a[72:75], v[24:39]
ds_read_b64_tr_b16 v[156:157], v7 offset:8192
buffer_load_dwordx4 v2, s[12:15], s55 offen lds
v_mul_f32 v177, v97, v14
v_mul_f32 v178, v98, v14
v_mfma_f32_32x32x16_bf16 v[40:55], v[160:163], a[76:79], v[40:55]
ds_read_b64_tr_b16 v[158:159], v7 offset:8704
buffer_load_dwordx4 v3, s[12:15], s55 offen offset:1024 lds
v_mul_f32 v179, v99, v14
v_mul_f32 v180, 0x3fb8aa3b, v176
v_mul_f32 v181, 0x3fb8aa3b, v177
v_mul_f32 v182, 0x3fb8aa3b, v178
v_mfma_f32_32x32x16_bf16 v[56:71], v[164:167], a[72:75], v[56:71]
v_mul_f32 v183, 0x3fb8aa3b, v179
v_min_f32 v180, 0, v180
v_min_f32 v181, 0, v181
v_min_f32 v182, 0, v182
v_min_f32 v183, 0, v183
v_exp_f32 v180, v180
v_mfma_f32_32x32x16_bf16 v[72:87], v[164:167], a[76:79], v[72:87]
v_exp_f32 v181, v181
v_exp_f32 v182, v182
s_waitcnt vmcnt(8) lgkmcnt(0)
ds_read_b64_tr_b16 v[160:161], v6 offset:10240
ds_read_b64_tr_b16 v[162:163], v6 offset:10752
s_add_u32 m0, s38, 8192
v_mfma_f32_32x32x16_bf16 v[24:39], v[152:155], a[80:83], v[24:39]
ds_read_b64_tr_b16 v[164:165], v7 offset:10240
buffer_load_dwordx4 v2, s[12:15], s56 offen lds
v_exp_f32 v183, v183
v_mfma_f32_32x32x16_bf16 v[40:55], v[152:155], a[84:87], v[40:55]
ds_read_b64_tr_b16 v[166:167], v7 offset:10752
buffer_load_dwordx4 v3, s[12:15], s56 offen offset:1024 lds
v_max_f32 v176, s96, v176
v_max_f32 v177, s96, v177
v_max_f32 v178, s96, v178
v_mfma_f32_32x32x16_bf16 v[56:71], v[156:159], a[80:83], v[56:71]
v_max_f32 v179, s96, v179
v_fma_f32 v176, v180, s97, v176
v_fma_f32 v177, v181, s97, v177
v_fma_f32 v178, v182, s97, v178
v_fma_f32 v179, v183, s97, v179
v_add_f32 v176, s98, v176
v_add_f32 v177, s98, v177
v_mfma_f32_32x32x16_bf16 v[72:87], v[156:159], a[84:87], v[72:87]
v_add_f32 v178, s98, v178
v_add_f32 v179, s98, v179
v_cvt_pk_bf16_f32 v200, v176, v177
v_cvt_pk_bf16_f32 v201, v178, v179
s_waitcnt vmcnt(8) lgkmcnt(0)
ds_read_b64_tr_b16 v[152:153], v6 offset:0
ds_read_b64_tr_b16 v[154:155], v6 offset:512
s_add_u32 m0, s38, 10240
v_mfma_f32_32x32x16_bf16 v[24:39], v[160:163], a[88:91], v[24:39]
ds_read_b64_tr_b16 v[156:157], v7 offset:0
buffer_load_dwordx4 v2, s[12:15], s57 offen lds
v_mul_f32 v184, v112, v15
v_mul_f32 v185, v113, v15
v_mfma_f32_32x32x16_bf16 v[40:55], v[160:163], a[92:95], v[40:55]
ds_read_b64_tr_b16 v[158:159], v7 offset:512
buffer_load_dwordx4 v3, s[12:15], s57 offen offset:1024 lds
v_mul_f32 v186, v114, v15
v_mul_f32 v187, v115, v15
v_mul_f32 v188, 0x3fb8aa3b, v184
v_mfma_f32_32x32x16_bf16 v[56:71], v[164:167], a[88:91], v[56:71]
v_mul_f32 v189, 0x3fb8aa3b, v185
v_mul_f32 v190, 0x3fb8aa3b, v186
v_mul_f32 v191, 0x3fb8aa3b, v187
v_min_f32 v188, 0, v188
v_min_f32 v189, 0, v189
v_min_f32 v190, 0, v190
v_min_f32 v191, 0, v191
v_mfma_f32_32x32x16_bf16 v[72:87], v[164:167], a[92:95], v[72:87]
v_exp_f32 v188, v188
v_exp_f32 v189, v189
s_waitcnt vmcnt(8) lgkmcnt(0)
ds_read_b64_tr_b16 v[160:161], v6 offset:2048
ds_read_b64_tr_b16 v[162:163], v6 offset:2560
s_add_u32 m0, s38, 0
v_mfma_f32_32x32x16_bf16 v[24:39], v[152:155], a[96:99], v[24:39]
ds_read_b64_tr_b16 v[164:165], v7 offset:2048
buffer_load_dwordx4 v2, s[12:15], s58 offen lds
v_exp_f32 v190, v190
v_mfma_f32_32x32x16_bf16 v[40:55], v[152:155], a[100:103], v[40:55]
ds_read_b64_tr_b16 v[166:167], v7 offset:2560
buffer_load_dwordx4 v3, s[12:15], s58 offen offset:1024 lds
v_exp_f32 v191, v191
v_max_f32 v184, s96, v184
v_max_f32 v185, s96, v185
v_mfma_f32_32x32x16_bf16 v[56:71], v[156:159], a[96:99], v[56:71]
v_max_f32 v186, s96, v186
v_max_f32 v187, s96, v187
v_fma_f32 v184, v188, s97, v184
v_fma_f32 v185, v189, s97, v185
v_fma_f32 v186, v190, s97, v186
v_fma_f32 v187, v191, s97, v187
v_mfma_f32_32x32x16_bf16 v[72:87], v[156:159], a[100:103], v[72:87]
v_add_f32 v184, s98, v184
v_add_f32 v185, s98, v185
v_add_f32 v186, s98, v186
v_add_f32 v187, s98, v187
s_waitcnt vmcnt(8) lgkmcnt(0)
ds_read_b64_tr_b16 v[152:153], v6 offset:4096
ds_read_b64_tr_b16 v[154:155], v6 offset:4608
s_add_u32 m0, s38, 2048
v_mfma_f32_32x32x16_bf16 v[24:39], v[160:163], a[104:107], v[24:39]
ds_read_b64_tr_b16 v[156:157], v7 offset:4096
buffer_load_dwordx4 v2, s[12:15], s59 offen lds
v_cvt_pk_bf16_f32 v202, v184, v185
v_cvt_pk_bf16_f32 v203, v186, v187
v_mfma_f32_32x32x16_bf16 v[40:55], v[160:163], a[108:111], v[40:55]
ds_read_b64_tr_b16 v[158:159], v7 offset:4608
buffer_load_dwordx4 v3, s[12:15], s59 offen offset:1024 lds
s_add_u32 s93, s100, 4294967290
s_cmp_lt_u32 s93, 9
s_cselect_b32 s96, 0xff800000, 0
s_cselect_b32 s97, 0, 1.0
s_cselect_b32 s98, 0, 0x358637bd
v_mul_f32 v176, v100, v14
v_mfma_f32_32x32x16_bf16 v[56:71], v[164:167], a[104:107], v[56:71]
v_mul_f32 v177, v101, v14
v_mul_f32 v178, v102, v14
v_mul_f32 v179, v103, v14
v_mul_f32 v180, 0x3fb8aa3b, v176
v_mul_f32 v181, 0x3fb8aa3b, v177
v_mul_f32 v182, 0x3fb8aa3b, v178
v_mul_f32 v183, 0x3fb8aa3b, v179
v_mfma_f32_32x32x16_bf16 v[72:87], v[164:167], a[108:111], v[72:87]
v_min_f32 v180, 0, v180
v_min_f32 v181, 0, v181
v_min_f32 v182, 0, v182
s_waitcnt vmcnt(8) lgkmcnt(0)
ds_read_b64_tr_b16 v[160:161], v6 offset:6144
ds_read_b64_tr_b16 v[162:163], v6 offset:6656
s_add_u32 m0, s38, 4096
v_mfma_f32_32x32x16_bf16 v[24:39], v[152:155], a[112:115], v[24:39]
ds_read_b64_tr_b16 v[164:165], v7 offset:6144
buffer_load_dwordx4 v2, s[12:15], s60 offen lds
v_min_f32 v183, 0, v183
v_exp_f32 v180, v180
v_mfma_f32_32x32x16_bf16 v[40:55], v[152:155], a[116:119], v[40:55]
ds_read_b64_tr_b16 v[166:167], v7 offset:6656
buffer_load_dwordx4 v3, s[12:15], s60 offen offset:1024 lds
v_exp_f32 v181, v181
v_mfma_f32_32x32x16_bf16 v[56:71], v[156:159], a[112:115], v[56:71]
v_exp_f32 v182, v182
v_exp_f32 v183, v183
v_max_f32 v176, s96, v176
v_max_f32 v177, s96, v177
v_max_f32 v178, s96, v178
v_max_f32 v179, s96, v179
v_mfma_f32_32x32x16_bf16 v[72:87], v[156:159], a[116:119], v[72:87]
v_fma_f32 v176, v180, s97, v176
v_fma_f32 v177, v181, s97, v177
v_fma_f32 v178, v182, s97, v178
s_waitcnt vmcnt(8) lgkmcnt(0)
ds_read_b64_tr_b16 v[152:153], v6 offset:8192
ds_read_b64_tr_b16 v[154:155], v6 offset:8704
s_add_u32 m0, s38, 6144
v_mfma_f32_32x32x16_bf16 v[24:39], v[160:163], a[120:123], v[24:39]
ds_read_b64_tr_b16 v[156:157], v7 offset:8192
buffer_load_dwordx4 v2, s[12:15], s61 offen lds
v_fma_f32 v179, v183, s97, v179
v_add_f32 v176, s98, v176
v_add_f32 v177, s98, v177
v_mfma_f32_32x32x16_bf16 v[40:55], v[160:163], a[124:127], v[40:55]
ds_read_b64_tr_b16 v[158:159], v7 offset:8704
buffer_load_dwordx4 v3, s[12:15], s61 offen offset:1024 lds
v_add_f32 v178, s98, v178
v_add_f32 v179, s98, v179
v_cvt_pk_bf16_f32 v204, v176, v177
v_mfma_f32_32x32x16_bf16 v[56:71], v[164:167], a[120:123], v[56:71]
v_cvt_pk_bf16_f32 v205, v178, v179
v_mul_f32 v184, v116, v15
v_mul_f32 v185, v117, v15
v_mul_f32 v186, v118, v15
v_mul_f32 v187, v119, v15
v_mul_f32 v188, 0x3fb8aa3b, v184
v_mul_f32 v189, 0x3fb8aa3b, v185
v_mfma_f32_32x32x16_bf16 v[72:87], v[164:167], a[124:127], v[72:87]
v_mul_f32 v190, 0x3fb8aa3b, v186
v_mul_f32 v191, 0x3fb8aa3b, v187
v_min_f32 v188, 0, v188
v_min_f32 v189, 0, v189
s_waitcnt vmcnt(8) lgkmcnt(0)
ds_read_b64_tr_b16 v[160:161], v6 offset:10240
ds_read_b64_tr_b16 v[162:163], v6 offset:10752
s_add_u32 m0, s38, 8192
v_mfma_f32_32x32x16_bf16 v[24:39], v[152:155], a[128:131], v[24:39]
ds_read_b64_tr_b16 v[164:165], v7 offset:10240
buffer_load_dwordx4 v2, s[12:15], s62 offen lds
v_min_f32 v190, 0, v190
v_min_f32 v191, 0, v191
v_mfma_f32_32x32x16_bf16 v[40:55], v[152:155], a[132:135], v[40:55]
ds_read_b64_tr_b16 v[166:167], v7 offset:10752
buffer_load_dwordx4 v3, s[12:15], s62 offen offset:1024 lds
v_exp_f32 v188, v188
v_exp_f32 v189, v189
v_mfma_f32_32x32x16_bf16 v[56:71], v[156:159], a[128:131], v[56:71]
v_exp_f32 v190, v190
v_exp_f32 v191, v191
v_max_f32 v184, s96, v184
v_max_f32 v185, s96, v185
v_mfma_f32_32x32x16_bf16 v[72:87], v[156:159], a[132:135], v[72:87]
v_max_f32 v186, s96, v186
v_max_f32 v187, s96, v187
v_fma_f32 v184, v188, s97, v184
v_fma_f32 v185, v189, s97, v185
s_waitcnt vmcnt(8) lgkmcnt(0)
ds_read_b64_tr_b16 v[152:153], v6 offset:0
ds_read_b64_tr_b16 v[154:155], v6 offset:512
s_add_u32 m0, s38, 10240
v_mfma_f32_32x32x16_bf16 v[24:39], v[160:163], a[136:139], v[24:39]
ds_read_b64_tr_b16 v[156:157], v7 offset:0
buffer_load_dwordx4 v2, s[12:15], s63 offen lds
v_fma_f32 v186, v190, s97, v186
v_fma_f32 v187, v191, s97, v187
v_mfma_f32_32x32x16_bf16 v[40:55], v[160:163], a[140:143], v[40:55]
ds_read_b64_tr_b16 v[158:159], v7 offset:512
buffer_load_dwordx4 v3, s[12:15], s63 offen offset:1024 lds
v_add_f32 v184, s98, v184
v_add_f32 v185, s98, v185
v_add_f32 v186, s98, v186
v_add_f32 v187, s98, v187
v_mfma_f32_32x32x16_bf16 v[56:71], v[164:167], a[136:139], v[56:71]
v_cvt_pk_bf16_f32 v206, v184, v185
v_cvt_pk_bf16_f32 v207, v186, v187
s_add_u32 s93, s100, 4294967291
s_cmp_lt_u32 s93, 9
s_cselect_b32 s96, 0xff800000, 0
s_cselect_b32 s97, 0, 1.0
s_cselect_b32 s98, 0, 0x358637bd
v_mul_f32 v176, v120, v14
v_mul_f32 v177, v121, v14
v_mfma_f32_32x32x16_bf16 v[72:87], v[164:167], a[140:143], v[72:87]
v_mul_f32 v178, v122, v14
v_mul_f32 v179, v123, v14
v_mul_f32 v180, 0x3fb8aa3b, v176
s_waitcnt vmcnt(8) lgkmcnt(0)
ds_read_b64_tr_b16 v[160:161], v6 offset:2048
ds_read_b64_tr_b16 v[162:163], v6 offset:2560
s_add_u32 m0, s38, 0
v_mfma_f32_32x32x16_bf16 v[24:39], v[152:155], a[144:147], v[24:39]
ds_read_b64_tr_b16 v[164:165], v7 offset:2048
buffer_load_dwordx4 v2, s[12:15], s64 offen lds
v_mul_f32 v181, 0x3fb8aa3b, v177
v_mul_f32 v182, 0x3fb8aa3b, v178
v_mfma_f32_32x32x16_bf16 v[40:55], v[152:155], a[148:151], v[40:55]
ds_read_b64_tr_b16 v[166:167], v7 offset:2560
buffer_load_dwordx4 v3, s[12:15], s64 offen offset:1024 lds
v_mul_f32 v183, 0x3fb8aa3b, v179
v_min_f32 v180, 0, v180
v_min_f32 v181, 0, v181
v_min_f32 v182, 0, v182
v_mfma_f32_32x32x16_bf16 v[56:71], v[156:159], a[144:147], v[56:71]
v_min_f32 v183, 0, v183
v_exp_f32 v180, v180
v_exp_f32 v181, v181
v_exp_f32 v182, v182
v_mfma_f32_32x32x16_bf16 v[72:87], v[156:159], a[148:151], v[72:87]
v_exp_f32 v183, v183
v_max_f32 v176, s96, v176
s_waitcnt vmcnt(8) lgkmcnt(0)
ds_read_b64_tr_b16 v[152:153], v6 offset:4096
ds_read_b64_tr_b16 v[154:155], v6 offset:4608
s_add_u32 m0, s38, 2048
v_mfma_f32_32x32x16_bf16 v[24:39], v[160:163], a[152:155], v[24:39]
ds_read_b64_tr_b16 v[156:157], v7 offset:4096
buffer_load_dwordx4 v2, s[12:15], s65 offen lds
v_max_f32 v177, s96, v177
v_max_f32 v178, s96, v178
v_max_f32 v179, s96, v179
v_mfma_f32_32x32x16_bf16 v[40:55], v[160:163], a[156:159], v[40:55]
ds_read_b64_tr_b16 v[158:159], v7 offset:4608
buffer_load_dwordx4 v3, s[12:15], s65 offen offset:1024 lds
v_fma_f32 v176, v180, s97, v176
v_fma_f32 v177, v181, s97, v177
v_fma_f32 v178, v182, s97, v178
v_mfma_f32_32x32x16_bf16 v[56:71], v[164:167], a[152:155], v[56:71]
v_fma_f32 v179, v183, s97, v179
v_add_f32 v176, s98, v176
v_add_f32 v177, s98, v177
v_add_f32 v178, s98, v178
v_add_f32 v179, s98, v179
v_cvt_pk_bf16_f32 v208, v176, v177
v_cvt_pk_bf16_f32 v209, v178, v179
v_mfma_f32_32x32x16_bf16 v[72:87], v[164:167], a[156:159], v[72:87]
v_mul_f32 v184, v136, v15
v_mul_f32 v185, v137, v15
v_mul_f32 v186, v138, v15
v_mul_f32 v187, v139, v15
s_waitcnt vmcnt(8) lgkmcnt(0)
ds_read_b64_tr_b16 v[160:161], v6 offset:6144
ds_read_b64_tr_b16 v[162:163], v6 offset:6656
s_add_u32 m0, s38, 4096
v_mfma_f32_32x32x16_bf16 v[24:39], v[152:155], a[160:163], v[24:39]
ds_read_b64_tr_b16 v[164:165], v7 offset:6144
buffer_load_dwordx4 v2, s[12:15], s66 offen lds
v_mul_f32 v188, 0x3fb8aa3b, v184
v_mul_f32 v189, 0x3fb8aa3b, v185
v_mfma_f32_32x32x16_bf16 v[40:55], v[152:155], a[164:167], v[40:55]
ds_read_b64_tr_b16 v[166:167], v7 offset:6656
buffer_load_dwordx4 v3, s[12:15], s66 offen offset:1024 lds
v_mul_f32 v190, 0x3fb8aa3b, v186
v_mul_f32 v191, 0x3fb8aa3b, v187
v_min_f32 v188, 0, v188
v_mfma_f32_32x32x16_bf16 v[56:71], v[156:159], a[160:163], v[56:71]
v_min_f32 v189, 0, v189
v_min_f32 v190, 0, v190
v_min_f32 v191, 0, v191
v_exp_f32 v188, v188
v_exp_f32 v189, v189
v_mfma_f32_32x32x16_bf16 v[72:87], v[156:159], a[164:167], v[72:87]
v_exp_f32 v190, v190
v_exp_f32 v191, v191
s_waitcnt vmcnt(8) lgkmcnt(0)
ds_read_b64_tr_b16 v[152:153], v6 offset:8192
ds_read_b64_tr_b16 v[154:155], v6 offset:8704
s_add_u32 m0, s38, 6144
v_mfma_f32_32x32x16_bf16 v[24:39], v[160:163], a[168:171], v[24:39]
ds_read_b64_tr_b16 v[156:157], v7 offset:8192
buffer_load_dwordx4 v2, s[12:15], s67 offen lds
v_max_f32 v184, s96, v184
v_max_f32 v185, s96, v185
v_mfma_f32_32x32x16_bf16 v[40:55], v[160:163], a[172:175], v[40:55]
ds_read_b64_tr_b16 v[158:159], v7 offset:8704
buffer_load_dwordx4 v3, s[12:15], s67 offen offset:1024 lds
v_max_f32 v186, s96, v186
v_max_f32 v187, s96, v187
v_fma_f32 v184, v188, s97, v184
v_fma_f32 v185, v189, s97, v185
v_mfma_f32_32x32x16_bf16 v[56:71], v[164:167], a[168:171], v[56:71]
v_fma_f32 v186, v190, s97, v186
v_fma_f32 v187, v191, s97, v187
v_add_f32 v184, s98, v184
v_add_f32 v185, s98, v185
v_add_f32 v186, s98, v186
v_add_f32 v187, s98, v187
v_cvt_pk_bf16_f32 v210, v184, v185
v_mfma_f32_32x32x16_bf16 v[72:87], v[164:167], a[172:175], v[72:87]
v_cvt_pk_bf16_f32 v211, v186, v187
s_add_u32 s93, s100, 4294967292
s_cmp_lt_u32 s93, 9
s_cselect_b32 s96, 0xff800000, 0
s_cselect_b32 s97, 0, 1.0
s_cselect_b32 s98, 0, 0x358637bd
s_waitcnt vmcnt(8) lgkmcnt(0)
ds_read_b64_tr_b16 v[160:161], v6 offset:10240
ds_read_b64_tr_b16 v[162:163], v6 offset:10752
s_add_u32 m0, s38, 8192
v_mfma_f32_32x32x16_bf16 v[24:39], v[152:155], a[176:179], v[24:39]
ds_read_b64_tr_b16 v[164:165], v7 offset:10240
buffer_load_dwordx4 v2, s[12:15], s68 offen lds
v_mul_f32 v176, v124, v14
v_mfma_f32_32x32x16_bf16 v[40:55], v[152:155], a[180:183], v[40:55]
ds_read_b64_tr_b16 v[166:167], v7 offset:10752
buffer_load_dwordx4 v3, s[12:15], s68 offen offset:1024 lds
v_mul_f32 v177, v125, v14
v_mul_f32 v178, v126, v14
v_mul_f32 v179, v127, v14
v_mul_f32 v180, 0x3fb8aa3b, v176
v_mfma_f32_32x32x16_bf16 v[56:71], v[156:159], a[176:179], v[56:71]
v_mul_f32 v181, 0x3fb8aa3b, v177
v_mul_f32 v182, 0x3fb8aa3b, v178
v_mul_f32 v183, 0x3fb8aa3b, v179
v_min_f32 v180, 0, v180
v_min_f32 v181, 0, v181
v_min_f32 v182, 0, v182
v_min_f32 v183, 0, v183
v_mfma_f32_32x32x16_bf16 v[72:87], v[156:159], a[180:183], v[72:87]
v_exp_f32 v180, v180
v_exp_f32 v181, v181
s_waitcnt vmcnt(8) lgkmcnt(0)
ds_read_b64_tr_b16 v[152:153], v6 offset:0
ds_read_b64_tr_b16 v[154:155], v6 offset:512
s_add_u32 m0, s38, 10240
v_mfma_f32_32x32x16_bf16 v[24:39], v[160:163], a[184:187], v[24:39]
ds_read_b64_tr_b16 v[156:157], v7 offset:0
buffer_load_dwordx4 v2, s[12:15], s69 offen lds
v_exp_f32 v182, v182
v_mfma_f32_32x32x16_bf16 v[40:55], v[160:163], a[188:191], v[40:55]
ds_read_b64_tr_b16 v[158:159], v7 offset:512
buffer_load_dwordx4 v3, s[12:15], s69 offen offset:1024 lds
v_exp_f32 v183, v183
v_max_f32 v176, s96, v176
v_mfma_f32_32x32x16_bf16 v[56:71], v[164:167], a[184:187], v[56:71]
v_max_f32 v177, s96, v177
v_max_f32 v178, s96, v178
v_max_f32 v179, s96, v179
v_fma_f32 v176, v180, s97, v176
v_fma_f32 v177, v181, s97, v177
v_fma_f32 v178, v182, s97, v178
v_fma_f32 v179, v183, s97, v179
v_mfma_f32_32x32x16_bf16 v[72:87], v[164:167], a[188:191], v[72:87]
v_add_f32 v176, s98, v176
v_add_f32 v177, s98, v177
v_add_f32 v178, s98, v178
s_waitcnt vmcnt(8) lgkmcnt(0)
ds_read_b64_tr_b16 v[160:161], v6 offset:2048
ds_read_b64_tr_b16 v[162:163], v6 offset:2560
s_add_u32 m0, s38, 0
v_mfma_f32_32x32x16_bf16 v[24:39], v[152:155], a[192:195], v[24:39]
ds_read_b64_tr_b16 v[164:165], v7 offset:2048
buffer_load_dwordx4 v2, s[12:15], s70 offen lds
v_add_f32 v179, s98, v179
v_cvt_pk_bf16_f32 v212, v176, v177
v_cvt_pk_bf16_f32 v213, v178, v179
v_mfma_f32_32x32x16_bf16 v[40:55], v[152:155], a[196:199], v[40:55]
ds_read_b64_tr_b16 v[166:167], v7 offset:2560
buffer_load_dwordx4 v3, s[12:15], s70 offen offset:1024 lds
v_mul_f32 v184, v140, v15
v_mul_f32 v185, v141, v15
v_mul_f32 v186, v142, v15
v_mfma_f32_32x32x16_bf16 v[56:71], v[156:159], a[192:195], v[56:71]
v_mul_f32 v187, v143, v15
v_mul_f32 v188, 0x3fb8aa3b, v184
v_mul_f32 v189, 0x3fb8aa3b, v185
v_mul_f32 v190, 0x3fb8aa3b, v186
v_mul_f32 v191, 0x3fb8aa3b, v187
v_min_f32 v188, 0, v188
v_min_f32 v189, 0, v189
v_mfma_f32_32x32x16_bf16 v[72:87], v[156:159], a[196:199], v[72:87]
v_min_f32 v190, 0, v190
v_min_f32 v191, 0, v191
v_exp_f32 v188, v188
s_waitcnt vmcnt(8) lgkmcnt(0)
ds_read_b64_tr_b16 v[152:153], v6 offset:4096
ds_read_b64_tr_b16 v[154:155], v6 offset:4608
s_add_u32 m0, s38, 2048
v_mfma_f32_32x32x16_bf16 v[24:39], v[160:163], a[200:203], v[24:39]
ds_read_b64_tr_b16 v[156:157], v7 offset:4096
buffer_load_dwordx4 v2, s[12:15], s71 offen lds
v_exp_f32 v189, v189
v_mfma_f32_32x32x16_bf16 v[40:55], v[160:163], a[204:207], v[40:55]
ds_read_b64_tr_b16 v[158:159], v7 offset:4608
buffer_load_dwordx4 v3, s[12:15], s71 offen offset:1024 lds
v_exp_f32 v190, v190
v_exp_f32 v191, v191
v_mfma_f32_32x32x16_bf16 v[56:71], v[164:167], a[200:203], v[56:71]
v_max_f32 v184, s96, v184
v_max_f32 v185, s96, v185
v_max_f32 v186, s96, v186
v_max_f32 v187, s96, v187
v_fma_f32 v184, v188, s97, v184
v_fma_f32 v185, v189, s97, v185
v_mfma_f32_32x32x16_bf16 v[72:87], v[164:167], a[204:207], v[72:87]
v_fma_f32 v186, v190, s97, v186
v_fma_f32 v187, v191, s97, v187
v_add_f32 v184, s98, v184
v_add_f32 v185, s98, v185
s_waitcnt vmcnt(8) lgkmcnt(0)
ds_read_b64_tr_b16 v[160:161], v6 offset:6144
ds_read_b64_tr_b16 v[162:163], v6 offset:6656
s_add_u32 m0, s38, 4096
v_mfma_f32_32x32x16_bf16 v[24:39], v[152:155], a[208:211], v[24:39]
ds_read_b64_tr_b16 v[164:165], v7 offset:6144
buffer_load_dwordx4 v2, s[12:15], s72 offen lds
v_add_f32 v186, s98, v186
v_add_f32 v187, s98, v187
v_mfma_f32_32x32x16_bf16 v[40:55], v[152:155], a[212:215], v[40:55]
ds_read_b64_tr_b16 v[166:167], v7 offset:6656
buffer_load_dwordx4 v3, s[12:15], s72 offen offset:1024 lds
v_cvt_pk_bf16_f32 v214, v184, v185
v_cvt_pk_bf16_f32 v215, v186, v187
s_add_u32 s93, s100, 4294967293
s_cmp_lt_u32 s93, 9
s_cselect_b32 s96, 0xff800000, 0
s_cselect_b32 s97, 0, 1.0
s_cselect_b32 s98, 0, 0x358637bd
v_mfma_f32_32x32x16_bf16 v[56:71], v[156:159], a[208:211], v[56:71]
v_mul_f32 v176, v128, v14
v_mul_f32 v177, v129, v14
v_mul_f32 v178, v130, v14
v_mul_f32 v179, v131, v14
v_mul_f32 v180, 0x3fb8aa3b, v176
v_mul_f32 v181, 0x3fb8aa3b, v177
v_mfma_f32_32x32x16_bf16 v[72:87], v[156:159], a[212:215], v[72:87]
v_mul_f32 v182, 0x3fb8aa3b, v178
v_mul_f32 v183, 0x3fb8aa3b, v179
v_min_f32 v180, 0, v180
s_waitcnt vmcnt(8) lgkmcnt(0)
ds_read_b64_tr_b16 v[152:153], v6 offset:8192
ds_read_b64_tr_b16 v[154:155], v6 offset:8704
s_add_u32 m0, s38, 6144
v_mfma_f32_32x32x16_bf16 v[24:39], v[160:163], a[216:219], v[24:39]
ds_read_b64_tr_b16 v[156:157], v7 offset:8192
buffer_load_dwordx4 v2, s[12:15], s73 offen lds
v_min_f32 v181, 0, v181
v_min_f32 v182, 0, v182
v_mfma_f32_32x32x16_bf16 v[40:55], v[160:163], a[220:223], v[40:55]
ds_read_b64_tr_b16 v[158:159], v7 offset:8704
buffer_load_dwordx4 v3, s[12:15], s73 offen offset:1024 lds
v_min_f32 v183, 0, v183
v_exp_f32 v180, v180
v_mfma_f32_32x32x16_bf16 v[56:71], v[164:167], a[216:219], v[56:71]
v_exp_f32 v181, v181
v_exp_f32 v182, v182
v_exp_f32 v183, v183
v_max_f32 v176, s96, v176
v_max_f32 v177, s96, v177
v_mfma_f32_32x32x16_bf16 v[72:87], v[164:167], a[220:223], v[72:87]
v_max_f32 v178, s96, v178
v_max_f32 v179, s96, v179
v_fma_f32 v176, v180, s97, v176
s_waitcnt vmcnt(8) lgkmcnt(0)
ds_read_b64_tr_b16 v[160:161], v6 offset:10240
ds_read_b64_tr_b16 v[162:163], v6 offset:10752
s_add_u32 m0, s38, 8192
v_mfma_f32_32x32x16_bf16 v[24:39], v[152:155], a[224:227], v[24:39]
ds_read_b64_tr_b16 v[164:165], v7 offset:10240
buffer_load_dwordx4 v2, s[12:15], s74 offen lds
v_fma_f32 v177, v181, s97, v177
v_fma_f32 v178, v182, s97, v178
v_fma_f32 v179, v183, s97, v179
v_mfma_f32_32x32x16_bf16 v[40:55], v[152:155], a[228:231], v[40:55]
ds_read_b64_tr_b16 v[166:167], v7 offset:10752
buffer_load_dwordx4 v3, s[12:15], s74 offen offset:1024 lds
v_add_f32 v176, s98, v176
v_add_f32 v177, s98, v177
v_add_f32 v178, s98, v178
v_mfma_f32_32x32x16_bf16 v[56:71], v[156:159], a[224:227], v[56:71]
v_add_f32 v179, s98, v179
v_cvt_pk_bf16_f32 v216, v176, v177
v_cvt_pk_bf16_f32 v217, v178, v179
v_mul_f32 v184, v144, v15
v_mul_f32 v185, v145, v15
v_mul_f32 v186, v146, v15
v_mul_f32 v187, v147, v15
v_mfma_f32_32x32x16_bf16 v[72:87], v[156:159], a[228:231], v[72:87]
v_mul_f32 v188, 0x3fb8aa3b, v184
v_mul_f32 v189, 0x3fb8aa3b, v185
v_mul_f32 v190, 0x3fb8aa3b, v186
v_mul_f32 v191, 0x3fb8aa3b, v187
s_waitcnt vmcnt(8) lgkmcnt(0)
ds_read_b64_tr_b16 v[152:153], v6 offset:0
ds_read_b64_tr_b16 v[154:155], v6 offset:512
s_add_u32 m0, s38, 10240
v_mfma_f32_32x32x16_bf16 v[24:39], v[160:163], a[232:235], v[24:39]
ds_read_b64_tr_b16 v[156:157], v7 offset:0
buffer_load_dwordx4 v2, s[12:15], s75 offen lds
v_min_f32 v188, 0, v188
v_min_f32 v189, 0, v189
v_mfma_f32_32x32x16_bf16 v[40:55], v[160:163], a[236:239], v[40:55]
ds_read_b64_tr_b16 v[158:159], v7 offset:512
buffer_load_dwordx4 v3, s[12:15], s75 offen offset:1024 lds
v_min_f32 v190, 0, v190
v_min_f32 v191, 0, v191
v_exp_f32 v188, v188
v_mfma_f32_32x32x16_bf16 v[56:71], v[164:167], a[232:235], v[56:71]
v_exp_f32 v189, v189
v_exp_f32 v190, v190
v_exp_f32 v191, v191
v_mfma_f32_32x32x16_bf16 v[72:87], v[164:167], a[236:239], v[72:87]
v_max_f32 v184, s96, v184
v_max_f32 v185, s96, v185
v_max_f32 v186, s96, v186
v_max_f32 v187, s96, v187
s_waitcnt vmcnt(8) lgkmcnt(0)
ds_read_b64_tr_b16 v[160:161], v6 offset:2048
ds_read_b64_tr_b16 v[162:163], v6 offset:2560
s_add_u32 m0, s38, 0
v_mfma_f32_32x32x16_bf16 v[24:39], v[152:155], a[240:243], v[24:39]
ds_read_b64_tr_b16 v[164:165], v7 offset:2048
buffer_load_dwordx4 v4, s[16:19], s40 offen lds
v_fma_f32 v184, v188, s97, v184
v_fma_f32 v185, v189, s97, v185
v_mfma_f32_32x32x16_bf16 v[40:55], v[152:155], a[244:247], v[40:55]
ds_read_b64_tr_b16 v[166:167], v7 offset:2560
buffer_load_dwordx4 v5, s[16:19], s40 offen offset:1024 lds
v_fma_f32 v186, v190, s97, v186
v_fma_f32 v187, v191, s97, v187
v_add_f32 v184, s98, v184
v_add_f32 v185, s98, v185
v_mfma_f32_32x32x16_bf16 v[56:71], v[156:159], a[240:243], v[56:71]
v_add_f32 v186, s98, v186
v_add_f32 v187, s98, v187
v_cvt_pk_bf16_f32 v218, v184, v185
v_cvt_pk_bf16_f32 v219, v186, v187
s_add_u32 s93, s100, 4294967294
s_cmp_lt_u32 s93, 9
s_cselect_b32 s96, 0xff800000, 0
s_cselect_b32 s97, 0, 1.0
s_cselect_b32 s98, 0, 0x358637bd
v_mfma_f32_32x32x16_bf16 v[72:87], v[156:159], a[244:247], v[72:87]
v_mul_f32 v176, v132, v14
v_mul_f32 v177, v133, v14
v_mul_f32 v178, v134, v14
s_waitcnt vmcnt(8) lgkmcnt(0)
ds_read_b64_tr_b16 v[152:153], v6 offset:4096
ds_read_b64_tr_b16 v[154:155], v6 offset:4608
s_add_u32 m0, s38, 2048
v_mfma_f32_32x32x16_bf16 v[24:39], v[160:163], a[248:251], v[24:39]
ds_read_b64_tr_b16 v[156:157], v7 offset:4096
buffer_load_dwordx4 v4, s[16:19], s41 offen lds
v_mul_f32 v179, v135, v14
v_mul_f32 v180, 0x3fb8aa3b, v176
v_mfma_f32_32x32x16_bf16 v[40:55], v[160:163], a[252:255], v[40:55]
ds_read_b64_tr_b16 v[158:159], v7 offset:4608
buffer_load_dwordx4 v5, s[16:19], s41 offen offset:1024 lds
v_mul_f32 v181, 0x3fb8aa3b, v177
v_mul_f32 v182, 0x3fb8aa3b, v178
v_mul_f32 v183, 0x3fb8aa3b, v179
v_min_f32 v180, 0, v180
v_mfma_f32_32x32x16_bf16 v[56:71], v[164:167], a[248:251], v[56:71]
v_min_f32 v181, 0, v181
v_min_f32 v182, 0, v182
v_min_f32 v183, 0, v183
v_exp_f32 v180, v180
v_exp_f32 v181, v181
v_mfma_f32_32x32x16_bf16 v[72:87], v[164:167], a[252:255], v[72:87]
v_exp_f32 v182, v182
v_exp_f32 v183, v183
s_waitcnt vmcnt(8) lgkmcnt(0)
ds_read_b64_tr_b16 v[160:161], v6 offset:6144
ds_read_b64_tr_b16 v[162:163], v6 offset:6656
s_add_u32 m0, s38, 4096
v_mfma_f32_32x32x16_bf16 v[24:39], v[152:155], v[224:227], v[24:39]
ds_read_b64_tr_b16 v[164:165], v7 offset:6144
buffer_load_dwordx4 v4, s[16:19], s42 offen lds
v_max_f32 v176, s96, v176
v_max_f32 v177, s96, v177
v_mfma_f32_32x32x16_bf16 v[40:55], v[152:155], v[228:231], v[40:55]
ds_read_b64_tr_b16 v[166:167], v7 offset:6656
buffer_load_dwordx4 v5, s[16:19], s42 offen offset:1024 lds
v_max_f32 v178, s96, v178
v_max_f32 v179, s96, v179
v_fma_f32 v176, v180, s97, v176
v_mfma_f32_32x32x16_bf16 v[56:71], v[156:159], v[224:227], v[56:71]
v_fma_f32 v177, v181, s97, v177
v_fma_f32 v178, v182, s97, v178
v_fma_f32 v179, v183, s97, v179
v_add_f32 v176, s98, v176
v_add_f32 v177, s98, v177
v_add_f32 v178, s98, v178
v_add_f32 v179, s98, v179
v_mfma_f32_32x32x16_bf16 v[72:87], v[156:159], v[228:231], v[72:87]
v_cvt_pk_bf16_f32 v220, v176, v177
v_cvt_pk_bf16_f32 v221, v178, v179
v_mul_f32 v184, v148, v15
v_mul_f32 v185, v149, v15
s_waitcnt vmcnt(8) lgkmcnt(0)
ds_read_b64_tr_b16 v[152:153], v6 offset:8192
ds_read_b64_tr_b16 v[154:155], v6 offset:8704
s_add_u32 m0, s38, 6144
v_mfma_f32_32x32x16_bf16 v[24:39], v[160:163], v[232:235], v[24:39]
ds_read_b64_tr_b16 v[156:157], v7 offset:8192
buffer_load_dwordx4 v4, s[16:19], s43 offen lds
v_mul_f32 v186, v150, v15
v_mul_f32 v187, v151, v15
v_mfma_f32_32x32x16_bf16 v[40:55], v[160:163], v[236:239], v[40:55]
ds_read_b64_tr_b16 v[158:159], v7 offset:8704
buffer_load_dwordx4 v5, s[16:19], s43 offen offset:1024 lds
v_mul_f32 v188, 0x3fb8aa3b, v184
v_mul_f32 v189, 0x3fb8aa3b, v185
v_mul_f32 v190, 0x3fb8aa3b, v186
v_mfma_f32_32x32x16_bf16 v[56:71], v[164:167], v[232:235], v[56:71]
v_mul_f32 v191, 0x3fb8aa3b, v187
v_min_f32 v188, 0, v188
v_min_f32 v189, 0, v189
v_min_f32 v190, 0, v190
v_min_f32 v191, 0, v191
v_exp_f32 v188, v188
v_mfma_f32_32x32x16_bf16 v[72:87], v[164:167], v[236:239], v[72:87]
v_exp_f32 v189, v189
v_exp_f32 v190, v190
s_waitcnt vmcnt(8) lgkmcnt(0)
ds_read_b64_tr_b16 v[160:161], v6 offset:10240
ds_read_b64_tr_b16 v[162:163], v6 offset:10752
s_add_u32 m0, s38, 8192
v_mfma_f32_32x32x16_bf16 v[24:39], v[152:155], v[240:243], v[24:39]
ds_read_b64_tr_b16 v[164:165], v7 offset:10240
buffer_load_dwordx4 v4, s[16:19], s44 offen lds
v_exp_f32 v191, v191
v_mfma_f32_32x32x16_bf16 v[40:55], v[152:155], v[244:247], v[40:55]
ds_read_b64_tr_b16 v[166:167], v7 offset:10752
buffer_load_dwordx4 v5, s[16:19], s44 offen offset:1024 lds
v_max_f32 v184, s96, v184
v_max_f32 v185, s96, v185
v_max_f32 v186, s96, v186
v_max_f32 v187, s96, v187
v_mfma_f32_32x32x16_bf16 v[56:71], v[156:159], v[240:243], v[56:71]
v_fma_f32 v184, v188, s97, v184
v_fma_f32 v185, v189, s97, v185
v_fma_f32 v186, v190, s97, v186
v_fma_f32 v187, v191, s97, v187
v_add_f32 v184, s98, v184
v_add_f32 v185, s98, v185
v_add_f32 v186, s98, v186
v_mfma_f32_32x32x16_bf16 v[72:87], v[156:159], v[244:247], v[72:87]
v_add_f32 v187, s98, v187
v_cvt_pk_bf16_f32 v222, v184, v185
v_cvt_pk_bf16_f32 v223, v186, v187
s_waitcnt vmcnt(8) lgkmcnt(0)
ds_read_b64_tr_b16 v[152:153], v6 offset:0
ds_read_b64_tr_b16 v[154:155], v6 offset:512
s_add_u32 m0, s38, 10240
v_mfma_f32_32x32x16_bf16 v[88:103], v[160:163], v[248:251], v[24:39]
ds_read_b64_tr_b16 v[156:157], v7 offset:0
buffer_load_dwordx4 v4, s[16:19], s45 offen lds
v_mfma_f32_32x32x16_bf16 v[104:119], v[160:163], v[252:255], v[40:55]
ds_read_b64_tr_b16 v[158:159], v7 offset:512
buffer_load_dwordx4 v5, s[16:19], s45 offen offset:1024 lds
v_mfma_f32_32x32x16_bf16 v[120:135], v[164:167], v[248:251], v[56:71]
v_mfma_f32_32x32x16_bf16 v[136:151], v[164:167], v[252:255], v[72:87]
s_add_u32 s92, s100, 0
s_lshl_b32 s93, s92, 4
s_cmp_lt_u32 s92, 27
s_cselect_b32 s99, s93, 0x40000
v_add_u32 v21, s99, v16
ds_write_b64 v21, v[192:193] offset:0
ds_write_b64 v21, v[194:195] offset:14592
s_add_u32 s92, s100, 1
s_lshl_b32 s93, s92, 4
s_cmp_lt_u32 s92, 27
s_cselect_b32 s99, s93, 0x40000
v_add_u32 v22, s99, v16
ds_write_b64 v22, v[196:197] offset:0
ds_write_b64 v22, v[198:199] offset:14592
s_add_u32 s92, s100, 2
s_lshl_b32 s93, s92, 4
s_cmp_lt_u32 s92, 27
s_cselect_b32 s99, s93, 0x40000
v_add_u32 v21, s99, v16
ds_write_b64 v21, v[200:201] offset:0
ds_write_b64 v21, v[202:203] offset:14592
s_add_u32 s92, s100, 3
s_lshl_b32 s93, s92, 4
s_cmp_lt_u32 s92, 27
s_cselect_b32 s99, s93, 0x40000
v_add_u32 v22, s99, v16
ds_write_b64 v22, v[204:205] offset:0
ds_write_b64 v22, v[206:207] offset:14592
s_add_u32 s92, s100, 4
s_lshl_b32 s93, s92, 4
s_cmp_lt_u32 s92, 27
s_cselect_b32 s99, s93, 0x40000
v_add_u32 v21, s99, v16
ds_write_b64 v21, v[208:209] offset:0
ds_write_b64 v21, v[210:211] offset:14592
s_add_u32 s92, s100, 5
s_lshl_b32 s93, s92, 4
s_cmp_lt_u32 s92, 27
s_cselect_b32 s99, s93, 0x40000
v_add_u32 v22, s99, v16
ds_write_b64 v22, v[212:213] offset:0
ds_write_b64 v22, v[214:215] offset:14592
s_add_u32 s92, s100, 6
s_lshl_b32 s93, s92, 4
s_cmp_lt_u32 s92, 27
s_cselect_b32 s99, s93, 0x40000
v_add_u32 v21, s99, v16
ds_write_b64 v21, v[216:217] offset:0
ds_write_b64 v21, v[218:219] offset:14592
s_add_u32 s92, s100, 7
s_lshl_b32 s93, s92, 4
s_cmp_lt_u32 s92, 27
s_cselect_b32 s99, s93, 0x40000
v_add_u32 v22, s99, v16
ds_write_b64 v22, v[220:221] offset:0
ds_write_b64 v22, v[222:223] offset:14592
s_lshl_b32 s92, s5, 13
s_add_u32 s92, s92, 49152
v_add_u32 v16, s92, v17
s_mov_b32 s12, s16
s_mov_b32 s13, s17
s_mov_b32 s14, s18
v_mov_b32 v2, v4
v_mov_b32 v3, v5
s_mov_b32 s95, 8
s_mov_b32 s16, s34
s_mov_b32 s17, s35
s_mov_b32 s18, 5308416
s_mov_b32 s19, 0x20000
s_mul_i32 s92, s4, 1152
s_lshl_b32 s93, s95, 7
s_add_u32 s92, s92, s93
s_mul_i32 s93, s5, 1327104
s_add_u32 s92, s92, s93
v_mul_u32_u24 v4, 9216, v18
v_add3_u32 v4, v4, v19, s92
v_add_u32 v5, 72704, v4
s_sub_u32 s92, s33, s38
v_add_u32 v14, s92, v8
v_add_u32 v15, s92, v9
v_readfirstlane_b32 s39, v174
s_mov_b32 s94, 0
L_nz:
s_cmp_lg_u32 s39, 0
s_cbranch_scc1 L_nz_ok
s_add_u32 s94, s94, 1
s_cmp_gt_u32 s94, 20000
s_cbranch_scc1 L_nz_ok
v_mov_b32 v21, 0
buffer_load_dword v174, v21, s[24:27], 0 offen sc1
s_waitcnt vmcnt(0)
v_readfirstlane_b32 s39, v174
s_branch L_nz
L_nz_ok:
s_mov_b32 s24, s89
s_mov_b32 s25, s90
s_mov_b32 s26, 2359296
s_add_u32 m0, s33, 32768
s_nop 0
buffer_load_dwordx4 v2, s[12:15], s46 offen lds
buffer_load_dwordx4 v3, s[12:15], s46 offen offset:1024 lds
s_waitcnt lgkmcnt(0)
s_barrier
s_and_b32 s92, s5, 1
s_mul_i32 s93, s5, 36
s_lshl_b32 s94, s92, 2
s_sub_u32 s93, s93, s94
s_add_u32 s93, s93, 122880
v_lshrrev_b32 v21, 5, v1
v_lshlrev_b32 v21, 3, v21
v_bfe_u32 v22, v1, 2, 2
v_add_u32 v21, v21, v22
v_mul_u32_u24 v21, 456, v21
v_bfe_u32 v22, v1, 4, 1
v_lshl_add_u32 v21, v22, 5, v21
v_and_b32 v22, 3, v1
v_lshl_add_u32 v21, v22, 3, v21
v_add_u32 v21, s93, v21
ds_read_b64_tr_b16 v[176:177], v21 offset:0
ds_read_b64_tr_b16 v[192:193], v21 offset:144
ds_read_b64_tr_b16 v[178:179], v21 offset:1824
ds_read_b64_tr_b16 v[194:195], v21 offset:1968
ds_read_b64_tr_b16 v[180:181], v21 offset:7296
ds_read_b64_tr_b16 v[196:197], v21 offset:7440
ds_read_b64_tr_b16 v[182:183], v21 offset:9120
ds_read_b64_tr_b16 v[198:199], v21 offset:9264
ds_read_b64_tr_b16 v[184:185], v21 offset:14592
ds_read_b64_tr_b16 v[200:201], v21 offset:14736
ds_read_b64_tr_b16 v[186:187], v21 offset:16416
ds_read_b64_tr_b16 v[202:203], v21 offset:16560
ds_read_b64_tr_b16 v[188:189], v21 offset:21888
ds_read_b64_tr_b16 v[204:205], v21 offset:22032
ds_read_b64_tr_b16 v[190:191], v21 offset:23712
ds_read_b64_tr_b16 v[206:207], v21 offset:23856
s_add_u32 m0, s33, 34816
s_nop 0
buffer_load_dwordx4 v2, s[12:15], s47 offen lds
buffer_load_dwordx4 v3, s[12:15], s47 offen offset:1024 lds
v_mov_b32 v208, 0x3f803f80
v_mov_b32 v209, 0x3f803f80
v_mov_b32 v210, 0x3f803f80
v_mov_b32 v211, 0x3f803f80
s_lshl_b32 s94, s92, 1
v_and_b32 v21, 31, v1
v_subrev_u32 v22, s94, v21
v_cmp_eq_u32 vcc, 31, v21
v_mov_b32 v23, 18
s_nop 0
v_cndmask_b32 v22, v22, v23, vcc
s_mov_b64 s[96:97], vcc
v_cmp_gt_u32 vcc, 18, v22
s_or_b64 vcc, vcc, s[96:97]
v_lshrrev_b32 v23, 5, v1
v_mul_u32_u24 v23, 19, v23
v_add_u32 v22, v22, v23
v_lshlrev_b32 v22, 4, v22
v_mov_b32 v23, 0x7f000000
v_cndmask_b32 v22, v23, v22, vcc
s_add_u32 m0, s33, 36864
s_nop 0
buffer_load_dwordx4 v2, s[12:15], s48 offen lds
buffer_load_dwordx4 v3, s[12:15], s48 offen offset:1024 lds
s_lshl_b32 s93, s4, 2
s_add_u32 s93, s93, s5
s_lshl_b32 s95, s93, 5
s_add_u32 s95, s95, s3
s_lshl_b32 s93, s95, 11
s_add_u32 s93, s93, 19922944
s_lshl_b32 s95, s95, 7
s_add_u32 s95, s95, 22085632
s_waitcnt lgkmcnt(0)
v_mfma_f32_32x32x16_bf16 v[24:39], v[176:179], v[192:195], 0
v_mfma_f32_32x32x16_bf16 v[40:55], v[176:179], v[208:211], 0
v_mfma_f32_32x32x16_bf16 v[24:39], v[180:183], v[196:199], v[24:39]
v_mfma_f32_32x32x16_bf16 v[40:55], v[180:183], v[208:211], v[40:55]
s_add_u32 m0, s33, 38912
s_nop 0
buffer_load_dwordx4 v2, s[12:15], s49 offen lds
buffer_load_dwordx4 v3, s[12:15], s49 offen offset:1024 lds
v_mfma_f32_32x32x16_bf16 v[24:39], v[184:187], v[200:203], v[24:39]
v_mfma_f32_32x32x16_bf16 v[40:55], v[184:187], v[208:211], v[40:55]
v_mfma_f32_32x32x16_bf16 v[24:39], v[188:191], v[204:207], v[24:39]
v_mfma_f32_32x32x16_bf16 v[40:55], v[188:191], v[208:211], v[40:55]
s_add_u32 m0, s33, 0
s_nop 0
buffer_load_dwordx4 v2, s[12:15], s50 offen lds
buffer_load_dwordx4 v3, s[12:15], s50 offen offset:1024 lds
s_add_u32 m0, s33, 2048
s_nop 0
buffer_load_dwordx4 v2, s[12:15], s51 offen lds
buffer_load_dwordx4 v3, s[12:15], s51 offen offset:1024 lds
s_add_u32 m0, s33, 4096
s_nop 0
buffer_load_dwordx4 v2, s[12:15], s52 offen lds
buffer_load_dwordx4 v3, s[12:15], s52 offen offset:1024 lds
s_nop 15
s_nop 3
v_cndmask_b32_e64 v24, v24, v40, s[96:97]
v_cndmask_b32_e64 v25, v25, v41, s[96:97]
v_cndmask_b32_e64 v26, v26, v42, s[96:97]
v_cndmask_b32_e64 v27, v27, v43, s[96:97]
v_cndmask_b32_e64 v28, v28, v44, s[96:97]
v_cndmask_b32_e64 v29, v29, v45, s[96:97]
v_cndmask_b32_e64 v30, v30, v46, s[96:97]
v_cndmask_b32_e64 v31, v31, v47, s[96:97]
v_cndmask_b32_e64 v32, v32, v48, s[96:97]
v_cndmask_b32_e64 v33, v33, v49, s[96:97]
v_cndmask_b32_e64 v34, v34, v50, s[96:97]
v_cndmask_b32_e64 v35, v35, v51, s[96:97]
buffer_store_dwordx4 v[24:27], v22, s[20:23], s93 offen offset:0 sc1
buffer_store_dwordx4 v[28:31], v22, s[20:23], s93 offen offset:608 sc1
buffer_store_dwordx4 v[32:35], v22, s[20:23], s93 offen offset:1216 sc1
s_mov_b32 s99, s95
s_lshr_b32 s92, s3, 3
s_lshl_b32 s93, s4, 2
s_add_u32 s93, s93, s92
s_lshl_b32 s96, s93, 12
s_add_u32 s96, s96, 22085632
s_and_b32 s92, s3, 7
s_lshl_b32 s92, s92, 1
s_and_b32 s94, s5, 1
s_add_u32 s92, s92, s94
s_lshl_b32 s97, s93, 16
s_lshl_b32 s94, s92, 7
s_add_u32 s97, s97, s94
s_add_u32 s97, s97, 19922944
s_lshl_b32 s98, s93, 11
s_add_u32 s98, s98, s94
s_add_u32 s98, s98, 22020096
s_lshl_b32 s100, s93, 11
s_lshl_b32 s94, s92, 7
s_add_u32 s100, s100, s94
s_add_u32 s100, s100, 22216704
v_min_u32 v168, 31, v1
v_lshlrev_b32 v168, 7, v168
s_waitcnt vmcnt(25) lgkmcnt(0)
ds_read_b64_tr_b16 v[160:161], v6 offset:2048
ds_read_b64_tr_b16 v[162:163], v6 offset:2560
s_add_u32 m0, s38, 0
v_mfma_f32_32x32x16_bf16 v[24:39], v[152:155], a[0:3], 0
ds_read_b64_tr_b16 v[164:165], v7 offset:2048
buffer_load_dwordx4 v2, s[12:15], s53 offen lds
v_mul_f32 v176, v88, v10
v_mul_f32 v177, v89, v10
v_mfma_f32_32x32x16_bf16 v[40:55], v[152:155], a[4:7], 0
ds_read_b64_tr_b16 v[166:167], v7 offset:2560
buffer_load_dwordx4 v3, s[12:15], s53 offen offset:1024 lds
v_mul_f32 v178, v90, v10
v_mul_f32 v179, v91, v10
v_mfma_f32_32x32x16_bf16 v[56:71], v[156:159], a[0:3], 0
v_exp_f32 v176, v176
v_exp_f32 v177, v177
v_exp_f32 v178, v178
v_mfma_f32_32x32x16_bf16 v[72:87], v[156:159], a[4:7], 0
v_exp_f32 v179, v179
v_fma_f32 v176, v176, v12, v12
v_fma_f32 v177, v177, v12, v12
s_waitcnt vmcnt(25) lgkmcnt(0)
ds_read_b64_tr_b16 v[152:153], v6 offset:4096
ds_read_b64_tr_b16 v[154:155], v6 offset:4608
s_add_u32 m0, s38, 2048
v_mfma_f32_32x32x16_bf16 v[24:39], v[160:163], a[8:11], v[24:39]
ds_read_b64_tr_b16 v[156:157], v7 offset:4096
buffer_load_dwordx4 v2, s[12:15], s54 offen lds
v_fma_f32 v178, v178, v12, v12
v_fma_f32 v179, v179, v12, v12
v_mfma_f32_32x32x16_bf16 v[40:55], v[160:163], a[12:15], v[40:55]
ds_read_b64_tr_b16 v[158:159], v7 offset:4608
buffer_load_dwordx4 v3, s[12:15], s54 offen offset:1024 lds
v_rcp_f32 v176, v176
v_mfma_f32_32x32x16_bf16 v[56:71], v[164:167], a[8:11], v[56:71]
v_rcp_f32 v177, v177
v_rcp_f32 v178, v178
v_rcp_f32 v179, v179
v_mfma_f32_32x32x16_bf16 v[72:87], v[164:167], a[12:15], v[72:87]
v_mul_f32 v176, v88, v176
v_mul_f32 v177, v89, v177
v_mul_f32 v178, v90, v178
s_waitcnt vmcnt(25) lgkmcnt(0)
ds_read_b64_tr_b16 v[160:161], v6 offset:6144
ds_read_b64_tr_b16 v[162:163], v6 offset:6656
s_add_u32 m0, s38, 4096
v_mfma_f32_32x32x16_bf16 v[24:39], v[152:155], a[16:19], v[24:39]
ds_read_b64_tr_b16 v[164:165], v7 offset:6144
buffer_load_dwordx4 v2, s[12:15], s55 offen lds
v_mul_f32 v179, v91, v179
v_cvt_pk_bf16_f32 v192, v176, v177
v_mfma_f32_32x32x16_bf16 v[40:55], v[152:155], a[20:23], v[40:55]
ds_read_b64_tr_b16 v[166:167], v7 offset:6656
buffer_load_dwordx4 v3, s[12:15], s55 offen offset:1024 lds
v_cvt_pk_bf16_f32 v193, v178, v179
v_mul_f32 v180, v92, v10
v_mul_f32 v181, v93, v10
v_mfma_f32_32x32x16_bf16 v[56:71], v[156:159], a[16:19], v[56:71]
v_mul_f32 v182, v94, v10
v_mul_f32 v183, v95, v10
v_exp_f32 v180, v180
v_exp_f32 v181, v181
v_mfma_f32_32x32x16_bf16 v[72:87], v[156:159], a[20:23], v[72:87]
v_exp_f32 v182, v182
v_exp_f32 v183, v183
s_waitcnt vmcnt(25) lgkmcnt(0)
ds_read_b64_tr_b16 v[152:153], v6 offset:8192
ds_read_b64_tr_b16 v[154:155], v6 offset:8704
s_add_u32 m0, s38, 6144
v_mfma_f32_32x32x16_bf16 v[24:39], v[160:163], a[24:27], v[24:39]
ds_read_b64_tr_b16 v[156:157], v7 offset:8192
buffer_load_dwordx4 v2, s[12:15], s56 offen lds
v_fma_f32 v180, v180, v12, v12
v_mfma_f32_32x32x16_bf16 v[40:55], v[160:163], a[28:31], v[40:55]
ds_read_b64_tr_b16 v[158:159], v7 offset:8704
buffer_load_dwordx4 v3, s[12:15], s56 offen offset:1024 lds
v_fma_f32 v181, v181, v12, v12
v_fma_f32 v182, v182, v12, v12
v_fma_f32 v183, v183, v12, v12
v_mfma_f32_32x32x16_bf16 v[56:71], v[164:167], a[24:27], v[56:71]
v_rcp_f32 v180, v180
v_rcp_f32 v181, v181
v_rcp_f32 v182, v182
v_mfma_f32_32x32x16_bf16 v[72:87], v[164:167], a[28:31], v[72:87]
v_rcp_f32 v183, v183
v_mul_f32 v180, v92, v180
s_waitcnt vmcnt(25) lgkmcnt(0)
ds_read_b64_tr_b16 v[160:161], v6 offset:10240
ds_read_b64_tr_b16 v[162:163], v6 offset:10752
s_add_u32 m0, s38, 8192
v_mfma_f32_32x32x16_bf16 v[24:39], v[152:155], a[32:35], v[24:39]
ds_read_b64_tr_b16 v[164:165], v7 offset:10240
buffer_load_dwordx4 v2, s[12:15], s57 offen lds
v_mul_f32 v181, v93, v181
v_mul_f32 v182, v94, v182
v_mfma_f32_32x32x16_bf16 v[40:55], v[152:155], a[36:39], v[40:55]
ds_read_b64_tr_b16 v[166:167], v7 offset:10752
buffer_load_dwordx4 v3, s[12:15], s57 offen offset:1024 lds
v_mul_f32 v183, v95, v183
v_cvt_pk_bf16_f32 v194, v180, v181
v_cvt_pk_bf16_f32 v195, v182, v183
v_mfma_f32_32x32x16_bf16 v[56:71], v[156:159], a[32:35], v[56:71]
v_mul_f32 v184, v96, v10
v_mul_f32 v185, v97, v10
v_mul_f32 v186, v98, v10
v_mul_f32 v187, v99, v10
v_exp_f32 v184, v184
v_mfma_f32_32x32x16_bf16 v[72:87], v[156:159], a[36:39], v[72:87]
v_exp_f32 v185, v185
s_waitcnt vmcnt(25) lgkmcnt(0)
ds_read_b64_tr_b16 v[152:153], v172 offset:32768
ds_read_b64_tr_b16 v[154:155], v172 offset:33280
s_add_u32 m0, s38, 10240
v_mfma_f32_32x32x16_bf16 v[24:39], v[160:163], a[40:43], v[24:39]
ds_read_b64_tr_b16 v[156:157], v173 offset:32768
buffer_load_dwordx4 v2, s[12:15], s58 offen lds
v_exp_f32 v186, v186
v_mfma_f32_32x32x16_bf16 v[40:55], v[160:163], a[44:47], v[40:55]
ds_read_b64_tr_b16 v[158:159], v173 offset:33280
buffer_load_dwordx4 v3, s[12:15], s58 offen offset:1024 lds
v_exp_f32 v187, v187
v_fma_f32 v184, v184, v12, v12
v_mfma_f32_32x32x16_bf16 v[56:71], v[164:167], a[40:43], v[56:71]
v_fma_f32 v185, v185, v12, v12
v_fma_f32 v186, v186, v12, v12
v_fma_f32 v187, v187, v12, v12
v_rcp_f32 v184, v184
v_rcp_f32 v185, v185
v_mfma_f32_32x32x16_bf16 v[72:87], v[164:167], a[44:47], v[72:87]
v_rcp_f32 v186, v186
s_waitcnt vmcnt(25) lgkmcnt(0)
ds_read_b64_tr_b16 v[160:161], v172 offset:34816
ds_read_b64_tr_b16 v[162:163], v172 offset:35328
s_add_u32 m0, s33, 6144
v_mfma_f32_32x32x16_bf16 v[24:39], v[152:155], a[48:51], v[24:39]
ds_read_b64_tr_b16 v[164:165], v173 offset:34816
buffer_load_dwordx4 v2, s[12:15], s59 offen lds
v_rcp_f32 v187, v187
v_mfma_f32_32x32x16_bf16 v[40:55], v[152:155], a[52:55], v[40:55]
ds_read_b64_tr_b16 v[166:167], v173 offset:35328
buffer_load_dwordx4 v3, s[12:15], s59 offen offset:1024 lds
v_mul_f32 v184, v96, v184
v_mul_f32 v185, v97, v185
v_mul_f32 v186, v98, v186
v_mfma_f32_32x32x16_bf16 v[56:71], v[156:159], a[48:51], v[56:71]
v_mul_f32 v187, v99, v187
v_cvt_pk_bf16_f32 v196, v184, v185
v_cvt_pk_bf16_f32 v197, v186, v187
v_mul_f32 v188, v100, v10
v_mul_f32 v189, v101, v10
v_mul_f32 v190, v102, v10
v_mfma_f32_32x32x16_bf16 v[72:87], v[156:159], a[52:55], v[72:87]
v_mul_f32 v191, v103, v10
v_exp_f32 v188, v188
s_waitcnt vmcnt(25) lgkmcnt(0)
ds_read_b64_tr_b16 v[152:153], v172 offset:36864
ds_read_b64_tr_b16 v[154:155], v172 offset:37376
s_add_u32 m0, s33, 32768
v_mfma_f32_32x32x16_bf16 v[24:39], v[160:163], a[56:59], v[24:39]
ds_read_b64_tr_b16 v[156:157], v173 offset:36864
buffer_load_dwordx4 v2, s[12:15], s60 offen lds
v_exp_f32 v189, v189
v_mfma_f32_32x32x16_bf16 v[40:55], v[160:163], a[60:63], v[40:55]
ds_read_b64_tr_b16 v[158:159], v173 offset:37376
buffer_load_dwordx4 v3, s[12:15], s60 offen offset:1024 lds
v_exp_f32 v190, v190
v_mfma_f32_32x32x16_bf16 v[56:71], v[164:167], a[56:59], v[56:71]
v_exp_f32 v191, v191
v_fma_f32 v188, v188, v12, v12
v_fma_f32 v189, v189, v12, v12
v_fma_f32 v190, v190, v12, v12
v_fma_f32 v191, v191, v12, v12
v_mfma_f32_32x32x16_bf16 v[72:87], v[164:167], a[60:63], v[72:87]
v_rcp_f32 v188, v188
v_rcp_f32 v189, v189
s_waitcnt vmcnt(25) lgkmcnt(0)
ds_read_b64_tr_b16 v[160:161], v172 offset:38912
ds_read_b64_tr_b16 v[162:163], v172 offset:39424
s_add_u32 m0, s33, 34816
v_mfma_f32_32x32x16_bf16 v[24:39], v[152:155], a[64:67], v[24:39]
ds_read_b64_tr_b16 v[164:165], v173 offset:38912
buffer_load_dwordx4 v2, s[12:15], s61 offen lds
v_rcp_f32 v190, v190
v_mfma_f32_32x32x16_bf16 v[40:55], v[152:155], a[68:71], v[40:55]
ds_read_b64_tr_b16 v[166:167], v173 offset:39424
buffer_load_dwordx4 v3, s[12:15], s61 offen offset:1024 lds
v_rcp_f32 v191, v191
v_mul_f32 v188, v100, v188
v_mfma_f32_32x32x16_bf16 v[56:71], v[156:159], a[64:67], v[56:71]
v_mul_f32 v189, v101, v189
v_mul_f32 v190, v102, v190
v_mul_f32 v191, v103, v191
v_cvt_pk_bf16_f32 v198, v188, v189
v_cvt_pk_bf16_f32 v199, v190, v191
v_mfma_f32_32x32x16_bf16 v[72:87], v[156:159], a[68:71], v[72:87]
v_mul_f32 v176, v104, v11
v_mul_f32 v177, v105, v11
v_mul_f32 v178, v106, v11
s_waitcnt vmcnt(25) lgkmcnt(0)
ds_read_b64_tr_b16 v[152:153], v172 offset:0
ds_read_b64_tr_b16 v[154:155], v172 offset:512
s_add_u32 m0, s33, 36864
v_mfma_f32_32x32x16_bf16 v[24:39], v[160:163], a[72:75], v[24:39]
ds_read_b64_tr_b16 v[156:157], v173 offset:0
buffer_load_dwordx4 v2, s[12:15], s62 offen lds
v_mul_f32 v179, v107, v11
v_exp_f32 v176, v176
v_mfma_f32_32x32x16_bf16 v[40:55], v[160:163], a[76:79], v[40:55]
ds_read_b64_tr_b16 v[158:159], v173 offset:512
buffer_load_dwordx4 v3, s[12:15], s62 offen offset:1024 lds
v_exp_f32 v177, v177
v_mfma_f32_32x32x16_bf16 v[56:71], v[164:167], a[72:75], v[56:71]
v_exp_f32 v178, v178
v_exp_f32 v179, v179
v_fma_f32 v176, v176, v13, v13
v_fma_f32 v177, v177, v13, v13
v_mfma_f32_32x32x16_bf16 v[72:87], v[164:167], a[76:79], v[72:87]
v_fma_f32 v178, v178, v13, v13
v_fma_f32 v179, v179, v13, v13
v_rcp_f32 v176, v176
s_waitcnt vmcnt(25) lgkmcnt(0)
ds_read_b64_tr_b16 v[160:161], v172 offset:2048
ds_read_b64_tr_b16 v[162:163], v172 offset:2560
s_add_u32 m0, s33, 0
v_mfma_f32_32x32x16_bf16 v[24:39], v[152:155], a[80:83], v[24:39]
ds_read_b64_tr_b16 v[164:165], v173 offset:2048
buffer_load_dwordx4 v2, s[12:15], s63 offen lds
v_rcp_f32 v177, v177
v_mfma_f32_32x32x16_bf16 v[40:55], v[152:155], a[84:87], v[40:55]
ds_read_b64_tr_b16 v[166:167], v173 offset:2560
buffer_load_dwordx4 v3, s[12:15], s63 offen offset:1024 lds
v_rcp_f32 v178, v178
v_mfma_f32_32x32x16_bf16 v[56:71], v[156:159], a[80:83], v[56:71]
v_rcp_f32 v179, v179
v_mul_f32 v176, v104, v176
v_mul_f32 v177, v105, v177
v_mul_f32 v178, v106, v178
v_mul_f32 v179, v107, v179
v_mfma_f32_32x32x16_bf16 v[72:87], v[156:159], a[84:87], v[72:87]
v_cvt_pk_bf16_f32 v200, v176, v177
v_cvt_pk_bf16_f32 v201, v178, v179
v_mul_f32 v180, v108, v11
s_waitcnt vmcnt(25) lgkmcnt(0)
ds_read_b64_tr_b16 v[152:153], v172 offset:4096
ds_read_b64_tr_b16 v[154:155], v172 offset:4608
s_add_u32 m0, s33, 2048
v_mfma_f32_32x32x16_bf16 v[24:39], v[160:163], a[88:91], v[24:39]
ds_read_b64_tr_b16 v[156:157], v173 offset:4096
buffer_load_dwordx4 v2, s[12:15], s64 offen lds
v_mul_f32 v181, v109, v11
v_mul_f32 v182, v110, v11
v_mfma_f32_32x32x16_bf16 v[40:55], v[160:163], a[92:95], v[40:55]
ds_read_b64_tr_b16 v[158:159], v173 offset:4608
buffer_load_dwordx4 v3, s[12:15], s64 offen offset:1024 lds
v_mul_f32 v183, v111, v11
v_exp_f32 v180, v180
v_mfma_f32_32x32x16_bf16 v[56:71], v[164:167], a[88:91], v[56:71]
v_exp_f32 v181, v181
v_exp_f32 v182, v182
v_exp_f32 v183, v183
v_mfma_f32_32x32x16_bf16 v[72:87], v[164:167], a[92:95], v[72:87]
v_fma_f32 v180, v180, v13, v13
v_fma_f32 v181, v181, v13, v13
v_fma_f32 v182, v182, v13, v13
s_waitcnt vmcnt(22) lgkmcnt(0)
ds_read_b64_tr_b16 v[160:161], v6 offset:0
ds_read_b64_tr_b16 v[162:163], v6 offset:512
s_add_u32 m0, s33, 4096
v_mfma_f32_32x32x16_bf16 v[24:39], v[152:155], a[96:99], v[24:39]
ds_read_b64_tr_b16 v[164:165], v7 offset:0
buffer_load_dwordx4 v2, s[12:15], s65 offen lds
v_fma_f32 v183, v183, v13, v13
v_mfma_f32_32x32x16_bf16 v[40:55], v[152:155], a[100:103], v[40:55]
ds_read_b64_tr_b16 v[166:167], v7 offset:512
buffer_load_dwordx4 v3, s[12:15], s65 offen offset:1024 lds
v_rcp_f32 v180, v180
v_rcp_f32 v181, v181
v_mfma_f32_32x32x16_bf16 v[56:71], v[156:159], a[96:99], v[56:71]
v_rcp_f32 v182, v182
v_rcp_f32 v183, v183
v_mul_f32 v180, v108, v180
v_mfma_f32_32x32x16_bf16 v[72:87], v[156:159], a[100:103], v[72:87]
v_mul_f32 v181, v109, v181
v_mul_f32 v182, v110, v182
v_mul_f32 v183, v111, v183
v_mov_b32 v21, s39
v_mov_b32 v22, 0
v_cmp_eq_u32 vcc, 0, v1
s_and_saveexec_b64 s[0:1], vcc
buffer_store_dword v21, v22, s[20:23], s99 offen sc1
s_mov_b64 exec, s[0:1]
s_waitcnt vmcnt(23) lgkmcnt(0)
ds_read_b64_tr_b16 v[152:153], v6 offset:2048
ds_read_b64_tr_b16 v[154:155], v6 offset:2560
s_add_u32 m0, s38, 0
v_mfma_f32_32x32x16_bf16 v[24:39], v[160:163], a[104:107], v[24:39]
ds_read_b64_tr_b16 v[156:157], v7 offset:2048
buffer_load_dwordx4 v2, s[12:15], s66 offen lds
v_cvt_pk_bf16_f32 v202, v180, v181
v_cvt_pk_bf16_f32 v203, v182, v183
v_mfma_f32_32x32x16_bf16 v[40:55], v[160:163], a[108:111], v[40:55]
ds_read_b64_tr_b16 v[158:159], v7 offset:2560
buffer_load_dwordx4 v3, s[12:15], s66 offen offset:1024 lds
v_mul_f32 v184, v112, v11
v_mul_f32 v185, v113, v11
v_mul_f32 v186, v114, v11
v_mfma_f32_32x32x16_bf16 v[56:71], v[164:167], a[104:107], v[56:71]
v_mul_f32 v187, v115, v11
v_exp_f32 v184, v184
v_exp_f32 v185, v185
v_exp_f32 v186, v186
v_mfma_f32_32x32x16_bf16 v[72:87], v[164:167], a[108:111], v[72:87]
v_exp_f32 v187, v187
s_waitcnt vmcnt(23) lgkmcnt(0)
ds_read_b64_tr_b16 v[160:161], v6 offset:4096
ds_read_b64_tr_b16 v[162:163], v6 offset:4608
s_add_u32 m0, s38, 2048
v_mfma_f32_32x32x16_bf16 v[24:39], v[152:155], a[112:115], v[24:39]
ds_read_b64_tr_b16 v[164:165], v7 offset:4096
buffer_load_dwordx4 v2, s[12:15], s67 offen lds
v_fma_f32 v184, v184, v13, v13
v_fma_f32 v185, v185, v13, v13
v_mfma_f32_32x32x16_bf16 v[40:55], v[152:155], a[116:119], v[40:55]
ds_read_b64_tr_b16 v[166:167], v7 offset:4608
buffer_load_dwordx4 v3, s[12:15], s67 offen offset:1024 lds
v_fma_f32 v186, v186, v13, v13
v_fma_f32 v187, v187, v13, v13
v_mfma_f32_32x32x16_bf16 v[56:71], v[156:159], a[112:115], v[56:71]
v_rcp_f32 v184, v184
v_rcp_f32 v185, v185
v_rcp_f32 v186, v186
v_mfma_f32_32x32x16_bf16 v[72:87], v[156:159], a[116:119], v[72:87]
v_rcp_f32 v187, v187
v_mul_f32 v184, v112, v184
v_mul_f32 v185, v113, v185
s_waitcnt vmcnt(23) lgkmcnt(0)
ds_read_b64_tr_b16 v[152:153], v6 offset:6144
ds_read_b64_tr_b16 v[154:155], v6 offset:6656
s_add_u32 m0, s38, 4096
v_mfma_f32_32x32x16_bf16 v[24:39], v[160:163], a[120:123], v[24:39]
ds_read_b64_tr_b16 v[156:157], v7 offset:6144
buffer_load_dwordx4 v2, s[12:15], s68 offen lds
v_mul_f32 v186, v114, v186
v_mul_f32 v187, v115, v187
v_mfma_f32_32x32x16_bf16 v[40:55], v[160:163], a[124:127], v[40:55]
ds_read_b64_tr_b16 v[158:159], v7 offset:6656
buffer_load_dwordx4 v3, s[12:15], s68 offen offset:1024 lds
v_cvt_pk_bf16_f32 v204, v184, v185
v_cvt_pk_bf16_f32 v205, v186, v187
v_mul_f32 v188, v116, v11
v_mfma_f32_32x32x16_bf16 v[56:71], v[164:167], a[120:123], v[56:71]
v_mul_f32 v189, v117, v11
v_mul_f32 v190, v118, v11
v_mul_f32 v191, v119, v11
v_exp_f32 v188, v188
v_mfma_f32_32x32x16_bf16 v[72:87], v[164:167], a[124:127], v[72:87]
v_exp_f32 v189, v189
v_exp_f32 v190, v190
s_waitcnt vmcnt(23) lgkmcnt(0)
ds_read_b64_tr_b16 v[160:161], v6 offset:8192
ds_read_b64_tr_b16 v[162:163], v6 offset:8704
s_add_u32 m0, s38, 6144
v_mfma_f32_32x32x16_bf16 v[24:39], v[152:155], a[128:131], v[24:39]
ds_read_b64_tr_b16 v[164:165], v7 offset:8192
buffer_load_dwordx4 v2, s[12:15], s69 offen lds
v_exp_f32 v191, v191
v_mfma_f32_32x32x16_bf16 v[40:55], v[152:155], a[132:135], v[40:55]
ds_read_b64_tr_b16 v[166:167], v7 offset:8704
buffer_load_dwordx4 v3, s[12:15], s69 offen offset:1024 lds
v_fma_f32 v188, v188, v13, v13
v_fma_f32 v189, v189, v13, v13
v_mfma_f32_32x32x16_bf16 v[56:71], v[156:159], a[128:131], v[56:71]
v_fma_f32 v190, v190, v13, v13
v_fma_f32 v191, v191, v13, v13
v_rcp_f32 v188, v188
v_rcp_f32 v189, v189
v_mfma_f32_32x32x16_bf16 v[72:87], v[156:159], a[132:135], v[72:87]
v_rcp_f32 v190, v190
v_rcp_f32 v191, v191
s_waitcnt vmcnt(23) lgkmcnt(0)
ds_read_b64_tr_b16 v[152:153], v6 offset:10240
ds_read_b64_tr_b16 v[154:155], v6 offset:10752
s_add_u32 m0, s38, 8192
v_mfma_f32_32x32x16_bf16 v[24:39], v[160:163], a[136:139], v[24:39]
ds_read_b64_tr_b16 v[156:157], v7 offset:10240
buffer_load_dwordx4 v2, s[12:15], s70 offen lds
v_mul_f32 v188, v116, v188
v_mfma_f32_32x32x16_bf16 v[40:55], v[160:163], a[140:143], v[40:55]
ds_read_b64_tr_b16 v[158:159], v7 offset:10752
buffer_load_dwordx4 v3, s[12:15], s70 offen offset:1024 lds
v_mul_f32 v189, v117, v189
v_mul_f32 v190, v118, v190
v_mul_f32 v191, v119, v191
v_mfma_f32_32x32x16_bf16 v[56:71], v[164:167], a[136:139], v[56:71]
v_cvt_pk_bf16_f32 v206, v188, v189
v_cvt_pk_bf16_f32 v207, v190, v191
v_mul_f32 v176, v120, v10
v_mul_f32 v177, v121, v10
v_mul_f32 v178, v122, v10
v_mul_f32 v179, v123, v10
v_mfma_f32_32x32x16_bf16 v[72:87], v[164:167], a[140:143], v[72:87]
v_exp_f32 v176, v176
s_waitcnt vmcnt(23) lgkmcnt(0)
ds_read_b64_tr_b16 v[160:161], v172 offset:6144
ds_read_b64_tr_b16 v[162:163], v172 offset:6656
s_add_u32 m0, s38, 10240
v_mfma_f32_32x32x16_bf16 v[24:39], v[152:155], a[144:147], v[24:39]
ds_read_b64_tr_b16 v[164:165], v173 offset:6144
buffer_load_dwordx4 v2, s[12:15], s71 offen lds
v_exp_f32 v177, v177
v_mfma_f32_32x32x16_bf16 v[40:55], v[152:155], a[148:151], v[40:55]
ds_read_b64_tr_b16 v[166:167], v173 offset:6656
buffer_load_dwordx4 v3, s[12:15], s71 offen offset:1024 lds
v_exp_f32 v178, v178
v_exp_f32 v179, v179
v_mfma_f32_32x32x16_bf16 v[56:71], v[156:159], a[144:147], v[56:71]
v_fma_f32 v176, v176, v12, v12
v_fma_f32 v177, v177, v12, v12
v_fma_f32 v178, v178, v12, v12
v_fma_f32 v179, v179, v12, v12
v_rcp_f32 v176, v176
v_mfma_f32_32x32x16_bf16 v[72:87], v[156:159], a[148:151], v[72:87]
v_rcp_f32 v177, v177
s_waitcnt vmcnt(23) lgkmcnt(0)
ds_read_b64_tr_b16 v[152:153], v172 offset:32768
ds_read_b64_tr_b16 v[154:155], v172 offset:33280
s_add_u32 m0, s33, 6144
v_mfma_f32_32x32x16_bf16 v[24:39], v[160:163], a[152:155], v[24:39]
ds_read_b64_tr_b16 v[156:157], v173 offset:32768
buffer_load_dwordx4 v2, s[12:15], s72 offen lds
v_rcp_f32 v178, v178
v_mfma_f32_32x32x16_bf16 v[40:55], v[160:163], a[156:159], v[40:55]
ds_read_b64_tr_b16 v[158:159], v173 offset:33280
buffer_load_dwordx4 v3, s[12:15], s72 offen offset:1024 lds
v_rcp_f32 v179, v179
v_mul_f32 v176, v120, v176
v_mfma_f32_32x32x16_bf16 v[56:71], v[164:167], a[152:155], v[56:71]
v_mul_f32 v177, v121, v177
v_mul_f32 v178, v122, v178
v_mul_f32 v179, v123, v179
v_cvt_pk_bf16_f32 v208, v176, v177
v_cvt_pk_bf16_f32 v209, v178, v179
v_mul_f32 v180, v124, v10
v_mfma_f32_32x32x16_bf16 v[72:87], v[164:167], a[156:159], v[72:87]
v_mul_f32 v181, v125, v10
v_mul_f32 v182, v126, v10
v_mul_f32 v183, v127, v10
s_waitcnt vmcnt(23) lgkmcnt(0)
ds_read_b64_tr_b16 v[160:161], v172 offset:34816
ds_read_b64_tr_b16 v[162:163], v172 offset:35328
s_add_u32 m0, s33, 32768
v_mfma_f32_32x32x16_bf16 v[24:39], v[152:155], a[160:163], v[24:39]
ds_read_b64_tr_b16 v[164:165], v173 offset:34816
buffer_load_dwordx4 v2, s[12:15], s73 offen lds
v_exp_f32 v180, v180
v_mfma_f32_32x32x16_bf16 v[40:55], v[152:155], a[164:167], v[40:55]
ds_read_b64_tr_b16 v[166:167], v173 offset:35328
buffer_load_dwordx4 v3, s[12:15], s73 offen offset:1024 lds
v_exp_f32 v181, v181
v_exp_f32 v182, v182
v_mfma_f32_32x32x16_bf16 v[56:71], v[156:159], a[160:163], v[56:71]
v_exp_f32 v183, v183
v_fma_f32 v180, v180, v12, v12
v_fma_f32 v181, v181, v12, v12
v_fma_f32 v182, v182, v12, v12
v_mfma_f32_32x32x16_bf16 v[72:87], v[156:159], a[164:167], v[72:87]
v_fma_f32 v183, v183, v12, v12
v_rcp_f32 v180, v180
s_waitcnt vmcnt(23) lgkmcnt(0)
ds_read_b64_tr_b16 v[152:153], v172 offset:36864
ds_read_b64_tr_b16 v[154:155], v172 offset:37376
s_add_u32 m0, s33, 34816
v_mfma_f32_32x32x16_bf16 v[24:39], v[160:163], a[168:171], v[24:39]
ds_read_b64_tr_b16 v[156:157], v173 offset:36864
buffer_load_dwordx4 v2, s[12:15], s74 offen lds
v_rcp_f32 v181, v181
v_mfma_f32_32x32x16_bf16 v[40:55], v[160:163], a[172:175], v[40:55]
ds_read_b64_tr_b16 v[158:159], v173 offset:37376
buffer_load_dwordx4 v3, s[12:15], s74 offen offset:1024 lds
v_rcp_f32 v182, v182
v_mfma_f32_32x32x16_bf16 v[56:71], v[164:167], a[168:171], v[56:71]
v_rcp_f32 v183, v183
v_mul_f32 v180, v124, v180
v_mul_f32 v181, v125, v181
v_mul_f32 v182, v126, v182
v_mul_f32 v183, v127, v183
v_cvt_pk_bf16_f32 v210, v180, v181
v_mfma_f32_32x32x16_bf16 v[72:87], v[164:167], a[172:175], v[72:87]
v_cvt_pk_bf16_f32 v211, v182, v183
v_mul_f32 v184, v128, v10
v_mul_f32 v185, v129, v10
s_waitcnt vmcnt(23) lgkmcnt(0)
ds_read_b64_tr_b16 v[160:161], v172 offset:0
ds_read_b64_tr_b16 v[162:163], v172 offset:512
s_add_u32 m0, s33, 36864
v_mfma_f32_32x32x16_bf16 v[24:39], v[152:155], a[176:179], v[24:39]
ds_read_b64_tr_b16 v[164:165], v173 offset:0
buffer_load_dwordx4 v2, s[12:15], s75 offen lds
v_mul_f32 v186, v130, v10
v_mul_f32 v187, v131, v10
v_mfma_f32_32x32x16_bf16 v[40:55], v[152:155], a[180:183], v[40:55]
ds_read_b64_tr_b16 v[166:167], v173 offset:512
buffer_load_dwordx4 v3, s[12:15], s75 offen offset:1024 lds
v_exp_f32 v184, v184
v_mfma_f32_32x32x16_bf16 v[56:71], v[156:159], a[176:179], v[56:71]
v_exp_f32 v185, v185
v_exp_f32 v186, v186
v_exp_f32 v187, v187
v_mfma_f32_32x32x16_bf16 v[72:87], v[156:159], a[180:183], v[72:87]
v_fma_f32 v184, v184, v12, v12
v_fma_f32 v185, v185, v12, v12
v_fma_f32 v186, v186, v12, v12
s_waitcnt vmcnt(23) lgkmcnt(0)
ds_read_b64_tr_b16 v[152:153], v172 offset:2048
ds_read_b64_tr_b16 v[154:155], v172 offset:2560
s_add_u32 m0, s33, 38912
v_mfma_f32_32x32x16_bf16 v[24:39], v[160:163], a[184:187], v[24:39]
ds_read_b64_tr_b16 v[156:157], v173 offset:2048
buffer_load_dwordx4 v4, s[16:19], s40 offen lds
v_fma_f32 v187, v187, v12, v12
v_rcp_f32 v184, v184
v_mfma_f32_32x32x16_bf16 v[40:55], v[160:163], a[188:191], v[40:55]
ds_read_b64_tr_b16 v[158:159], v173 offset:2560
buffer_load_dwordx4 v5, s[16:19], s40 offen offset:1024 lds
v_rcp_f32 v185, v185
v_mfma_f32_32x32x16_bf16 v[56:71], v[164:167], a[184:187], v[56:71]
v_rcp_f32 v186, v186
v_rcp_f32 v187, v187
v_mul_f32 v184, v128, v184
v_mul_f32 v185, v129, v185
v_mfma_f32_32x32x16_bf16 v[72:87], v[164:167], a[188:191], v[72:87]
v_mul_f32 v186, v130, v186
v_mul_f32 v187, v131, v187
v_cvt_pk_bf16_f32 v212, v184, v185
s_add_u32 s49, s7, 165888
s_add_u32 s50, s7, 184320
s_add_u32 s51, s7, 202752
s_waitcnt vmcnt(23) lgkmcnt(0)
ds_read_b64_tr_b16 v[160:161], v172 offset:4096
ds_read_b64_tr_b16 v[162:163], v172 offset:4608
v_mfma_f32_32x32x16_bf16 v[24:39], v[152:155], a[192:195], v[24:39]
ds_read_b64_tr_b16 v[164:165], v173 offset:4096
v_cvt_pk_bf16_f32 v213, v186, v187
v_mul_f32 v188, v132, v10
v_mfma_f32_32x32x16_bf16 v[40:55], v[152:155], a[196:199], v[40:55]
ds_read_b64_tr_b16 v[166:167], v173 offset:4608
v_mul_f32 v189, v133, v10
v_mul_f32 v190, v134, v10
v_mul_f32 v191, v135, v10
v_mfma_f32_32x32x16_bf16 v[56:71], v[156:159], a[192:195], v[56:71]
v_exp_f32 v188, v188
v_exp_f32 v189, v189
v_exp_f32 v190, v190
v_mfma_f32_32x32x16_bf16 v[72:87], v[156:159], a[196:199], v[72:87]
v_exp_f32 v191, v191
v_fma_f32 v188, v188, v12, v12
s_add_u32 s52, s7, 221184
s_add_u32 s53, s7, 239616
s_add_u32 s54, s7, 258048
s_waitcnt vmcnt(20) lgkmcnt(0)
ds_read_b64_tr_b16 v[152:153], v6 offset:0
ds_read_b64_tr_b16 v[154:155], v6 offset:512
v_mfma_f32_32x32x16_bf16 v[24:39], v[160:163], a[200:203], v[24:39]
ds_read_b64_tr_b16 v[156:157], v7 offset:0
v_fma_f32 v189, v189, v12, v12
v_fma_f32 v190, v190, v12, v12
v_mfma_f32_32x32x16_bf16 v[40:55], v[160:163], a[204:207], v[40:55]
ds_read_b64_tr_b16 v[158:159], v7 offset:512
v_fma_f32 v191, v191, v12, v12
v_rcp_f32 v188, v188
v_mfma_f32_32x32x16_bf16 v[56:71], v[164:167], a[200:203], v[56:71]
v_rcp_f32 v189, v189
v_rcp_f32 v190, v190
v_rcp_f32 v191, v191
v_mfma_f32_32x32x16_bf16 v[72:87], v[164:167], a[204:207], v[72:87]
v_mul_f32 v188, v132, v188
v_mul_f32 v189, v133, v189
v_mul_f32 v190, v134, v190
s_add_u32 s55, s7, 276480
s_add_u32 s56, s7, 589824
s_add_u32 s57, s7, 608256
s_waitcnt vmcnt(18) lgkmcnt(0)
ds_read_b64_tr_b16 v[160:161], v6 offset:2048
ds_read_b64_tr_b16 v[162:163], v6 offset:2560
s_add_u32 m0, s38, 0
v_mfma_f32_32x32x16_bf16 v[24:39], v[152:155], a[208:211], v[24:39]
ds_read_b64_tr_b16 v[164:165], v7 offset:2048
buffer_load_dwordx4 v4, s[16:19], s41 offen lds
v_mul_f32 v191, v135, v191
v_cvt_pk_bf16_f32 v214, v188, v189
v_mfma_f32_32x32x16_bf16 v[40:55], v[152:155], a[212:215], v[40:55]
ds_read_b64_tr_b16 v[166:167], v7 offset:2560
buffer_load_dwordx4 v5, s[16:19], s41 offen offset:1024 lds
v_cvt_pk_bf16_f32 v215, v190, v191
v_mul_f32 v176, v136, v11
v_mfma_f32_32x32x16_bf16 v[56:71], v[156:159], a[208:211], v[56:71]
v_mul_f32 v177, v137, v11
v_mul_f32 v178, v138, v11
v_mul_f32 v179, v139, v11
v_exp_f32 v176, v176
v_exp_f32 v177, v177
v_mfma_f32_32x32x16_bf16 v[72:87], v[156:159], a[212:215], v[72:87]
v_exp_f32 v178, v178
s_add_u32 s58, s7, 626688
s_add_u32 s59, s7, 645120
s_add_u32 s60, s7, 294912
s_waitcnt vmcnt(18) lgkmcnt(0)
ds_read_b64_tr_b16 v[152:153], v6 offset:4096
ds_read_b64_tr_b16 v[154:155], v6 offset:4608
s_add_u32 m0, s38, 2048
v_mfma_f32_32x32x16_bf16 v[24:39], v[160:163], a[216:219], v[24:39]
ds_read_b64_tr_b16 v[156:157], v7 offset:4096
buffer_load_dwordx4 v4, s[16:19], s42 offen lds
v_exp_f32 v179, v179
v_mfma_f32_32x32x16_bf16 v[40:55], v[160:163], a[220:223], v[40:55]
ds_read_b64_tr_b16 v[158:159], v7 offset:4608
buffer_load_dwordx4 v5, s[16:19], s42 offen offset:1024 lds
v_fma_f32 v176, v176, v13, v13
v_fma_f32 v177, v177, v13, v13
v_fma_f32 v178, v178, v13, v13
v_mfma_f32_32x32x16_bf16 v[56:71], v[164:167], a[216:219], v[56:71]
v_fma_f32 v179, v179, v13, v13
v_rcp_f32 v176, v176
v_rcp_f32 v177, v177
v_rcp_f32 v178, v178
v_mfma_f32_32x32x16_bf16 v[72:87], v[164:167], a[220:223], v[72:87]
v_rcp_f32 v179, v179
s_add_u32 s61, s7, 313344
s_add_u32 s62, s7, 331776
s_add_u32 s63, s7, 350208
s_waitcnt vmcnt(18) lgkmcnt(0)
ds_read_b64_tr_b16 v[160:161], v6 offset:6144
ds_read_b64_tr_b16 v[162:163], v6 offset:6656
s_add_u32 m0, s38, 4096
v_mfma_f32_32x32x16_bf16 v[24:39], v[152:155], a[224:227], v[24:39]
ds_read_b64_tr_b16 v[164:165], v7 offset:6144
buffer_load_dwordx4 v4, s[16:19], s43 offen lds
v_mul_f32 v176, v136, v176
v_mul_f32 v177, v137, v177
v_mfma_f32_32x32x16_bf16 v[40:55], v[152:155], a[228:231], v[40:55]
ds_read_b64_tr_b16 v[166:167], v7 offset:6656
buffer_load_dwordx4 v5, s[16:19], s43 offen offset:1024 lds
v_mul_f32 v178, v138, v178
v_mul_f32 v179, v139, v179
v_cvt_pk_bf16_f32 v216, v176, v177
v_mfma_f32_32x32x16_bf16 v[56:71], v[156:159], a[224:227], v[56:71]
v_cvt_pk_bf16_f32 v217, v178, v179
v_mul_f32 v180, v140, v11
v_mul_f32 v181, v141, v11
v_mul_f32 v182, v142, v11
v_mul_f32 v183, v143, v11
v_mfma_f32_32x32x16_bf16 v[72:87], v[156:159], a[228:231], v[72:87]
v_exp_f32 v180, v180
v_exp_f32 v181, v181
s_add_u32 s64, s7, 368640
s_add_u32 s65, s7, 387072
s_add_u32 s66, s7, 405504
s_waitcnt vmcnt(18) lgkmcnt(0)
ds_read_b64_tr_b16 v[152:153], v6 offset:8192
ds_read_b64_tr_b16 v[154:155], v6 offset:8704
s_add_u32 m0, s38, 6144
v_mfma_f32_32x32x16_bf16 v[24:39], v[160:163], a[232:235], v[24:39]
ds_read_b64_tr_b16 v[156:157], v7 offset:8192
buffer_load_dwordx4 v4, s[16:19], s44 offen lds
v_exp_f32 v182, v182
v_mfma_f32_32x32x16_bf16 v[40:55], v[160:163], a[236:239], v[40:55]
ds_read_b64_tr_b16 v[158:159], v7 offset:8704
buffer_load_dwordx4 v5, s[16:19], s44 offen offset:1024 lds
v_exp_f32 v183, v183
v_fma_f32 v180, v180, v13, v13
v_mfma_f32_32x32x16_bf16 v[56:71], v[164:167], a[232:235], v[56:71]
v_fma_f32 v181, v181, v13, v13
v_fma_f32 v182, v182, v13, v13
v_fma_f32 v183, v183, v13, v13
v_rcp_f32 v180, v180
v_mfma_f32_32x32x16_bf16 v[72:87], v[164:167], a[236:239], v[72:87]
v_rcp_f32 v181, v181
v_rcp_f32 v182, v182
buffer_load_dword v169, v168, s[20:23], s96 offen sc1
s_add_u32 s67, s7, 423936
s_add_u32 s68, s7, 442368
s_add_u32 s69, s7, 460800
s_waitcnt vmcnt(19) lgkmcnt(0)
ds_read_b64_tr_b16 v[160:161], v6 offset:10240
ds_read_b64_tr_b16 v[162:163], v6 offset:10752
s_add_u32 m0, s38, 8192
v_mfma_f32_32x32x16_bf16 v[24:39], v[152:155], a[240:243], v[24:39]
ds_read_b64_tr_b16 v[164:165], v7 offset:10240
buffer_load_dwordx4 v4, s[16:19], s45 offen lds
v_rcp_f32 v183, v183
v_mfma_f32_32x32x16_bf16 v[40:55], v[152:155], a[244:247], v[40:55]
ds_read_b64_tr_b16 v[166:167], v7 offset:10752
buffer_load_dwordx4 v5, s[16:19], s45 offen offset:1024 lds
v_mul_f32 v180, v140, v180
v_mul_f32 v181, v141, v181
v_mfma_f32_32x32x16_bf16 v[56:71], v[156:159], a[240:243], v[56:71]
v_mul_f32 v182, v142, v182
v_mul_f32 v183, v143, v183
v_cvt_pk_bf16_f32 v218, v180, v181
v_cvt_pk_bf16_f32 v219, v182, v183
v_mul_f32 v184, v144, v11
v_mul_f32 v185, v145, v11
v_mfma_f32_32x32x16_bf16 v[72:87], v[156:159], a[244:247], v[72:87]
v_mul_f32 v186, v146, v11
v_mul_f32 v187, v147, v11
v_exp_f32 v184, v184
s_add_u32 s70, s7, 479232
s_add_u32 s71, s7, 497664
s_add_u32 s72, s7, 516096
s_waitcnt vmcnt(19) lgkmcnt(0)
ds_read_b64_tr_b16 v[152:153], v172 offset:6144
ds_read_b64_tr_b16 v[154:155], v172 offset:6656
s_add_u32 m0, s38, 10240
v_mfma_f32_32x32x16_bf16 v[24:39], v[160:163], a[248:251], v[24:39]
ds_read_b64_tr_b16 v[156:157], v173 offset:6144
buffer_load_dwordx4 v4, s[16:19], s46 offen lds
v_exp_f32 v185, v185
v_mfma_f32_32x32x16_bf16 v[40:55], v[160:163], a[252:255], v[40:55]
ds_read_b64_tr_b16 v[158:159], v173 offset:6656
buffer_load_dwordx4 v5, s[16:19], s46 offen offset:1024 lds
v_exp_f32 v186, v186
v_mfma_f32_32x32x16_bf16 v[56:71], v[164:167], a[248:251], v[56:71]
v_exp_f32 v187, v187
v_fma_f32 v184, v184, v13, v13
v_fma_f32 v185, v185, v13, v13
v_fma_f32 v186, v186, v13, v13
v_fma_f32 v187, v187, v13, v13
v_mfma_f32_32x32x16_bf16 v[72:87], v[164:167], a[252:255], v[72:87]
v_rcp_f32 v184, v184
s_add_u32 s73, s7, 534528
s_add_u32 s74, s7, 552960
s_add_u32 s75, s7, 571392
s_waitcnt vmcnt(19) lgkmcnt(0)
ds_read_b64_tr_b16 v[160:161], v172 offset:32768
ds_read_b64_tr_b16 v[162:163], v172 offset:33280
v_mfma_f32_32x32x16_bf16 v[24:39], v[152:155], v[224:227], v[24:39]
ds_read_b64_tr_b16 v[164:165], v173 offset:32768
v_rcp_f32 v185, v185
v_mfma_f32_32x32x16_bf16 v[40:55], v[152:155], v[228:231], v[40:55]
ds_read_b64_tr_b16 v[166:167], v173 offset:33280
v_rcp_f32 v186, v186
v_rcp_f32 v187, v187
v_mfma_f32_32x32x16_bf16 v[56:71], v[156:159], v[224:227], v[56:71]
v_mul_f32 v184, v144, v184
v_mul_f32 v185, v145, v185
v_mul_f32 v186, v146, v186
v_mul_f32 v187, v147, v187
v_cvt_pk_bf16_f32 v220, v184, v185
v_cvt_pk_bf16_f32 v221, v186, v187
v_mfma_f32_32x32x16_bf16 v[72:87], v[156:159], v[228:231], v[72:87]
v_mul_f32 v188, v148, v11
v_mul_f32 v189, v149, v11
v_mul_f32 v190, v150, v11
s_add_u32 s76, s2, 0
s_add_u32 s77, s2, 18432
s_add_u32 s78, s2, 36864
s_waitcnt vmcnt(17) lgkmcnt(0)
ds_read_b64_tr_b16 v[152:153], v172 offset:34816
ds_read_b64_tr_b16 v[154:155], v172 offset:35328
s_add_u32 m0, s33, 32768
v_mfma_f32_32x32x16_bf16 v[24:39], v[160:163], v[232:235], v[24:39]
ds_read_b64_tr_b16 v[156:157], v173 offset:34816
buffer_load_dwordx4 v4, s[16:19], s47 offen lds
v_mul_f32 v191, v151, v11
v_mfma_f32_32x32x16_bf16 v[40:55], v[160:163], v[236:239], v[40:55]
ds_read_b64_tr_b16 v[158:159], v173 offset:35328
buffer_load_dwordx4 v5, s[16:19], s47 offen offset:1024 lds
v_exp_f32 v188, v188
v_exp_f32 v189, v189
v_mfma_f32_32x32x16_bf16 v[56:71], v[164:167], v[232:235], v[56:71]
v_exp_f32 v190, v190
v_exp_f32 v191, v191
v_fma_f32 v188, v188, v13, v13
v_mfma_f32_32x32x16_bf16 v[72:87], v[164:167], v[236:239], v[72:87]
v_fma_f32 v189, v189, v13, v13
v_fma_f32 v190, v190, v13, v13
v_fma_f32 v191, v191, v13, v13
s_add_u32 s79, s2, 55296
s_add_u32 s80, s2, 73728
s_waitcnt vmcnt(17) lgkmcnt(0)
ds_read_b64_tr_b16 v[160:161], v172 offset:36864
ds_read_b64_tr_b16 v[162:163], v172 offset:37376
s_add_u32 m0, s33, 34816
v_mfma_f32_32x32x16_bf16 v[24:39], v[152:155], v[240:243], v[24:39]
ds_read_b64_tr_b16 v[164:165], v173 offset:36864
buffer_load_dwordx4 v4, s[16:19], s48 offen lds
v_rcp_f32 v188, v188
v_mfma_f32_32x32x16_bf16 v[40:55], v[152:155], v[244:247], v[40:55]
ds_read_b64_tr_b16 v[166:167], v173 offset:37376
buffer_load_dwordx4 v5, s[16:19], s48 offen offset:1024 lds
v_rcp_f32 v189, v189
v_rcp_f32 v190, v190
v_mfma_f32_32x32x16_bf16 v[56:71], v[156:159], v[240:243], v[56:71]
v_rcp_f32 v191, v191
v_mul_f32 v188, v148, v188
v_mul_f32 v189, v149, v189
v_mul_f32 v190, v150, v190
v_mfma_f32_32x32x16_bf16 v[72:87], v[156:159], v[244:247], v[72:87]
v_mul_f32 v191, v151, v191
v_cvt_pk_bf16_f32 v222, v188, v189
v_cvt_pk_bf16_f32 v223, v190, v191
s_waitcnt vmcnt(17) lgkmcnt(0)
ds_read_b64_tr_b16 v[152:153], v172 offset:38912
ds_read_b64_tr_b16 v[154:155], v172 offset:39424
v_mfma_f32_32x32x16_bf16 v[88:103], v[160:163], v[248:251], v[24:39]
ds_read_b64_tr_b16 v[156:157], v173 offset:38912
v_mfma_f32_32x32x16_bf16 v[104:119], v[160:163], v[252:255], v[40:55]
ds_read_b64_tr_b16 v[158:159], v173 offset:39424
v_mfma_f32_32x32x16_bf16 v[120:135], v[164:167], v[248:251], v[56:71]
v_mfma_f32_32x32x16_bf16 v[136:151], v[164:167], v[252:255], v[72:87]
ds_write_b128 v16, v[192:195] offset:0
ds_write_b128 v16, v[196:199] offset:2048
ds_write_b128 v16, v[200:203] offset:1024
ds_write_b128 v16, v[204:207] offset:3072
ds_write_b128 v16, v[208:211] offset:4096
ds_write_b128 v16, v[212:215] offset:6144
ds_write_b128 v16, v[216:219] offset:5120
ds_write_b128 v16, v[220:223] offset:7168
s_mov_b32 s16, s36
s_mov_b32 s17, s37
s_mov_b32 s18, 5308416
s_mov_b32 s19, 0x20000
s_mov_b32 s12, s36
s_mov_b32 s13, s37
s_mov_b32 s14, 5308416
s_mov_b32 s15, 0x20000
s_add_u32 s40, s7, 0
s_add_u32 s41, s7, 18432
s_add_u32 s42, s7, 36864
s_add_u32 s43, s7, 55296
s_add_u32 s44, s7, 73728
s_add_u32 s45, s7, 92160
s_add_u32 s46, s7, 110592
s_add_u32 s47, s7, 129024
s_add_u32 s48, s7, 147456
s_add_u32 s95, s4, s5
s_add_u32 s95, s95, 0
s_and_b32 s95, s95, 7
s_cmp_eq_u32 s5, 0
s_cselect_b32 s95, 8, s95
s_lshl_b32 s93, s95, 7
v_mul_u32_u24 v4, 1152, v18
v_add3_u32 v4, v4, v19, s93
v_add_u32 v5, 8192, v4
s_cmp_eq_u32 s5, 1
s_cbranch_scc1 L_sf1
s_cmp_eq_u32 s5, 2
s_cbranch_scc1 L_sf2
s_cmp_eq_u32 s5, 3
s_cbranch_scc1 L_sf3
L_sf0:
s_waitcnt vmcnt(15) lgkmcnt(0)
ds_read_b64_tr_b16 v[160:161], v6 offset:0
ds_read_b64_tr_b16 v[162:163], v6 offset:512
v_mfma_f32_32x32x16_bf16 v[24:39], v[152:155], a[0:3], 0
ds_read_b64_tr_b16 v[164:165], v7 offset:0
v_mfma_f32_32x32x16_bf16 v[40:55], v[152:155], a[4:7], 0
ds_read_b64_tr_b16 v[166:167], v7 offset:512
s_waitcnt vmcnt(8)
v_cmp_ne_u32 vcc, s39, v169
s_and_b32 vcc_lo, vcc_lo, 0xffffffff
s_mov_b32 vcc_hi, 0
s_cbranch_vccnz L_c1_0_slow
L_c1_0_ret:
v_mfma_f32_32x32x16_bf16 v[56:71], v[156:159], a[0:3], 0
v_lshrrev_b32 v21, 3, v1
v_lshlrev_b32 v21, 11, v21
v_and_b32 v22, 7, v1
v_lshl_add_u32 v21, v22, 4, v21
buffer_load_dwordx4 v[208:211], v21, s[20:23], s97 offen sc1
s_add_u32 s97, s97, 16384
buffer_load_dwordx4 v[212:215], v21, s[20:23], s97 offen sc1
s_add_u32 s97, s97, 16384
buffer_load_dwordx4 v[216:219], v21, s[20:23], s97 offen sc1
s_add_u32 s97, s97, 16384
buffer_load_dwordx4 v[220:223], v21, s[20:23], s97 offen sc1
v_mfma_f32_32x32x16_bf16 v[72:87], v[156:159], a[4:7], 0
s_waitcnt lgkmcnt(0)
ds_read_b64_tr_b16 v[152:153], v6 offset:2048
ds_read_b64_tr_b16 v[154:155], v6 offset:2560
v_mfma_f32_32x32x16_bf16 v[24:39], v[160:163], a[8:11], v[24:39]
ds_read_b64_tr_b16 v[156:157], v7 offset:2048
s_mov_b32 s92, s36
s_mov_b32 s93, s37
s_mov_b32 s94, 5308416
s_mov_b32 s95, 0x20000
v_add_u32 v170, 0, v1
v_cmp_le_u32 vcc, 162, v170
v_lshlrev_b32 v170, 7, v170
v_mov_b32 v171, 0x7f000000
s_mul_i32 s87, s3, 20736
s_add_u32 s87, s87, s7
v_cndmask_b32 v170, v170, v171, vcc
v_mfma_f32_32x32x16_bf16 v[40:55], v[160:163], a[12:15], v[40:55]
ds_read_b64_tr_b16 v[158:159], v7 offset:2560
buffer_load_dword v174, v170, s[92:95], s87 offen
v_mfma_f32_32x32x16_bf16 v[56:71], v[164:167], a[8:11], v[56:71]
s_mul_i32 s87, s3, 2688
s_add_u32 s87, s87, s2
v_cmp_gt_u32 vcc, 21, v1
v_lshlrev_b32 v170, 7, v1
s_nop 0
v_cndmask_b32 v170, v171, v170, vcc
v_mfma_f32_32x32x16_bf16 v[72:87], v[164:167], a[12:15], v[72:87]
buffer_load_dword v175, v170, s[28:31], s87 offen
s_waitcnt lgkmcnt(0)
ds_read_b64_tr_b16 v[160:161], v6 offset:4096
ds_read_b64_tr_b16 v[162:163], v6 offset:4608
v_mfma_f32_32x32x16_bf16 v[24:39], v[152:155], a[16:19], v[24:39]
ds_read_b64_tr_b16 v[164:165], v7 offset:4096
v_mfma_f32_32x32x16_bf16 v[40:55], v[152:155], a[20:23], v[40:55]
ds_read_b64_tr_b16 v[166:167], v7 offset:4608
v_mfma_f32_32x32x16_bf16 v[56:71], v[156:159], a[16:19], v[56:71]
v_mfma_f32_32x32x16_bf16 v[72:87], v[156:159], a[20:23], v[72:87]
s_waitcnt lgkmcnt(0)
ds_read_b64_tr_b16 v[152:153], v6 offset:6144
ds_read_b64_tr_b16 v[154:155], v6 offset:6656
v_mfma_f32_32x32x16_bf16 v[24:39], v[160:163], a[24:27], v[24:39]
ds_read_b64_tr_b16 v[156:157], v7 offset:6144
v_mfma_f32_32x32x16_bf16 v[40:55], v[160:163], a[28:31], v[40:55]
ds_read_b64_tr_b16 v[158:159], v7 offset:6656
v_mfma_f32_32x32x16_bf16 v[56:71], v[164:167], a[24:27], v[56:71]
v_mfma_f32_32x32x16_bf16 v[72:87], v[164:167], a[28:31], v[72:87]
s_waitcnt vmcnt(12) lgkmcnt(0)
ds_read_b64_tr_b16 v[160:161], v6 offset:8192
ds_read_b64_tr_b16 v[162:163], v6 offset:8704
v_mfma_f32_32x32x16_bf16 v[24:39], v[152:155], a[32:35], v[24:39]
ds_read_b64_tr_b16 v[164:165], v7 offset:8192
v_mfma_f32_32x32x16_bf16 v[40:55], v[152:155], a[36:39], v[40:55]
ds_read_b64_tr_b16 v[166:167], v7 offset:8704
v_mfma_f32_32x32x16_bf16 v[56:71], v[156:159], a[32:35], v[56:71]
v_mfma_f32_32x32x16_bf16 v[72:87], v[156:159], a[36:39], v[72:87]
s_waitcnt vmcnt(10) lgkmcnt(0)
ds_read_b64_tr_b16 v[152:153], v6 offset:10240
ds_read_b64_tr_b16 v[154:155], v6 offset:10752
v_mfma_f32_32x32x16_bf16 v[24:39], v[160:163], a[40:43], v[24:39]
ds_read_b64_tr_b16 v[156:157], v7 offset:10240
v_mfma_f32_32x32x16_bf16 v[40:55], v[160:163], a[44:47], v[40:55]
ds_read_b64_tr_b16 v[158:159], v7 offset:10752
v_mfma_f32_32x32x16_bf16 v[56:71], v[164:167], a[40:43], v[56:71]
v_mfma_f32_32x32x16_bf16 v[72:87], v[164:167], a[44:47], v[72:87]
s_waitcnt vmcnt(8) lgkmcnt(0)
ds_read_b64_tr_b16 v[160:161], v172 offset:32768
ds_read_b64_tr_b16 v[162:163], v172 offset:33280
v_mfma_f32_32x32x16_bf16 v[24:39], v[152:155], a[48:51], v[24:39]
ds_read_b64_tr_b16 v[164:165], v173 offset:32768
v_mfma_f32_32x32x16_bf16 v[40:55], v[152:155], a[52:55], v[40:55]
ds_read_b64_tr_b16 v[166:167], v173 offset:33280
v_mfma_f32_32x32x16_bf16 v[56:71], v[156:159], a[48:51], v[56:71]
v_mfma_f32_32x32x16_bf16 v[72:87], v[156:159], a[52:55], v[72:87]
s_waitcnt vmcnt(6) lgkmcnt(0)
ds_read_b64_tr_b16 v[152:153], v172 offset:34816
ds_read_b64_tr_b16 v[154:155], v172 offset:35328
v_mfma_f32_32x32x16_bf16 v[24:39], v[160:163], a[56:59], v[24:39]
ds_read_b64_tr_b16 v[156:157], v173 offset:34816
v_mfma_f32_32x32x16_bf16 v[40:55], v[160:163], a[60:63], v[40:55]
ds_read_b64_tr_b16 v[158:159], v173 offset:35328
v_mfma_f32_32x32x16_bf16 v[56:71], v[164:167], a[56:59], v[56:71]
v_mfma_f32_32x32x16_bf16 v[72:87], v[164:167], a[60:63], v[72:87]
s_waitcnt lgkmcnt(0)
v_mfma_f32_32x32x16_bf16 v[24:39], v[152:155], a[64:67], v[24:39]
v_mfma_f32_32x32x16_bf16 v[40:55], v[152:155], a[68:71], v[40:55]
v_mfma_f32_32x32x16_bf16 v[56:71], v[156:159], a[64:67], v[56:71]
v_mfma_f32_32x32x16_bf16 v[72:87], v[156:159], a[68:71], v[72:87]
s_nop 15
v_add_u32 v21, s38, v17
ds_write_b128 v21, v[40:43] offset:0
ds_write_b128 v21, v[44:47] offset:1024
ds_write_b128 v21, v[48:51] offset:2048
ds_write_b128 v21, v[52:55] offset:3072
ds_write_b128 v21, v[56:59] offset:4096
ds_write_b128 v21, v[60:63] offset:5120
ds_write_b128 v21, v[64:67] offset:6144
ds_write_b128 v21, v[68:71] offset:7168
ds_write_b128 v21, v[72:75] offset:8192
ds_write_b128 v21, v[76:79] offset:9216
ds_write_b128 v21, v[80:83] offset:10240
ds_write_b128 v21, v[84:87] offset:11264
s_waitcnt lgkmcnt(0)
s_barrier
v_add_u32 v21, 0, v17
ds_read_b128 v[176:179], v21 offset:12288
ds_read_b128 v[180:183], v21 offset:13312
ds_read_b128 v[184:187], v21 offset:14336
ds_read_b128 v[188:191], v21 offset:15360
ds_read_b128 v[192:195], v21 offset:24576
ds_read_b128 v[196:199], v21 offset:25600
ds_read_b128 v[200:203], v21 offset:26624
ds_read_b128 v[204:207], v21 offset:27648
ds_read_b128 v[40:43], v21 offset:36864
ds_read_b128 v[44:47], v21 offset:37888
ds_read_b128 v[48:51], v21 offset:38912
ds_read_b128 v[52:55], v21 offset:39936
s_waitcnt lgkmcnt(8)
v_add_f32 v24, v24, v176
v_add_f32 v25, v25, v177
v_add_f32 v26, v26, v178
v_add_f32 v27, v27, v179
v_add_f32 v28, v28, v180
v_add_f32 v29, v29, v181
v_add_f32 v30, v30, v182
v_add_f32 v31, v31, v183
v_add_f32 v32, v32, v184
v_add_f32 v33, v33, v185
v_add_f32 v34, v34, v186
v_add_f32 v35, v35, v187
v_add_f32 v36, v36, v188
v_add_f32 v37, v37, v189
v_add_f32 v38, v38, v190
v_add_f32 v39, v39, v191
s_waitcnt lgkmcnt(4)
v_add_f32 v24, v24, v192
v_add_f32 v25, v25, v193
v_add_f32 v26, v26, v194
v_add_f32 v27, v27, v195
v_add_f32 v28, v28, v196
v_add_f32 v29, v29, v197
v_add_f32 v30, v30, v198
v_add_f32 v31, v31, v199
v_add_f32 v32, v32, v200
v_add_f32 v33, v33, v201
v_add_f32 v34, v34, v202
v_add_f32 v35, v35, v203
v_add_f32 v36, v36, v204
v_add_f32 v37, v37, v205
v_add_f32 v38, v38, v206
v_add_f32 v39, v39, v207
s_waitcnt lgkmcnt(0)
v_add_f32 v24, v24, v40
v_add_f32 v25, v25, v41
v_add_f32 v26, v26, v42
v_add_f32 v27, v27, v43
v_add_f32 v28, v28, v44
v_add_f32 v29, v29, v45
v_add_f32 v30, v30, v46
v_add_f32 v31, v31, v47
v_add_f32 v32, v32, v48
v_add_f32 v33, v33, v49
v_add_f32 v34, v34, v50
v_add_f32 v35, v35, v51
v_add_f32 v36, v36, v52
v_add_f32 v37, v37, v53
v_add_f32 v38, v38, v54
v_add_f32 v39, v39, v55
v_add_u32 v21, 114688, v17
v_mul_f32 v56, v24, v10
v_mul_f32 v57, v25, v10
v_mul_f32 v58, v26, v10
v_mul_f32 v59, v27, v10
v_exp_f32 v56, v56
v_exp_f32 v57, v57
v_exp_f32 v58, v58
v_exp_f32 v59, v59
v_fma_f32 v56, v56, v12, v12
v_fma_f32 v57, v57, v12, v12
v_fma_f32 v58, v58, v12, v12
v_fma_f32 v59, v59, v12, v12
v_rcp_f32 v56, v56
v_rcp_f32 v57, v57
v_rcp_f32 v58, v58
v_rcp_f32 v59, v59
v_mul_f32 v56, v24, v56
v_mul_f32 v57, v25, v57
v_mul_f32 v58, v26, v58
v_mul_f32 v59, v27, v59
v_cvt_pk_bf16_f32 v176, v56, v57
v_cvt_pk_bf16_f32 v177, v58, v59
v_mul_f32 v60, v28, v10
v_mul_f32 v61, v29, v10
v_mul_f32 v62, v30, v10
v_mul_f32 v63, v31, v10
v_exp_f32 v60, v60
v_exp_f32 v61, v61
v_exp_f32 v62, v62
v_exp_f32 v63, v63
v_fma_f32 v60, v60, v12, v12
v_fma_f32 v61, v61, v12, v12
v_fma_f32 v62, v62, v12, v12
v_fma_f32 v63, v63, v12, v12
v_rcp_f32 v60, v60
v_rcp_f32 v61, v61
v_rcp_f32 v62, v62
v_rcp_f32 v63, v63
v_mul_f32 v60, v28, v60
v_mul_f32 v61, v29, v61
v_mul_f32 v62, v30, v62
v_mul_f32 v63, v31, v63
v_cvt_pk_bf16_f32 v178, v60, v61
v_cvt_pk_bf16_f32 v179, v62, v63
ds_write_b128 v21, v[176:179] offset:0
v_mul_f32 v64, v32, v10
v_mul_f32 v65, v33, v10
v_mul_f32 v66, v34, v10
v_mul_f32 v67, v35, v10
v_exp_f32 v64, v64
v_exp_f32 v65, v65
v_exp_f32 v66, v66
v_exp_f32 v67, v67
v_fma_f32 v64, v64, v12, v12
v_fma_f32 v65, v65, v12, v12
v_fma_f32 v66, v66, v12, v12
v_fma_f32 v67, v67, v12, v12
v_rcp_f32 v64, v64
v_rcp_f32 v65, v65
v_rcp_f32 v66, v66
v_rcp_f32 v67, v67
v_mul_f32 v64, v32, v64
v_mul_f32 v65, v33, v65
v_mul_f32 v66, v34, v66
v_mul_f32 v67, v35, v67
v_cvt_pk_bf16_f32 v180, v64, v65
v_cvt_pk_bf16_f32 v181, v66, v67
v_mul_f32 v68, v36, v10
v_mul_f32 v69, v37, v10
v_mul_f32 v70, v38, v10
v_mul_f32 v71, v39, v10
v_exp_f32 v68, v68
v_exp_f32 v69, v69
v_exp_f32 v70, v70
v_exp_f32 v71, v71
v_fma_f32 v68, v68, v12, v12
v_fma_f32 v69, v69, v12, v12
v_fma_f32 v70, v70, v12, v12
v_fma_f32 v71, v71, v12, v12
v_rcp_f32 v68, v68
v_rcp_f32 v69, v69
v_rcp_f32 v70, v70
v_rcp_f32 v71, v71
v_mul_f32 v68, v36, v68
v_mul_f32 v69, v37, v69
v_mul_f32 v70, v38, v70
v_mul_f32 v71, v39, v71
v_cvt_pk_bf16_f32 v182, v68, v69
v_cvt_pk_bf16_f32 v183, v70, v71
ds_write_b128 v21, v[180:183] offset:2048
s_waitcnt vmcnt(2)
v_add_f32 v208, v208, v212
v_add_f32 v216, v216, v220
v_add_f32 v209, v209, v213
v_add_f32 v217, v217, v221
v_add_f32 v210, v210, v214
v_add_f32 v218, v218, v222
v_add_f32 v211, v211, v215
v_add_f32 v219, v219, v223
v_add_f32 v208, v208, v216
v_add_f32 v209, v209, v217
v_add_f32 v210, v210, v218
v_add_f32 v211, v211, v219
s_nop 1
v_add_f32_dpp v208, v208, v208 row_ror:8 row_mask:0xf bank_mask:0xf
v_add_f32_dpp v209, v209, v209 row_ror:8 row_mask:0xf bank_mask:0xf
v_add_f32_dpp v210, v210, v210 row_ror:8 row_mask:0xf bank_mask:0xf
v_add_f32_dpp v211, v211, v211 row_ror:8 row_mask:0xf bank_mask:0xf
v_mov_b32 v212, v208
v_mov_b32 v213, v209
v_mov_b32 v214, v210
v_mov_b32 v215, v211
s_nop 1
v_permlane16_swap_b32 v208, v212
v_permlane16_swap_b32 v209, v213
v_permlane16_swap_b32 v210, v214
v_permlane16_swap_b32 v211, v215
s_nop 1
v_add_f32 v208, v208, v212
v_add_f32 v209, v209, v213
v_add_f32 v210, v210, v214
v_add_f32 v211, v211, v215
v_mov_b32 v212, v208
v_mov_b32 v213, v209
v_mov_b32 v214, v210
v_mov_b32 v215, v211
s_nop 1
v_permlane32_swap_b32 v208, v212
v_permlane32_swap_b32 v209, v213
v_permlane32_swap_b32 v210, v214
v_permlane32_swap_b32 v211, v215
s_nop 1
v_add_f32 v208, v208, v212
v_add_f32 v209, v209, v213
v_add_f32 v210, v210, v214
v_add_f32 v211, v211, v215
v_cmp_gt_u32 vcc, 8, v1
s_and_saveexec_b64 s[0:1], vcc
buffer_store_dwordx4 v[208:211], v17, s[20:23], s98 offen sc1
s_mov_b64 exec, s[0:1]
s_branch L_sf_done
L_sf1:
s_waitcnt vmcnt(15) lgkmcnt(0)
ds_read_b64_tr_b16 v[160:161], v6 offset:0
ds_read_b64_tr_b16 v[162:163], v6 offset:512
v_mfma_f32_32x32x16_bf16 v[24:39], v[152:155], a[72:75], 0
ds_read_b64_tr_b16 v[164:165], v7 offset:0
v_mfma_f32_32x32x16_bf16 v[40:55], v[152:155], a[76:79], 0
ds_read_b64_tr_b16 v[166:167], v7 offset:512
s_waitcnt vmcnt(8)
v_cmp_ne_u32 vcc, s39, v169
s_and_b32 vcc_lo, vcc_lo, 0xffffffff
s_mov_b32 vcc_hi, 0
s_cbranch_vccnz L_c1_1_slow
L_c1_1_ret:
v_mfma_f32_32x32x16_bf16 v[56:71], v[156:159], a[72:75], 0
v_lshrrev_b32 v21, 3, v1
v_lshlrev_b32 v21, 11, v21
v_and_b32 v22, 7, v1
v_lshl_add_u32 v21, v22, 4, v21
buffer_load_dwordx4 v[208:211], v21, s[20:23], s97 offen sc1
s_add_u32 s97, s97, 16384
buffer_load_dwordx4 v[212:215], v21, s[20:23], s97 offen sc1
s_add_u32 s97, s97, 16384
buffer_load_dwordx4 v[216:219], v21, s[20:23], s97 offen sc1
s_add_u32 s97, s97, 16384
buffer_load_dwordx4 v[220:223], v21, s[20:23], s97 offen sc1
v_mfma_f32_32x32x16_bf16 v[72:87], v[156:159], a[76:79], 0
s_waitcnt lgkmcnt(0)
ds_read_b64_tr_b16 v[152:153], v6 offset:2048
ds_read_b64_tr_b16 v[154:155], v6 offset:2560
v_mfma_f32_32x32x16_bf16 v[24:39], v[160:163], a[80:83], v[24:39]
ds_read_b64_tr_b16 v[156:157], v7 offset:2048
s_mov_b32 s92, s36
s_mov_b32 s93, s37
s_mov_b32 s94, 5308416
s_mov_b32 s95, 0x20000
v_add_u32 v170, 64, v1
v_cmp_le_u32 vcc, 162, v170
v_lshlrev_b32 v170, 7, v170
v_mov_b32 v171, 0x7f000000
s_mul_i32 s87, s3, 20736
s_add_u32 s87, s87, s7
v_cndmask_b32 v170, v170, v171, vcc
v_mfma_f32_32x32x16_bf16 v[40:55], v[160:163], a[84:87], v[40:55]
ds_read_b64_tr_b16 v[158:159], v7 offset:2560
buffer_load_dword v174, v170, s[92:95], s87 offen
v_mfma_f32_32x32x16_bf16 v[56:71], v[164:167], a[80:83], v[56:71]
v_mfma_f32_32x32x16_bf16 v[72:87], v[164:167], a[84:87], v[72:87]
s_waitcnt lgkmcnt(0)
ds_read_b64_tr_b16 v[160:161], v6 offset:4096
ds_read_b64_tr_b16 v[162:163], v6 offset:4608
v_mfma_f32_32x32x16_bf16 v[24:39], v[152:155], a[88:91], v[24:39]
ds_read_b64_tr_b16 v[164:165], v7 offset:4096
v_mfma_f32_32x32x16_bf16 v[40:55], v[152:155], a[92:95], v[40:55]
ds_read_b64_tr_b16 v[166:167], v7 offset:4608
v_mfma_f32_32x32x16_bf16 v[56:71], v[156:159], a[88:91], v[56:71]
v_mfma_f32_32x32x16_bf16 v[72:87], v[156:159], a[92:95], v[72:87]
s_waitcnt lgkmcnt(0)
ds_read_b64_tr_b16 v[152:153], v6 offset:6144
ds_read_b64_tr_b16 v[154:155], v6 offset:6656
v_mfma_f32_32x32x16_bf16 v[24:39], v[160:163], a[96:99], v[24:39]
ds_read_b64_tr_b16 v[156:157], v7 offset:6144
v_mfma_f32_32x32x16_bf16 v[40:55], v[160:163], a[100:103], v[40:55]
ds_read_b64_tr_b16 v[158:159], v7 offset:6656
v_mfma_f32_32x32x16_bf16 v[56:71], v[164:167], a[96:99], v[56:71]
v_mfma_f32_32x32x16_bf16 v[72:87], v[164:167], a[100:103], v[72:87]
s_waitcnt vmcnt(11) lgkmcnt(0)
ds_read_b64_tr_b16 v[160:161], v6 offset:8192
ds_read_b64_tr_b16 v[162:163], v6 offset:8704
v_mfma_f32_32x32x16_bf16 v[24:39], v[152:155], a[104:107], v[24:39]
ds_read_b64_tr_b16 v[164:165], v7 offset:8192
v_mfma_f32_32x32x16_bf16 v[40:55], v[152:155], a[108:111], v[40:55]
ds_read_b64_tr_b16 v[166:167], v7 offset:8704
v_mfma_f32_32x32x16_bf16 v[56:71], v[156:159], a[104:107], v[56:71]
v_mfma_f32_32x32x16_bf16 v[72:87], v[156:159], a[108:111], v[72:87]
s_waitcnt vmcnt(9) lgkmcnt(0)
ds_read_b64_tr_b16 v[152:153], v6 offset:10240
ds_read_b64_tr_b16 v[154:155], v6 offset:10752
v_mfma_f32_32x32x16_bf16 v[24:39], v[160:163], a[112:115], v[24:39]
ds_read_b64_tr_b16 v[156:157], v7 offset:10240
v_mfma_f32_32x32x16_bf16 v[40:55], v[160:163], a[116:119], v[40:55]
ds_read_b64_tr_b16 v[158:159], v7 offset:10752
v_mfma_f32_32x32x16_bf16 v[56:71], v[164:167], a[112:115], v[56:71]
v_mfma_f32_32x32x16_bf16 v[72:87], v[164:167], a[116:119], v[72:87]
s_waitcnt vmcnt(7) lgkmcnt(0)
ds_read_b64_tr_b16 v[160:161], v172 offset:32768
ds_read_b64_tr_b16 v[162:163], v172 offset:33280
v_mfma_f32_32x32x16_bf16 v[24:39], v[152:155], a[120:123], v[24:39]
ds_read_b64_tr_b16 v[164:165], v173 offset:32768
v_mfma_f32_32x32x16_bf16 v[40:55], v[152:155], a[124:127], v[40:55]
ds_read_b64_tr_b16 v[166:167], v173 offset:33280
v_mfma_f32_32x32x16_bf16 v[56:71], v[156:159], a[120:123], v[56:71]
v_mfma_f32_32x32x16_bf16 v[72:87], v[156:159], a[124:127], v[72:87]
s_waitcnt vmcnt(5) lgkmcnt(0)
ds_read_b64_tr_b16 v[152:153], v172 offset:34816
ds_read_b64_tr_b16 v[154:155], v172 offset:35328
v_mfma_f32_32x32x16_bf16 v[24:39], v[160:163], a[128:131], v[24:39]
ds_read_b64_tr_b16 v[156:157], v173 offset:34816
v_mfma_f32_32x32x16_bf16 v[40:55], v[160:163], a[132:135], v[40:55]
ds_read_b64_tr_b16 v[158:159], v173 offset:35328
v_mfma_f32_32x32x16_bf16 v[56:71], v[164:167], a[128:131], v[56:71]
v_mfma_f32_32x32x16_bf16 v[72:87], v[164:167], a[132:135], v[72:87]
s_waitcnt lgkmcnt(0)
v_mfma_f32_32x32x16_bf16 v[24:39], v[152:155], a[136:139], v[24:39]
v_mfma_f32_32x32x16_bf16 v[40:55], v[152:155], a[140:143], v[40:55]
v_mfma_f32_32x32x16_bf16 v[56:71], v[156:159], a[136:139], v[56:71]
v_mfma_f32_32x32x16_bf16 v[72:87], v[156:159], a[140:143], v[72:87]
s_nop 15
v_add_u32 v21, s38, v17
ds_write_b128 v21, v[24:27] offset:0
ds_write_b128 v21, v[28:31] offset:1024
ds_write_b128 v21, v[32:35] offset:2048
ds_write_b128 v21, v[36:39] offset:3072
ds_write_b128 v21, v[56:59] offset:4096
ds_write_b128 v21, v[60:63] offset:5120
ds_write_b128 v21, v[64:67] offset:6144
ds_write_b128 v21, v[68:71] offset:7168
ds_write_b128 v21, v[72:75] offset:8192
ds_write_b128 v21, v[76:79] offset:9216
ds_write_b128 v21, v[80:83] offset:10240
ds_write_b128 v21, v[84:87] offset:11264
s_waitcnt lgkmcnt(0)
s_barrier
v_add_u32 v21, 0, v17
ds_read_b128 v[176:179], v21 offset:0
ds_read_b128 v[180:183], v21 offset:1024
ds_read_b128 v[184:187], v21 offset:2048
ds_read_b128 v[188:191], v21 offset:3072
ds_read_b128 v[192:195], v21 offset:28672
ds_read_b128 v[196:199], v21 offset:29696
ds_read_b128 v[200:203], v21 offset:30720
ds_read_b128 v[204:207], v21 offset:31744
ds_read_b128 v[56:59], v21 offset:40960
ds_read_b128 v[60:63], v21 offset:41984
ds_read_b128 v[64:67], v21 offset:43008
ds_read_b128 v[68:71], v21 offset:44032
s_waitcnt lgkmcnt(8)
v_add_f32 v40, v40, v176
v_add_f32 v41, v41, v177
v_add_f32 v42, v42, v178
v_add_f32 v43, v43, v179
v_add_f32 v44, v44, v180
v_add_f32 v45, v45, v181
v_add_f32 v46, v46, v182
v_add_f32 v47, v47, v183
v_add_f32 v48, v48, v184
v_add_f32 v49, v49, v185
v_add_f32 v50, v50, v186
v_add_f32 v51, v51, v187
v_add_f32 v52, v52, v188
v_add_f32 v53, v53, v189
v_add_f32 v54, v54, v190
v_add_f32 v55, v55, v191
s_waitcnt lgkmcnt(4)
v_add_f32 v40, v40, v192
v_add_f32 v41, v41, v193
v_add_f32 v42, v42, v194
v_add_f32 v43, v43, v195
v_add_f32 v44, v44, v196
v_add_f32 v45, v45, v197
v_add_f32 v46, v46, v198
v_add_f32 v47, v47, v199
v_add_f32 v48, v48, v200
v_add_f32 v49, v49, v201
v_add_f32 v50, v50, v202
v_add_f32 v51, v51, v203
v_add_f32 v52, v52, v204
v_add_f32 v53, v53, v205
v_add_f32 v54, v54, v206
v_add_f32 v55, v55, v207
s_waitcnt lgkmcnt(0)
v_add_f32 v40, v40, v56
v_add_f32 v41, v41, v57
v_add_f32 v42, v42, v58
v_add_f32 v43, v43, v59
v_add_f32 v44, v44, v60
v_add_f32 v45, v45, v61
v_add_f32 v46, v46, v62
v_add_f32 v47, v47, v63
v_add_f32 v48, v48, v64
v_add_f32 v49, v49, v65
v_add_f32 v50, v50, v66
v_add_f32 v51, v51, v67
v_add_f32 v52, v52, v68
v_add_f32 v53, v53, v69
v_add_f32 v54, v54, v70
v_add_f32 v55, v55, v71
v_add_u32 v21, 115712, v17
v_mul_f32 v72, v40, v11
v_mul_f32 v73, v41, v11
v_mul_f32 v74, v42, v11
v_mul_f32 v75, v43, v11
v_exp_f32 v72, v72
v_exp_f32 v73, v73
v_exp_f32 v74, v74
v_exp_f32 v75, v75
v_fma_f32 v72, v72, v13, v13
v_fma_f32 v73, v73, v13, v13
v_fma_f32 v74, v74, v13, v13
v_fma_f32 v75, v75, v13, v13
v_rcp_f32 v72, v72
v_rcp_f32 v73, v73
v_rcp_f32 v74, v74
v_rcp_f32 v75, v75
v_mul_f32 v72, v40, v72
v_mul_f32 v73, v41, v73
v_mul_f32 v74, v42, v74
v_mul_f32 v75, v43, v75
v_cvt_pk_bf16_f32 v176, v72, v73
v_cvt_pk_bf16_f32 v177, v74, v75
v_mul_f32 v76, v44, v11
v_mul_f32 v77, v45, v11
v_mul_f32 v78, v46, v11
v_mul_f32 v79, v47, v11
v_exp_f32 v76, v76
v_exp_f32 v77, v77
v_exp_f32 v78, v78
v_exp_f32 v79, v79
v_fma_f32 v76, v76, v13, v13
v_fma_f32 v77, v77, v13, v13
v_fma_f32 v78, v78, v13, v13
v_fma_f32 v79, v79, v13, v13
v_rcp_f32 v76, v76
v_rcp_f32 v77, v77
v_rcp_f32 v78, v78
v_rcp_f32 v79, v79
v_mul_f32 v76, v44, v76
v_mul_f32 v77, v45, v77
v_mul_f32 v78, v46, v78
v_mul_f32 v79, v47, v79
v_cvt_pk_bf16_f32 v178, v76, v77
v_cvt_pk_bf16_f32 v179, v78, v79
ds_write_b128 v21, v[176:179] offset:0
v_mul_f32 v80, v48, v11
v_mul_f32 v81, v49, v11
v_mul_f32 v82, v50, v11
v_mul_f32 v83, v51, v11
v_exp_f32 v80, v80
v_exp_f32 v81, v81
v_exp_f32 v82, v82
v_exp_f32 v83, v83
v_fma_f32 v80, v80, v13, v13
v_fma_f32 v81, v81, v13, v13
v_fma_f32 v82, v82, v13, v13
v_fma_f32 v83, v83, v13, v13
v_rcp_f32 v80, v80
v_rcp_f32 v81, v81
v_rcp_f32 v82, v82
v_rcp_f32 v83, v83
v_mul_f32 v80, v48, v80
v_mul_f32 v81, v49, v81
v_mul_f32 v82, v50, v82
v_mul_f32 v83, v51, v83
v_cvt_pk_bf16_f32 v180, v80, v81
v_cvt_pk_bf16_f32 v181, v82, v83
v_mul_f32 v84, v52, v11
v_mul_f32 v85, v53, v11
v_mul_f32 v86, v54, v11
v_mul_f32 v87, v55, v11
v_exp_f32 v84, v84
v_exp_f32 v85, v85
v_exp_f32 v86, v86
v_exp_f32 v87, v87
v_fma_f32 v84, v84, v13, v13
v_fma_f32 v85, v85, v13, v13
v_fma_f32 v86, v86, v13, v13
v_fma_f32 v87, v87, v13, v13
v_rcp_f32 v84, v84
v_rcp_f32 v85, v85
v_rcp_f32 v86, v86
v_rcp_f32 v87, v87
v_mul_f32 v84, v52, v84
v_mul_f32 v85, v53, v85
v_mul_f32 v86, v54, v86
v_mul_f32 v87, v55, v87
v_cvt_pk_bf16_f32 v182, v84, v85
v_cvt_pk_bf16_f32 v183, v86, v87
ds_write_b128 v21, v[180:183] offset:2048
s_waitcnt vmcnt(1)
v_add_f32 v208, v208, v212
v_add_f32 v216, v216, v220
v_add_f32 v209, v209, v213
v_add_f32 v217, v217, v221
v_add_f32 v210, v210, v214
v_add_f32 v218, v218, v222
v_add_f32 v211, v211, v215
v_add_f32 v219, v219, v223
v_add_f32 v208, v208, v216
v_add_f32 v209, v209, v217
v_add_f32 v210, v210, v218
v_add_f32 v211, v211, v219
s_nop 1
v_add_f32_dpp v208, v208, v208 row_ror:8 row_mask:0xf bank_mask:0xf
v_add_f32_dpp v209, v209, v209 row_ror:8 row_mask:0xf bank_mask:0xf
v_add_f32_dpp v210, v210, v210 row_ror:8 row_mask:0xf bank_mask:0xf
v_add_f32_dpp v211, v211, v211 row_ror:8 row_mask:0xf bank_mask:0xf
v_mov_b32 v212, v208
v_mov_b32 v213, v209
v_mov_b32 v214, v210
v_mov_b32 v215, v211
s_nop 1
v_permlane16_swap_b32 v208, v212
v_permlane16_swap_b32 v209, v213
v_permlane16_swap_b32 v210, v214
v_permlane16_swap_b32 v211, v215
s_nop 1
v_add_f32 v208, v208, v212
v_add_f32 v209, v209, v213
v_add_f32 v210, v210, v214
v_add_f32 v211, v211, v215
v_mov_b32 v212, v208
v_mov_b32 v213, v209
v_mov_b32 v214, v210
v_mov_b32 v215, v211
s_nop 1
v_permlane32_swap_b32 v208, v212
v_permlane32_swap_b32 v209, v213
v_permlane32_swap_b32 v210, v214
v_permlane32_swap_b32 v211, v215
s_nop 1
v_add_f32 v208, v208, v212
v_add_f32 v209, v209, v213
v_add_f32 v210, v210, v214
v_add_f32 v211, v211, v215
v_cmp_gt_u32 vcc, 8, v1
s_and_saveexec_b64 s[0:1], vcc
buffer_store_dwordx4 v[208:211], v17, s[20:23], s98 offen sc1
s_mov_b64 exec, s[0:1]
s_branch L_sf_done
L_sf2:
s_waitcnt vmcnt(15) lgkmcnt(0)
ds_read_b64_tr_b16 v[160:161], v6 offset:0
ds_read_b64_tr_b16 v[162:163], v6 offset:512
v_mfma_f32_32x32x16_bf16 v[24:39], v[152:155], a[144:147], 0
ds_read_b64_tr_b16 v[164:165], v7 offset:0
v_mfma_f32_32x32x16_bf16 v[40:55], v[152:155], a[148:151], 0
ds_read_b64_tr_b16 v[166:167], v7 offset:512
v_mfma_f32_32x32x16_bf16 v[56:71], v[156:159], a[144:147], 0
v_mfma_f32_32x32x16_bf16 v[72:87], v[156:159], a[148:151], 0
s_waitcnt vmcnt(13) lgkmcnt(0)
ds_read_b64_tr_b16 v[152:153], v6 offset:2048
ds_read_b64_tr_b16 v[154:155], v6 offset:2560
v_mfma_f32_32x32x16_bf16 v[24:39], v[160:163], a[152:155], v[24:39]
ds_read_b64_tr_b16 v[156:157], v7 offset:2048
s_mov_b32 s92, s36
s_mov_b32 s93, s37
s_mov_b32 s94, 5308416
s_mov_b32 s95, 0x20000
v_add_u32 v170, 128, v1
v_cmp_le_u32 vcc, 162, v170
v_lshlrev_b32 v170, 7, v170
v_mov_b32 v171, 0x7f000000
s_mul_i32 s87, s3, 20736
s_add_u32 s87, s87, s7
v_cndmask_b32 v170, v170, v171, vcc
v_mfma_f32_32x32x16_bf16 v[40:55], v[160:163], a[156:159], v[40:55]
ds_read_b64_tr_b16 v[158:159], v7 offset:2560
buffer_load_dword v174, v170, s[92:95], s87 offen
v_mfma_f32_32x32x16_bf16 v[56:71], v[164:167], a[152:155], v[56:71]
v_mfma_f32_32x32x16_bf16 v[72:87], v[164:167], a[156:159], v[72:87]
s_waitcnt vmcnt(12) lgkmcnt(0)
ds_read_b64_tr_b16 v[160:161], v6 offset:4096
ds_read_b64_tr_b16 v[162:163], v6 offset:4608
v_mfma_f32_32x32x16_bf16 v[24:39], v[152:155], a[160:163], v[24:39]
ds_read_b64_tr_b16 v[164:165], v7 offset:4096
v_mfma_f32_32x32x16_bf16 v[40:55], v[152:155], a[164:167], v[40:55]
ds_read_b64_tr_b16 v[166:167], v7 offset:4608
v_mfma_f32_32x32x16_bf16 v[56:71], v[156:159], a[160:163], v[56:71]
v_mfma_f32_32x32x16_bf16 v[72:87], v[156:159], a[164:167], v[72:87]
s_waitcnt vmcnt(10) lgkmcnt(0)
ds_read_b64_tr_b16 v[152:153], v6 offset:6144
ds_read_b64_tr_b16 v[154:155], v6 offset:6656
v_mfma_f32_32x32x16_bf16 v[24:39], v[160:163], a[168:171], v[24:39]
ds_read_b64_tr_b16 v[156:157], v7 offset:6144
v_mfma_f32_32x32x16_bf16 v[40:55], v[160:163], a[172:175], v[40:55]
ds_read_b64_tr_b16 v[158:159], v7 offset:6656
v_mfma_f32_32x32x16_bf16 v[56:71], v[164:167], a[168:171], v[56:71]
v_mfma_f32_32x32x16_bf16 v[72:87], v[164:167], a[172:175], v[72:87]
s_waitcnt vmcnt(7) lgkmcnt(0)
ds_read_b64_tr_b16 v[160:161], v6 offset:8192
ds_read_b64_tr_b16 v[162:163], v6 offset:8704
v_mfma_f32_32x32x16_bf16 v[24:39], v[152:155], a[176:179], v[24:39]
ds_read_b64_tr_b16 v[164:165], v7 offset:8192
v_mfma_f32_32x32x16_bf16 v[40:55], v[152:155], a[180:183], v[40:55]
ds_read_b64_tr_b16 v[166:167], v7 offset:8704
v_mfma_f32_32x32x16_bf16 v[56:71], v[156:159], a[176:179], v[56:71]
v_mfma_f32_32x32x16_bf16 v[72:87], v[156:159], a[180:183], v[72:87]
s_waitcnt vmcnt(5) lgkmcnt(0)
ds_read_b64_tr_b16 v[152:153], v6 offset:10240
ds_read_b64_tr_b16 v[154:155], v6 offset:10752
v_mfma_f32_32x32x16_bf16 v[24:39], v[160:163], a[184:187], v[24:39]
ds_read_b64_tr_b16 v[156:157], v7 offset:10240
v_mfma_f32_32x32x16_bf16 v[40:55], v[160:163], a[188:191], v[40:55]
ds_read_b64_tr_b16 v[158:159], v7 offset:10752
v_mfma_f32_32x32x16_bf16 v[56:71], v[164:167], a[184:187], v[56:71]
v_mfma_f32_32x32x16_bf16 v[72:87], v[164:167], a[188:191], v[72:87]
s_waitcnt vmcnt(3) lgkmcnt(0)
ds_read_b64_tr_b16 v[160:161], v172 offset:32768
ds_read_b64_tr_b16 v[162:163], v172 offset:33280
v_mfma_f32_32x32x16_bf16 v[24:39], v[152:155], a[192:195], v[24:39]
ds_read_b64_tr_b16 v[164:165], v173 offset:32768
v_mfma_f32_32x32x16_bf16 v[40:55], v[152:155], a[196:199], v[40:55]
ds_read_b64_tr_b16 v[166:167], v173 offset:33280
v_mfma_f32_32x32x16_bf16 v[56:71], v[156:159], a[192:195], v[56:71]
v_mfma_f32_32x32x16_bf16 v[72:87], v[156:159], a[196:199], v[72:87]
s_waitcnt vmcnt(1) lgkmcnt(0)
ds_read_b64_tr_b16 v[152:153], v172 offset:34816
ds_read_b64_tr_b16 v[154:155], v172 offset:35328
v_mfma_f32_32x32x16_bf16 v[24:39], v[160:163], a[200:203], v[24:39]
ds_read_b64_tr_b16 v[156:157], v173 offset:34816
v_mfma_f32_32x32x16_bf16 v[40:55], v[160:163], a[204:207], v[40:55]
ds_read_b64_tr_b16 v[158:159], v173 offset:35328
v_mfma_f32_32x32x16_bf16 v[56:71], v[164:167], a[200:203], v[56:71]
v_mfma_f32_32x32x16_bf16 v[72:87], v[164:167], a[204:207], v[72:87]
s_waitcnt lgkmcnt(0)
v_mfma_f32_32x32x16_bf16 v[24:39], v[152:155], a[208:211], v[24:39]
v_mfma_f32_32x32x16_bf16 v[40:55], v[152:155], a[212:215], v[40:55]
v_mfma_f32_32x32x16_bf16 v[56:71], v[156:159], a[208:211], v[56:71]
v_mfma_f32_32x32x16_bf16 v[72:87], v[156:159], a[212:215], v[72:87]
s_nop 15
v_add_u32 v21, s38, v17
ds_write_b128 v21, v[24:27] offset:0
ds_write_b128 v21, v[28:31] offset:1024
ds_write_b128 v21, v[32:35] offset:2048
ds_write_b128 v21, v[36:39] offset:3072
ds_write_b128 v21, v[40:43] offset:4096
ds_write_b128 v21, v[44:47] offset:5120
ds_write_b128 v21, v[48:51] offset:6144
ds_write_b128 v21, v[52:55] offset:7168
ds_write_b128 v21, v[72:75] offset:8192
ds_write_b128 v21, v[76:79] offset:9216
ds_write_b128 v21, v[80:83] offset:10240
ds_write_b128 v21, v[84:87] offset:11264
s_waitcnt lgkmcnt(0)
s_barrier
v_add_u32 v21, 0, v17
ds_read_b128 v[176:179], v21 offset:4096
ds_read_b128 v[180:183], v21 offset:5120
ds_read_b128 v[184:187], v21 offset:6144
ds_read_b128 v[188:191], v21 offset:7168
ds_read_b128 v[192:195], v21 offset:16384
ds_read_b128 v[196:199], v21 offset:17408
ds_read_b128 v[200:203], v21 offset:18432
ds_read_b128 v[204:207], v21 offset:19456
ds_read_b128 v[72:75], v21 offset:45056
ds_read_b128 v[76:79], v21 offset:46080
ds_read_b128 v[80:83], v21 offset:47104
ds_read_b128 v[84:87], v21 offset:48128
s_waitcnt lgkmcnt(8)
v_add_f32 v56, v56, v176
v_add_f32 v57, v57, v177
v_add_f32 v58, v58, v178
v_add_f32 v59, v59, v179
v_add_f32 v60, v60, v180
v_add_f32 v61, v61, v181
v_add_f32 v62, v62, v182
v_add_f32 v63, v63, v183
v_add_f32 v64, v64, v184
v_add_f32 v65, v65, v185
v_add_f32 v66, v66, v186
v_add_f32 v67, v67, v187
v_add_f32 v68, v68, v188
v_add_f32 v69, v69, v189
v_add_f32 v70, v70, v190
v_add_f32 v71, v71, v191
s_waitcnt lgkmcnt(4)
v_add_f32 v56, v56, v192
v_add_f32 v57, v57, v193
v_add_f32 v58, v58, v194
v_add_f32 v59, v59, v195
v_add_f32 v60, v60, v196
v_add_f32 v61, v61, v197
v_add_f32 v62, v62, v198
v_add_f32 v63, v63, v199
v_add_f32 v64, v64, v200
v_add_f32 v65, v65, v201
v_add_f32 v66, v66, v202
v_add_f32 v67, v67, v203
v_add_f32 v68, v68, v204
v_add_f32 v69, v69, v205
v_add_f32 v70, v70, v206
v_add_f32 v71, v71, v207
s_waitcnt lgkmcnt(0)
v_add_f32 v56, v56, v72
v_add_f32 v57, v57, v73
v_add_f32 v58, v58, v74
v_add_f32 v59, v59, v75
v_add_f32 v60, v60, v76
v_add_f32 v61, v61, v77
v_add_f32 v62, v62, v78
v_add_f32 v63, v63, v79
v_add_f32 v64, v64, v80
v_add_f32 v65, v65, v81
v_add_f32 v66, v66, v82
v_add_f32 v67, v67, v83
v_add_f32 v68, v68, v84
v_add_f32 v69, v69, v85
v_add_f32 v70, v70, v86
v_add_f32 v71, v71, v87
v_add_u32 v21, 118784, v17
v_mul_f32 v24, v56, v10
v_mul_f32 v25, v57, v10
v_mul_f32 v26, v58, v10
v_mul_f32 v27, v59, v10
v_exp_f32 v24, v24
v_exp_f32 v25, v25
v_exp_f32 v26, v26
v_exp_f32 v27, v27
v_fma_f32 v24, v24, v12, v12
v_fma_f32 v25, v25, v12, v12
v_fma_f32 v26, v26, v12, v12
v_fma_f32 v27, v27, v12, v12
v_rcp_f32 v24, v24
v_rcp_f32 v25, v25
v_rcp_f32 v26, v26
v_rcp_f32 v27, v27
v_mul_f32 v24, v56, v24
v_mul_f32 v25, v57, v25
v_mul_f32 v26, v58, v26
v_mul_f32 v27, v59, v27
v_cvt_pk_bf16_f32 v176, v24, v25
v_cvt_pk_bf16_f32 v177, v26, v27
v_mul_f32 v28, v60, v10
v_mul_f32 v29, v61, v10
v_mul_f32 v30, v62, v10
v_mul_f32 v31, v63, v10
v_exp_f32 v28, v28
v_exp_f32 v29, v29
v_exp_f32 v30, v30
v_exp_f32 v31, v31
v_fma_f32 v28, v28, v12, v12
v_fma_f32 v29, v29, v12, v12
v_fma_f32 v30, v30, v12, v12
v_fma_f32 v31, v31, v12, v12
v_rcp_f32 v28, v28
v_rcp_f32 v29, v29
v_rcp_f32 v30, v30
v_rcp_f32 v31, v31
v_mul_f32 v28, v60, v28
v_mul_f32 v29, v61, v29
v_mul_f32 v30, v62, v30
v_mul_f32 v31, v63, v31
v_cvt_pk_bf16_f32 v178, v28, v29
v_cvt_pk_bf16_f32 v179, v30, v31
ds_write_b128 v21, v[176:179] offset:0
v_mul_f32 v32, v64, v10
v_mul_f32 v33, v65, v10
v_mul_f32 v34, v66, v10
v_mul_f32 v35, v67, v10
v_exp_f32 v32, v32
v_exp_f32 v33, v33
v_exp_f32 v34, v34
v_exp_f32 v35, v35
v_fma_f32 v32, v32, v12, v12
v_fma_f32 v33, v33, v12, v12
v_fma_f32 v34, v34, v12, v12
v_fma_f32 v35, v35, v12, v12
v_rcp_f32 v32, v32
v_rcp_f32 v33, v33
v_rcp_f32 v34, v34
v_rcp_f32 v35, v35
v_mul_f32 v32, v64, v32
v_mul_f32 v33, v65, v33
v_mul_f32 v34, v66, v34
v_mul_f32 v35, v67, v35
v_cvt_pk_bf16_f32 v180, v32, v33
v_cvt_pk_bf16_f32 v181, v34, v35
v_mul_f32 v36, v68, v10
v_mul_f32 v37, v69, v10
v_mul_f32 v38, v70, v10
v_mul_f32 v39, v71, v10
v_exp_f32 v36, v36
v_exp_f32 v37, v37
v_exp_f32 v38, v38
v_exp_f32 v39, v39
v_fma_f32 v36, v36, v12, v12
v_fma_f32 v37, v37, v12, v12
v_fma_f32 v38, v38, v12, v12
v_fma_f32 v39, v39, v12, v12
v_rcp_f32 v36, v36
v_rcp_f32 v37, v37
v_rcp_f32 v38, v38
v_rcp_f32 v39, v39
v_mul_f32 v36, v68, v36
v_mul_f32 v37, v69, v37
v_mul_f32 v38, v70, v38
v_mul_f32 v39, v71, v39
v_cvt_pk_bf16_f32 v182, v36, v37
v_cvt_pk_bf16_f32 v183, v38, v39
ds_write_b128 v21, v[180:183] offset:2048
s_branch L_sf_done
L_sf3:
s_waitcnt vmcnt(15) lgkmcnt(0)
ds_read_b64_tr_b16 v[160:161], v6 offset:0
ds_read_b64_tr_b16 v[162:163], v6 offset:512
v_mfma_f32_32x32x16_bf16 v[24:39], v[152:155], a[216:219], 0
ds_read_b64_tr_b16 v[164:165], v7 offset:0
v_mfma_f32_32x32x16_bf16 v[40:55], v[152:155], a[220:223], 0
ds_read_b64_tr_b16 v[166:167], v7 offset:512
v_mfma_f32_32x32x16_bf16 v[56:71], v[156:159], a[216:219], 0
v_mfma_f32_32x32x16_bf16 v[72:87], v[156:159], a[220:223], 0
s_waitcnt vmcnt(13) lgkmcnt(0)
ds_read_b64_tr_b16 v[152:153], v6 offset:2048
ds_read_b64_tr_b16 v[154:155], v6 offset:2560
v_mfma_f32_32x32x16_bf16 v[24:39], v[160:163], a[224:227], v[24:39]
ds_read_b64_tr_b16 v[156:157], v7 offset:2048
s_mov_b32 s92, s36
s_mov_b32 s93, s37
s_mov_b32 s94, 5308416
s_mov_b32 s95, 0x20000
v_add_u32 v170, 192, v1
v_cmp_le_u32 vcc, 162, v170
v_lshlrev_b32 v170, 7, v170
v_mov_b32 v171, 0x7f000000
s_mul_i32 s87, s3, 20736
s_add_u32 s87, s87, s7
v_cndmask_b32 v170, v170, v171, vcc
v_mfma_f32_32x32x16_bf16 v[40:55], v[160:163], a[228:231], v[40:55]
ds_read_b64_tr_b16 v[158:159], v7 offset:2560
buffer_load_dword v174, v170, s[92:95], s87 offen
v_mfma_f32_32x32x16_bf16 v[56:71], v[164:167], a[224:227], v[56:71]
v_mfma_f32_32x32x16_bf16 v[72:87], v[164:167], a[228:231], v[72:87]
s_waitcnt vmcnt(12) lgkmcnt(0)
ds_read_b64_tr_b16 v[160:161], v6 offset:4096
ds_read_b64_tr_b16 v[162:163], v6 offset:4608
v_mfma_f32_32x32x16_bf16 v[24:39], v[152:155], a[232:235], v[24:39]
ds_read_b64_tr_b16 v[164:165], v7 offset:4096
v_mfma_f32_32x32x16_bf16 v[40:55], v[152:155], a[236:239], v[40:55]
ds_read_b64_tr_b16 v[166:167], v7 offset:4608
v_mfma_f32_32x32x16_bf16 v[56:71], v[156:159], a[232:235], v[56:71]
v_mfma_f32_32x32x16_bf16 v[72:87], v[156:159], a[236:239], v[72:87]
s_waitcnt vmcnt(10) lgkmcnt(0)
ds_read_b64_tr_b16 v[152:153], v6 offset:6144
ds_read_b64_tr_b16 v[154:155], v6 offset:6656
v_mfma_f32_32x32x16_bf16 v[24:39], v[160:163], a[240:243], v[24:39]
ds_read_b64_tr_b16 v[156:157], v7 offset:6144
v_mfma_f32_32x32x16_bf16 v[40:55], v[160:163], a[244:247], v[40:55]
ds_read_b64_tr_b16 v[158:159], v7 offset:6656
v_mfma_f32_32x32x16_bf16 v[56:71], v[164:167], a[240:243], v[56:71]
v_mfma_f32_32x32x16_bf16 v[72:87], v[164:167], a[244:247], v[72:87]
s_waitcnt vmcnt(7) lgkmcnt(0)
ds_read_b64_tr_b16 v[160:161], v6 offset:8192
ds_read_b64_tr_b16 v[162:163], v6 offset:8704
v_mfma_f32_32x32x16_bf16 v[24:39], v[152:155], a[248:251], v[24:39]
ds_read_b64_tr_b16 v[164:165], v7 offset:8192
v_mfma_f32_32x32x16_bf16 v[40:55], v[152:155], a[252:255], v[40:55]
ds_read_b64_tr_b16 v[166:167], v7 offset:8704
v_mfma_f32_32x32x16_bf16 v[56:71], v[156:159], a[248:251], v[56:71]
v_mfma_f32_32x32x16_bf16 v[72:87], v[156:159], a[252:255], v[72:87]
s_waitcnt vmcnt(5) lgkmcnt(0)
ds_read_b64_tr_b16 v[152:153], v6 offset:10240
ds_read_b64_tr_b16 v[154:155], v6 offset:10752
v_mfma_f32_32x32x16_bf16 v[24:39], v[160:163], v[224:227], v[24:39]
ds_read_b64_tr_b16 v[156:157], v7 offset:10240
v_mfma_f32_32x32x16_bf16 v[40:55], v[160:163], v[228:231], v[40:55]
ds_read_b64_tr_b16 v[158:159], v7 offset:10752
v_mfma_f32_32x32x16_bf16 v[56:71], v[164:167], v[224:227], v[56:71]
v_mfma_f32_32x32x16_bf16 v[72:87], v[164:167], v[228:231], v[72:87]
s_waitcnt vmcnt(3) lgkmcnt(0)
ds_read_b64_tr_b16 v[160:161], v172 offset:32768
ds_read_b64_tr_b16 v[162:163], v172 offset:33280
v_mfma_f32_32x32x16_bf16 v[24:39], v[152:155], v[232:235], v[24:39]
ds_read_b64_tr_b16 v[164:165], v173 offset:32768
v_mfma_f32_32x32x16_bf16 v[40:55], v[152:155], v[236:239], v[40:55]
ds_read_b64_tr_b16 v[166:167], v173 offset:33280
v_mfma_f32_32x32x16_bf16 v[56:71], v[156:159], v[232:235], v[56:71]
v_mfma_f32_32x32x16_bf16 v[72:87], v[156:159], v[236:239], v[72:87]
s_waitcnt vmcnt(1) lgkmcnt(0)
ds_read_b64_tr_b16 v[152:153], v172 offset:34816
ds_read_b64_tr_b16 v[154:155], v172 offset:35328
v_mfma_f32_32x32x16_bf16 v[24:39], v[160:163], v[240:243], v[24:39]
ds_read_b64_tr_b16 v[156:157], v173 offset:34816
v_mfma_f32_32x32x16_bf16 v[40:55], v[160:163], v[244:247], v[40:55]
ds_read_b64_tr_b16 v[158:159], v173 offset:35328
v_mfma_f32_32x32x16_bf16 v[56:71], v[164:167], v[240:243], v[56:71]
v_mfma_f32_32x32x16_bf16 v[72:87], v[164:167], v[244:247], v[72:87]
s_waitcnt lgkmcnt(0)
v_mfma_f32_32x32x16_bf16 v[24:39], v[152:155], v[248:251], v[24:39]
v_mfma_f32_32x32x16_bf16 v[40:55], v[152:155], v[252:255], v[40:55]
v_mfma_f32_32x32x16_bf16 v[56:71], v[156:159], v[248:251], v[56:71]
v_mfma_f32_32x32x16_bf16 v[72:87], v[156:159], v[252:255], v[72:87]
s_nop 15
v_add_u32 v21, s38, v17
ds_write_b128 v21, v[24:27] offset:0
ds_write_b128 v21, v[28:31] offset:1024
ds_write_b128 v21, v[32:35] offset:2048
ds_write_b128 v21, v[36:39] offset:3072
ds_write_b128 v21, v[40:43] offset:4096
ds_write_b128 v21, v[44:47] offset:5120
ds_write_b128 v21, v[48:51] offset:6144
ds_write_b128 v21, v[52:55] offset:7168
ds_write_b128 v21, v[56:59] offset:8192
ds_write_b128 v21, v[60:63] offset:9216
ds_write_b128 v21, v[64:67] offset:10240
ds_write_b128 v21, v[68:71] offset:11264
s_waitcnt lgkmcnt(0)
s_barrier
v_add_u32 v21, 0, v17
ds_read_b128 v[176:179], v21 offset:8192
ds_read_b128 v[180:183], v21 offset:9216
ds_read_b128 v[184:187], v21 offset:10240
ds_read_b128 v[188:191], v21 offset:11264
ds_read_b128 v[192:195], v21 offset:20480
ds_read_b128 v[196:199], v21 offset:21504
ds_read_b128 v[200:203], v21 offset:22528
ds_read_b128 v[204:207], v21 offset:23552
ds_read_b128 v[24:27], v21 offset:32768
ds_read_b128 v[28:31], v21 offset:33792
ds_read_b128 v[32:35], v21 offset:34816
ds_read_b128 v[36:39], v21 offset:35840
s_waitcnt lgkmcnt(8)
v_add_f32 v72, v72, v176
v_add_f32 v73, v73, v177
v_add_f32 v74, v74, v178
v_add_f32 v75, v75, v179
v_add_f32 v76, v76, v180
v_add_f32 v77, v77, v181
v_add_f32 v78, v78, v182
v_add_f32 v79, v79, v183
v_add_f32 v80, v80, v184
v_add_f32 v81, v81, v185
v_add_f32 v82, v82, v186
v_add_f32 v83, v83, v187
v_add_f32 v84, v84, v188
v_add_f32 v85, v85, v189
v_add_f32 v86, v86, v190
v_add_f32 v87, v87, v191
s_waitcnt lgkmcnt(4)
v_add_f32 v72, v72, v192
v_add_f32 v73, v73, v193
v_add_f32 v74, v74, v194
v_add_f32 v75, v75, v195
v_add_f32 v76, v76, v196
v_add_f32 v77, v77, v197
v_add_f32 v78, v78, v198
v_add_f32 v79, v79, v199
v_add_f32 v80, v80, v200
v_add_f32 v81, v81, v201
v_add_f32 v82, v82, v202
v_add_f32 v83, v83, v203
v_add_f32 v84, v84, v204
v_add_f32 v85, v85, v205
v_add_f32 v86, v86, v206
v_add_f32 v87, v87, v207
s_waitcnt lgkmcnt(0)
v_add_f32 v72, v72, v24
v_add_f32 v73, v73, v25
v_add_f32 v74, v74, v26
v_add_f32 v75, v75, v27
v_add_f32 v76, v76, v28
v_add_f32 v77, v77, v29
v_add_f32 v78, v78, v30
v_add_f32 v79, v79, v31
v_add_f32 v80, v80, v32
v_add_f32 v81, v81, v33
v_add_f32 v82, v82, v34
v_add_f32 v83, v83, v35
v_add_f32 v84, v84, v36
v_add_f32 v85, v85, v37
v_add_f32 v86, v86, v38
v_add_f32 v87, v87, v39
v_add_u32 v21, 119808, v17
v_mul_f32 v40, v72, v11
v_mul_f32 v41, v73, v11
v_mul_f32 v42, v74, v11
v_mul_f32 v43, v75, v11
v_exp_f32 v40, v40
v_exp_f32 v41, v41
v_exp_f32 v42, v42
v_exp_f32 v43, v43
v_fma_f32 v40, v40, v13, v13
v_fma_f32 v41, v41, v13, v13
v_fma_f32 v42, v42, v13, v13
v_fma_f32 v43, v43, v13, v13
v_rcp_f32 v40, v40
v_rcp_f32 v41, v41
v_rcp_f32 v42, v42
v_rcp_f32 v43, v43
v_mul_f32 v40, v72, v40
v_mul_f32 v41, v73, v41
v_mul_f32 v42, v74, v42
v_mul_f32 v43, v75, v43
v_cvt_pk_bf16_f32 v176, v40, v41
v_cvt_pk_bf16_f32 v177, v42, v43
v_mul_f32 v44, v76, v11
v_mul_f32 v45, v77, v11
v_mul_f32 v46, v78, v11
v_mul_f32 v47, v79, v11
v_exp_f32 v44, v44
v_exp_f32 v45, v45
v_exp_f32 v46, v46
v_exp_f32 v47, v47
v_fma_f32 v44, v44, v13, v13
v_fma_f32 v45, v45, v13, v13
v_fma_f32 v46, v46, v13, v13
v_fma_f32 v47, v47, v13, v13
v_rcp_f32 v44, v44
v_rcp_f32 v45, v45
v_rcp_f32 v46, v46
v_rcp_f32 v47, v47
v_mul_f32 v44, v76, v44
v_mul_f32 v45, v77, v45
v_mul_f32 v46, v78, v46
v_mul_f32 v47, v79, v47
v_cvt_pk_bf16_f32 v178, v44, v45
v_cvt_pk_bf16_f32 v179, v46, v47
ds_write_b128 v21, v[176:179] offset:0
v_mul_f32 v48, v80, v11
v_mul_f32 v49, v81, v11
v_mul_f32 v50, v82, v11
v_mul_f32 v51, v83, v11
v_exp_f32 v48, v48
v_exp_f32 v49, v49
v_exp_f32 v50, v50
v_exp_f32 v51, v51
v_fma_f32 v48, v48, v13, v13
v_fma_f32 v49, v49, v13, v13
v_fma_f32 v50, v50, v13, v13
v_fma_f32 v51, v51, v13, v13
v_rcp_f32 v48, v48
v_rcp_f32 v49, v49
v_rcp_f32 v50, v50
v_rcp_f32 v51, v51
v_mul_f32 v48, v80, v48
v_mul_f32 v49, v81, v49
v_mul_f32 v50, v82, v50
v_mul_f32 v51, v83, v51
v_cvt_pk_bf16_f32 v180, v48, v49
v_cvt_pk_bf16_f32 v181, v50, v51
v_mul_f32 v52, v84, v11
v_mul_f32 v53, v85, v11
v_mul_f32 v54, v86, v11
v_mul_f32 v55, v87, v11
v_exp_f32 v52, v52
v_exp_f32 v53, v53
v_exp_f32 v54, v54
v_exp_f32 v55, v55
v_fma_f32 v52, v52, v13, v13
v_fma_f32 v53, v53, v13, v13
v_fma_f32 v54, v54, v13, v13
v_fma_f32 v55, v55, v13, v13
v_rcp_f32 v52, v52
v_rcp_f32 v53, v53
v_rcp_f32 v54, v54
v_rcp_f32 v55, v55
v_mul_f32 v52, v84, v52
v_mul_f32 v53, v85, v53
v_mul_f32 v54, v86, v54
v_mul_f32 v55, v87, v55
v_cvt_pk_bf16_f32 v182, v52, v53
v_cvt_pk_bf16_f32 v183, v54, v55
ds_write_b128 v21, v[180:183] offset:2048
L_sf_done:
s_waitcnt lgkmcnt(0)
s_barrier
s_mov_b32 s101, s100
s_add_u32 m0, s33, 32768
s_nop 0
buffer_load_dwordx4 v4, s[16:19], s40 offen lds
buffer_load_dwordx4 v5, s[16:19], s40 offen offset:1024 lds
s_add_u32 m0, s33, 34816
s_nop 0
buffer_load_dwordx4 v4, s[16:19], s41 offen lds
buffer_load_dwordx4 v5, s[16:19], s41 offen offset:1024 lds
v_mov_b32 v2, v4
v_mov_b32 v3, v5
v_add_u32 v21, 49152, v17
v_add_u32 v22, 114688, v17
ds_read_b128 a[0:3], v21 offset:0
ds_read_b128 a[4:7], v21 offset:1024
ds_read_b128 a[8:11], v21 offset:2048
ds_read_b128 a[12:15], v21 offset:3072
ds_read_b128 a[16:19], v21 offset:4096
ds_read_b128 a[20:23], v21 offset:5120
ds_read_b128 a[24:27], v21 offset:6144
ds_read_b128 a[28:31], v21 offset:7168
ds_read_b128 a[32:35], v21 offset:8192
ds_read_b128 a[36:39], v21 offset:9216
ds_read_b128 a[40:43], v21 offset:10240
ds_read_b128 a[44:47], v21 offset:11264
s_waitcnt lgkmcnt(4)
s_add_u32 m0, s33, 36864
s_nop 0
buffer_load_dwordx4 v4, s[16:19], s42 offen lds
buffer_load_dwordx4 v5, s[16:19], s42 offen offset:1024 lds
ds_read_b128 a[48:51], v21 offset:12288
ds_read_b128 a[52:55], v21 offset:13312
ds_read_b128 a[56:59], v21 offset:14336
ds_read_b128 a[60:63], v21 offset:15360
ds_read_b128 a[64:67], v21 offset:16384
ds_read_b128 a[68:71], v21 offset:17408
ds_read_b128 a[72:75], v21 offset:18432
ds_read_b128 a[76:79], v21 offset:19456
ds_read_b128 a[80:83], v21 offset:20480
ds_read_b128 a[84:87], v21 offset:21504
ds_read_b128 a[88:91], v21 offset:22528
ds_read_b128 a[92:95], v21 offset:23552
s_waitcnt lgkmcnt(4)
s_add_u32 m0, s33, 38912
s_nop 0
buffer_load_dwordx4 v4, s[16:19], s43 offen lds
buffer_load_dwordx4 v5, s[16:19], s43 offen offset:1024 lds
ds_read_b128 a[96:99], v21 offset:24576
ds_read_b128 a[100:103], v21 offset:25600
ds_read_b128 a[104:107], v21 offset:26624
ds_read_b128 a[108:111], v21 offset:27648
ds_read_b128 a[112:115], v21 offset:28672
ds_read_b128 a[116:119], v21 offset:29696
ds_read_b128 a[120:123], v21 offset:30720
ds_read_b128 a[124:127], v21 offset:31744
ds_read_b128 a[128:131], v22 offset:0
ds_read_b128 a[132:135], v22 offset:1024
ds_read_b128 a[136:139], v22 offset:2048
ds_read_b128 a[140:143], v22 offset:3072
s_waitcnt lgkmcnt(4)
s_add_u32 m0, s38, 0
s_nop 0
buffer_load_dwordx4 v4, s[16:19], s44 offen lds
buffer_load_dwordx4 v5, s[16:19], s44 offen offset:1024 lds
ds_read_b128 a[144:147], v22 offset:4096
ds_read_b128 a[148:151], v22 offset:5120
ds_read_b128 a[152:155], v22 offset:6144
ds_read_b128 a[156:159], v22 offset:7168
s_add_u32 m0, s38, 2048
s_nop 0
buffer_load_dwordx4 v4, s[16:19], s45 offen lds
buffer_load_dwordx4 v5, s[16:19], s45 offen offset:1024 lds
s_add_u32 m0, s38, 4096
s_nop 0
buffer_load_dwordx4 v4, s[16:19], s46 offen lds
buffer_load_dwordx4 v5, s[16:19], s46 offen offset:1024 lds
s_cmp_ge_u32 s5, 2
s_cbranch_scc1 L_nof2
s_waitcnt vmcnt(14)
v_mov_b32 v21, s39
v_mov_b32 v22, 0
v_cmp_eq_u32 vcc, 0, v1
s_and_saveexec_b64 s[0:1], vcc
buffer_store_dword v21, v22, s[20:23], s101 offen sc1
s_mov_b64 exec, s[0:1]
L_nof2:
s_lshl_b32 s92, s5, 13
s_add_u32 s92, s92, 81920
v_add_u32 v16, s92, v17
s_add_u32 s95, s4, s5
s_add_u32 s95, s95, 4
s_and_b32 s95, s95, 7
s_lshl_b32 s93, s95, 7
v_mul_u32_u24 v4, 1152, v18
v_add3_u32 v4, v4, v19, s93
v_add_u32 v5, 8192, v4
s_lshl_b32 s93, s4, 2
s_add_u32 s93, s93, s5
s_lshl_b32 s96, s93, 11
s_add_u32 s96, s96, 22216704
s_lshl_b32 s97, s93, 11
s_add_u32 s97, s97, 22020096
v_lshrrev_b32 v23, 5, v1
s_and_b32 s92, s5, 1
v_cmp_eq_u32 vcc, 0, v23
s_mov_b64 s[100:101], vcc
s_cmp_eq_u32 s92, 0
s_cselect_b64 s[98:99], 0, vcc
s_mul_i32 s93, s5, 36
s_lshl_b32 s95, s92, 2
s_sub_u32 s93, s93, s95
s_add_u32 s91, s93, 123168
v_min_u32 v21, 15, v1
v_lshlrev_b32 v21, 7, v21
s_waitcnt vmcnt(12)
s_waitcnt lgkmcnt(0)
s_barrier
ds_read_b64_tr_b16 v[152:153], v14 offset:32768
ds_read_b64_tr_b16 v[154:155], v14 offset:33792
ds_read_b64_tr_b16 v[156:157], v15 offset:32768
ds_read_b64_tr_b16 v[158:159], v15 offset:33792
s_waitcnt vmcnt(10) lgkmcnt(0)
ds_read_b64_tr_b16 v[160:161], v14 offset:34816
ds_read_b64_tr_b16 v[162:163], v14 offset:35840
s_add_u32 m0, s38, 6144
v_mfma_f32_32x32x16_bf16 v[24:39], v[152:155], a[0:3], 0
ds_read_b64_tr_b16 v[164:165], v15 offset:34816
buffer_load_dwordx4 v2, s[12:15], s47 offen lds
v_mul_f32 v216, v88, v10
v_mul_f32 v217, v89, v10
v_mul_f32 v218, v90, v10
v_mul_f32 v219, v91, v10
v_mfma_f32_32x32x16_bf16 v[40:55], v[152:155], a[4:7], 0
ds_read_b64_tr_b16 v[166:167], v15 offset:35840
buffer_load_dwordx4 v3, s[12:15], s47 offen offset:1024 lds
v_exp_f32 v216, v216
v_exp_f32 v217, v217
v_exp_f32 v218, v218
v_mfma_f32_32x32x16_bf16 v[56:71], v[156:159], a[0:3], 0
v_exp_f32 v219, v219
v_fma_f32 v216, v216, v12, v12
v_fma_f32 v217, v217, v12, v12
v_fma_f32 v218, v218, v12, v12
v_fma_f32 v219, v219, v12, v12
v_rcp_f32 v216, v216
v_rcp_f32 v217, v217
v_rcp_f32 v218, v218
v_rcp_f32 v219, v219
v_mfma_f32_32x32x16_bf16 v[72:87], v[156:159], a[4:7], 0
v_mul_f32 v216, v88, v216
v_mul_f32 v217, v89, v217
v_mul_f32 v218, v90, v218
v_mul_f32 v219, v91, v219
v_cvt_pk_bf16_f32 v232, v216, v217
v_cvt_pk_bf16_f32 v233, v218, v219
s_waitcnt vmcnt(10) lgkmcnt(0)
ds_read_b64_tr_b16 v[152:153], v14 offset:36864
ds_read_b64_tr_b16 v[154:155], v14 offset:37888
s_add_u32 m0, s38, 8192
v_mfma_f32_32x32x16_bf16 v[24:39], v[160:163], a[8:11], v[24:39]
ds_read_b64_tr_b16 v[156:157], v15 offset:36864
buffer_load_dwordx4 v2, s[12:15], s48 offen lds
v_mul_f32 v220, v92, v10
v_mul_f32 v221, v93, v10
v_mul_f32 v222, v94, v10
v_mul_f32 v223, v95, v10
v_mfma_f32_32x32x16_bf16 v[40:55], v[160:163], a[12:15], v[40:55]
ds_read_b64_tr_b16 v[158:159], v15 offset:37888
buffer_load_dwordx4 v3, s[12:15], s48 offen offset:1024 lds
v_exp_f32 v220, v220
v_exp_f32 v221, v221
v_exp_f32 v222, v222
v_mfma_f32_32x32x16_bf16 v[56:71], v[164:167], a[8:11], v[56:71]
v_exp_f32 v223, v223
v_fma_f32 v220, v220, v12, v12
v_fma_f32 v221, v221, v12, v12
v_fma_f32 v222, v222, v12, v12
v_fma_f32 v223, v223, v12, v12
v_rcp_f32 v220, v220
v_rcp_f32 v221, v221
v_rcp_f32 v222, v222
v_rcp_f32 v223, v223
v_mfma_f32_32x32x16_bf16 v[72:87], v[164:167], a[12:15], v[72:87]
v_mul_f32 v220, v92, v220
v_mul_f32 v221, v93, v221
v_mul_f32 v222, v94, v222
v_mul_f32 v223, v95, v223
v_cvt_pk_bf16_f32 v234, v220, v221
v_cvt_pk_bf16_f32 v235, v222, v223
s_waitcnt vmcnt(10) lgkmcnt(0)
ds_read_b64_tr_b16 v[160:161], v14 offset:38912
ds_read_b64_tr_b16 v[162:163], v14 offset:39936
s_add_u32 m0, s38, 10240
v_mfma_f32_32x32x16_bf16 v[24:39], v[152:155], a[16:19], v[24:39]
ds_read_b64_tr_b16 v[164:165], v15 offset:38912
buffer_load_dwordx4 v2, s[12:15], s49 offen lds
v_mul_f32 v224, v96, v10
v_mul_f32 v225, v97, v10
v_mul_f32 v226, v98, v10
v_mul_f32 v227, v99, v10
v_mfma_f32_32x32x16_bf16 v[40:55], v[152:155], a[20:23], v[40:55]
ds_read_b64_tr_b16 v[166:167], v15 offset:39936
buffer_load_dwordx4 v3, s[12:15], s49 offen offset:1024 lds
v_exp_f32 v224, v224
v_exp_f32 v225, v225
v_exp_f32 v226, v226
v_mfma_f32_32x32x16_bf16 v[56:71], v[156:159], a[16:19], v[56:71]
v_exp_f32 v227, v227
v_fma_f32 v224, v224, v12, v12
v_fma_f32 v225, v225, v12, v12
v_fma_f32 v226, v226, v12, v12
v_fma_f32 v227, v227, v12, v12
v_rcp_f32 v224, v224
v_rcp_f32 v225, v225
v_rcp_f32 v226, v226
v_rcp_f32 v227, v227
v_mfma_f32_32x32x16_bf16 v[72:87], v[156:159], a[20:23], v[72:87]
v_mul_f32 v224, v96, v224
v_mul_f32 v225, v97, v225
v_mul_f32 v226, v98, v226
v_mul_f32 v227, v99, v227
v_cvt_pk_bf16_f32 v236, v224, v225
v_cvt_pk_bf16_f32 v237, v226, v227
s_waitcnt vmcnt(10) lgkmcnt(0)
ds_read_b64_tr_b16 v[152:153], v8 offset:0
ds_read_b64_tr_b16 v[154:155], v8 offset:1024
s_add_u32 m0, s33, 0
v_mfma_f32_32x32x16_bf16 v[24:39], v[160:163], a[24:27], v[24:39]
ds_read_b64_tr_b16 v[156:157], v9 offset:0
buffer_load_dwordx4 v2, s[12:15], s50 offen lds
v_mul_f32 v228, v100, v10
v_mul_f32 v229, v101, v10
v_mul_f32 v230, v102, v10
v_mul_f32 v231, v103, v10
v_mfma_f32_32x32x16_bf16 v[40:55], v[160:163], a[28:31], v[40:55]
ds_read_b64_tr_b16 v[158:159], v9 offset:1024
buffer_load_dwordx4 v3, s[12:15], s50 offen offset:1024 lds
v_exp_f32 v228, v228
v_exp_f32 v229, v229
v_exp_f32 v230, v230
v_mfma_f32_32x32x16_bf16 v[56:71], v[164:167], a[24:27], v[56:71]
v_exp_f32 v231, v231
v_fma_f32 v228, v228, v12, v12
v_fma_f32 v229, v229, v12, v12
v_fma_f32 v230, v230, v12, v12
v_fma_f32 v231, v231, v12, v12
v_rcp_f32 v228, v228
v_rcp_f32 v229, v229
v_rcp_f32 v230, v230
v_rcp_f32 v231, v231
v_mfma_f32_32x32x16_bf16 v[72:87], v[164:167], a[28:31], v[72:87]
v_mul_f32 v228, v100, v228
v_mul_f32 v229, v101, v229
v_mul_f32 v230, v102, v230
v_mul_f32 v231, v103, v231
v_cvt_pk_bf16_f32 v238, v228, v229
v_cvt_pk_bf16_f32 v239, v230, v231
s_waitcnt vmcnt(10) lgkmcnt(0)
ds_read_b64_tr_b16 v[160:161], v8 offset:2048
ds_read_b64_tr_b16 v[162:163], v8 offset:3072
s_add_u32 m0, s38, 0
v_mfma_f32_32x32x16_bf16 v[24:39], v[152:155], a[32:35], v[24:39]
ds_read_b64_tr_b16 v[164:165], v9 offset:2048
buffer_load_dwordx4 v2, s[12:15], s51 offen lds
v_mul_f32 v216, v104, v11
v_mul_f32 v217, v105, v11
v_mul_f32 v218, v106, v11
v_mul_f32 v219, v107, v11
v_mfma_f32_32x32x16_bf16 v[40:55], v[152:155], a[36:39], v[40:55]
ds_read_b64_tr_b16 v[166:167], v9 offset:3072
buffer_load_dwordx4 v3, s[12:15], s51 offen offset:1024 lds
v_exp_f32 v216, v216
v_exp_f32 v217, v217
v_exp_f32 v218, v218
v_mfma_f32_32x32x16_bf16 v[56:71], v[156:159], a[32:35], v[56:71]
v_exp_f32 v219, v219
v_fma_f32 v216, v216, v13, v13
v_fma_f32 v217, v217, v13, v13
v_fma_f32 v218, v218, v13, v13
v_fma_f32 v219, v219, v13, v13
v_rcp_f32 v216, v216
v_rcp_f32 v217, v217
v_rcp_f32 v218, v218
v_rcp_f32 v219, v219
v_mfma_f32_32x32x16_bf16 v[72:87], v[156:159], a[36:39], v[72:87]
v_mul_f32 v216, v104, v216
v_mul_f32 v217, v105, v217
v_mul_f32 v218, v106, v218
v_mul_f32 v219, v107, v219
v_cvt_pk_bf16_f32 v240, v216, v217
v_cvt_pk_bf16_f32 v241, v218, v219
s_waitcnt vmcnt(10) lgkmcnt(0)
ds_read_b64_tr_b16 v[152:153], v8 offset:4096
ds_read_b64_tr_b16 v[154:155], v8 offset:5120
s_add_u32 m0, s38, 2048
v_mfma_f32_32x32x16_bf16 v[24:39], v[160:163], a[40:43], v[24:39]
ds_read_b64_tr_b16 v[156:157], v9 offset:4096
buffer_load_dwordx4 v2, s[12:15], s52 offen lds
v_mul_f32 v220, v108, v11
v_mul_f32 v221, v109, v11
v_mul_f32 v222, v110, v11
v_mul_f32 v223, v111, v11
v_mfma_f32_32x32x16_bf16 v[40:55], v[160:163], a[44:47], v[40:55]
ds_read_b64_tr_b16 v[158:159], v9 offset:5120
buffer_load_dwordx4 v3, s[12:15], s52 offen offset:1024 lds
v_exp_f32 v220, v220
v_exp_f32 v221, v221
v_exp_f32 v222, v222
v_mfma_f32_32x32x16_bf16 v[56:71], v[164:167], a[40:43], v[56:71]
v_exp_f32 v223, v223
v_fma_f32 v220, v220, v13, v13
v_fma_f32 v221, v221, v13, v13
v_fma_f32 v222, v222, v13, v13
v_fma_f32 v223, v223, v13, v13
v_rcp_f32 v220, v220
v_rcp_f32 v221, v221
v_rcp_f32 v222, v222
v_rcp_f32 v223, v223
v_mfma_f32_32x32x16_bf16 v[72:87], v[164:167], a[44:47], v[72:87]
v_mul_f32 v220, v108, v220
v_mul_f32 v221, v109, v221
v_mul_f32 v222, v110, v222
v_mul_f32 v223, v111, v223
v_cvt_pk_bf16_f32 v242, v220, v221
v_cvt_pk_bf16_f32 v243, v222, v223
s_waitcnt vmcnt(10) lgkmcnt(0)
ds_read_b64_tr_b16 v[160:161], v8 offset:6144
ds_read_b64_tr_b16 v[162:163], v8 offset:7168
s_add_u32 m0, s38, 4096
v_mfma_f32_32x32x16_bf16 v[24:39], v[152:155], a[48:51], v[24:39]
ds_read_b64_tr_b16 v[164:165], v9 offset:6144
buffer_load_dwordx4 v2, s[12:15], s53 offen lds
v_mul_f32 v224, v112, v11
v_mul_f32 v225, v113, v11
v_mul_f32 v226, v114, v11
v_mul_f32 v227, v115, v11
v_mfma_f32_32x32x16_bf16 v[40:55], v[152:155], a[52:55], v[40:55]
ds_read_b64_tr_b16 v[166:167], v9 offset:7168
buffer_load_dwordx4 v3, s[12:15], s53 offen offset:1024 lds
v_exp_f32 v224, v224
v_exp_f32 v225, v225
v_exp_f32 v226, v226
v_mfma_f32_32x32x16_bf16 v[56:71], v[156:159], a[48:51], v[56:71]
v_exp_f32 v227, v227
v_fma_f32 v224, v224, v13, v13
v_fma_f32 v225, v225, v13, v13
v_fma_f32 v226, v226, v13, v13
v_fma_f32 v227, v227, v13, v13
v_rcp_f32 v224, v224
v_rcp_f32 v225, v225
v_rcp_f32 v226, v226
v_rcp_f32 v227, v227
v_mfma_f32_32x32x16_bf16 v[72:87], v[156:159], a[52:55], v[72:87]
v_mul_f32 v224, v112, v224
v_mul_f32 v225, v113, v225
v_mul_f32 v226, v114, v226
v_mul_f32 v227, v115, v227
v_cvt_pk_bf16_f32 v244, v224, v225
v_cvt_pk_bf16_f32 v245, v226, v227
s_waitcnt vmcnt(10) lgkmcnt(0)
ds_read_b64_tr_b16 v[152:153], v8 offset:8192
ds_read_b64_tr_b16 v[154:155], v8 offset:9216
s_add_u32 m0, s38, 6144
v_mfma_f32_32x32x16_bf16 v[24:39], v[160:163], a[56:59], v[24:39]
ds_read_b64_tr_b16 v[156:157], v9 offset:8192
buffer_load_dwordx4 v2, s[12:15], s54 offen lds
v_mul_f32 v228, v116, v11
v_mul_f32 v229, v117, v11
v_mul_f32 v230, v118, v11
v_mul_f32 v231, v119, v11
v_mfma_f32_32x32x16_bf16 v[40:55], v[160:163], a[60:63], v[40:55]
ds_read_b64_tr_b16 v[158:159], v9 offset:9216
buffer_load_dwordx4 v3, s[12:15], s54 offen offset:1024 lds
v_exp_f32 v228, v228
v_exp_f32 v229, v229
v_exp_f32 v230, v230
v_mfma_f32_32x32x16_bf16 v[56:71], v[164:167], a[56:59], v[56:71]
v_exp_f32 v231, v231
v_fma_f32 v228, v228, v13, v13
v_fma_f32 v229, v229, v13, v13
v_fma_f32 v230, v230, v13, v13
v_fma_f32 v231, v231, v13, v13
v_rcp_f32 v228, v228
v_rcp_f32 v229, v229
v_rcp_f32 v230, v230
v_rcp_f32 v231, v231
v_mfma_f32_32x32x16_bf16 v[72:87], v[164:167], a[60:63], v[72:87]
v_mul_f32 v228, v116, v228
v_mul_f32 v229, v117, v229
v_mul_f32 v230, v118, v230
v_mul_f32 v231, v119, v231
v_cvt_pk_bf16_f32 v246, v228, v229
v_cvt_pk_bf16_f32 v247, v230, v231
s_waitcnt vmcnt(10) lgkmcnt(0)
ds_read_b64_tr_b16 v[160:161], v8 offset:10240
ds_read_b64_tr_b16 v[162:163], v8 offset:11264
s_add_u32 m0, s38, 8192
v_mfma_f32_32x32x16_bf16 v[24:39], v[152:155], a[64:67], v[24:39]
ds_read_b64_tr_b16 v[164:165], v9 offset:10240
buffer_load_dwordx4 v2, s[12:15], s55 offen lds
v_mul_f32 v216, v120, v10
v_mul_f32 v217, v121, v10
v_mul_f32 v218, v122, v10
v_mul_f32 v219, v123, v10
v_mfma_f32_32x32x16_bf16 v[40:55], v[152:155], a[68:71], v[40:55]
ds_read_b64_tr_b16 v[166:167], v9 offset:11264
buffer_load_dwordx4 v3, s[12:15], s55 offen offset:1024 lds
v_exp_f32 v216, v216
v_exp_f32 v217, v217
v_exp_f32 v218, v218
v_mfma_f32_32x32x16_bf16 v[56:71], v[156:159], a[64:67], v[56:71]
v_exp_f32 v219, v219
v_fma_f32 v216, v216, v12, v12
v_fma_f32 v217, v217, v12, v12
v_fma_f32 v218, v218, v12, v12
v_fma_f32 v219, v219, v12, v12
v_rcp_f32 v216, v216
v_rcp_f32 v217, v217
v_rcp_f32 v218, v218
v_rcp_f32 v219, v219
v_mfma_f32_32x32x16_bf16 v[72:87], v[156:159], a[68:71], v[72:87]
v_mul_f32 v216, v120, v216
v_mul_f32 v217, v121, v217
v_mul_f32 v218, v122, v218
v_mul_f32 v219, v123, v219
v_cvt_pk_bf16_f32 v248, v216, v217
v_cvt_pk_bf16_f32 v249, v218, v219
s_waitcnt vmcnt(10) lgkmcnt(0)
ds_read_b64_tr_b16 v[152:153], v14 offset:0
ds_read_b64_tr_b16 v[154:155], v14 offset:1024
s_add_u32 m0, s38, 10240
v_mfma_f32_32x32x16_bf16 v[24:39], v[160:163], a[72:75], v[24:39]
ds_read_b64_tr_b16 v[156:157], v15 offset:0
buffer_load_dwordx4 v2, s[12:15], s56 offen lds
v_mul_f32 v220, v124, v10
v_mul_f32 v221, v125, v10
v_mul_f32 v222, v126, v10
v_mul_f32 v223, v127, v10
v_mfma_f32_32x32x16_bf16 v[40:55], v[160:163], a[76:79], v[40:55]
ds_read_b64_tr_b16 v[158:159], v15 offset:1024
buffer_load_dwordx4 v3, s[12:15], s56 offen offset:1024 lds
v_exp_f32 v220, v220
v_exp_f32 v221, v221
v_exp_f32 v222, v222
v_mfma_f32_32x32x16_bf16 v[56:71], v[164:167], a[72:75], v[56:71]
v_exp_f32 v223, v223
v_fma_f32 v220, v220, v12, v12
v_fma_f32 v221, v221, v12, v12
v_fma_f32 v222, v222, v12, v12
v_fma_f32 v223, v223, v12, v12
v_rcp_f32 v220, v220
v_rcp_f32 v221, v221
v_rcp_f32 v222, v222
v_rcp_f32 v223, v223
v_mfma_f32_32x32x16_bf16 v[72:87], v[164:167], a[76:79], v[72:87]
v_mul_f32 v220, v124, v220
v_mul_f32 v221, v125, v221
v_mul_f32 v222, v126, v222
v_mul_f32 v223, v127, v223
v_cvt_pk_bf16_f32 v250, v220, v221
v_cvt_pk_bf16_f32 v251, v222, v223
s_waitcnt vmcnt(10) lgkmcnt(0)
ds_read_b64_tr_b16 v[160:161], v8 offset:0
ds_read_b64_tr_b16 v[162:163], v8 offset:1024
s_add_u32 m0, s33, 0
v_mfma_f32_32x32x16_bf16 v[24:39], v[152:155], a[80:83], v[24:39]
ds_read_b64_tr_b16 v[164:165], v9 offset:0
buffer_load_dwordx4 v2, s[12:15], s57 offen lds
v_mul_f32 v224, v128, v10
v_mul_f32 v225, v129, v10
v_mul_f32 v226, v130, v10
v_mul_f32 v227, v131, v10
v_mfma_f32_32x32x16_bf16 v[40:55], v[152:155], a[84:87], v[40:55]
ds_read_b64_tr_b16 v[166:167], v9 offset:1024
buffer_load_dwordx4 v3, s[12:15], s57 offen offset:1024 lds
v_exp_f32 v224, v224
v_exp_f32 v225, v225
v_exp_f32 v226, v226
v_mfma_f32_32x32x16_bf16 v[56:71], v[156:159], a[80:83], v[56:71]
v_exp_f32 v227, v227
v_fma_f32 v224, v224, v12, v12
v_fma_f32 v225, v225, v12, v12
v_fma_f32 v226, v226, v12, v12
v_fma_f32 v227, v227, v12, v12
v_rcp_f32 v224, v224
v_rcp_f32 v225, v225
v_rcp_f32 v226, v226
v_rcp_f32 v227, v227
buffer_load_dword v22, v21, s[20:23], s96 offen sc1
v_mfma_f32_32x32x16_bf16 v[72:87], v[156:159], a[84:87], v[72:87]
v_mul_f32 v224, v128, v224
v_mul_f32 v225, v129, v225
v_mul_f32 v226, v130, v226
v_mul_f32 v227, v131, v227
v_cvt_pk_bf16_f32 v252, v224, v225
v_cvt_pk_bf16_f32 v253, v226, v227
s_waitcnt vmcnt(11) lgkmcnt(0)
ds_read_b64_tr_b16 v[152:153], v8 offset:2048
ds_read_b64_tr_b16 v[154:155], v8 offset:3072
s_add_u32 m0, s38, 0
v_mfma_f32_32x32x16_bf16 v[24:39], v[160:163], a[88:91], v[24:39]
ds_read_b64_tr_b16 v[156:157], v9 offset:2048
buffer_load_dwordx4 v2, s[12:15], s58 offen lds
v_mul_f32 v228, v132, v10
v_mul_f32 v229, v133, v10
v_mul_f32 v230, v134, v10
v_mul_f32 v231, v135, v10
v_mfma_f32_32x32x16_bf16 v[40:55], v[160:163], a[92:95], v[40:55]
ds_read_b64_tr_b16 v[158:159], v9 offset:3072
buffer_load_dwordx4 v3, s[12:15], s58 offen offset:1024 lds
v_exp_f32 v228, v228
v_exp_f32 v229, v229
v_exp_f32 v230, v230
v_mfma_f32_32x32x16_bf16 v[56:71], v[164:167], a[88:91], v[56:71]
v_exp_f32 v231, v231
v_fma_f32 v228, v228, v12, v12
v_fma_f32 v229, v229, v12, v12
v_fma_f32 v230, v230, v12, v12
v_fma_f32 v231, v231, v12, v12
v_rcp_f32 v228, v228
v_rcp_f32 v229, v229
v_rcp_f32 v230, v230
v_rcp_f32 v231, v231
v_mfma_f32_32x32x16_bf16 v[72:87], v[164:167], a[92:95], v[72:87]
v_mul_f32 v228, v132, v228
v_mul_f32 v229, v133, v229
v_mul_f32 v230, v134, v230
v_mul_f32 v231, v135, v231
v_cvt_pk_bf16_f32 v254, v228, v229
v_cvt_pk_bf16_f32 v255, v230, v231
s_waitcnt vmcnt(11) lgkmcnt(0)
ds_read_b64_tr_b16 v[160:161], v8 offset:4096
ds_read_b64_tr_b16 v[162:163], v8 offset:5120
s_add_u32 m0, s38, 2048
v_mfma_f32_32x32x16_bf16 v[24:39], v[152:155], a[96:99], v[24:39]
ds_read_b64_tr_b16 v[164:165], v9 offset:4096
buffer_load_dwordx4 v2, s[12:15], s59 offen lds
v_mul_f32 v216, v136, v11
v_mul_f32 v217, v137, v11
v_mul_f32 v218, v138, v11
v_mul_f32 v219, v139, v11
v_mfma_f32_32x32x16_bf16 v[40:55], v[152:155], a[100:103], v[40:55]
ds_read_b64_tr_b16 v[166:167], v9 offset:5120
buffer_load_dwordx4 v3, s[12:15], s59 offen offset:1024 lds
v_exp_f32 v216, v216
v_exp_f32 v217, v217
v_exp_f32 v218, v218
v_mfma_f32_32x32x16_bf16 v[56:71], v[156:159], a[96:99], v[56:71]
v_exp_f32 v219, v219
v_fma_f32 v216, v216, v13, v13
v_fma_f32 v217, v217, v13, v13
v_fma_f32 v218, v218, v13, v13
v_fma_f32 v219, v219, v13, v13
v_rcp_f32 v216, v216
v_rcp_f32 v217, v217
v_rcp_f32 v218, v218
v_rcp_f32 v219, v219
v_mfma_f32_32x32x16_bf16 v[72:87], v[156:159], a[100:103], v[72:87]
v_mul_f32 v216, v136, v216
v_mul_f32 v217, v137, v217
v_mul_f32 v218, v138, v218
v_mul_f32 v219, v139, v219
v_cvt_pk_bf16_f32 v176, v216, v217
v_cvt_pk_bf16_f32 v177, v218, v219
s_waitcnt vmcnt(11) lgkmcnt(0)
ds_read_b64_tr_b16 v[152:153], v8 offset:6144
ds_read_b64_tr_b16 v[154:155], v8 offset:7168
s_add_u32 m0, s38, 4096
v_mfma_f32_32x32x16_bf16 v[24:39], v[160:163], a[104:107], v[24:39]
ds_read_b64_tr_b16 v[156:157], v9 offset:6144
buffer_load_dwordx4 v2, s[12:15], s60 offen lds
v_mul_f32 v220, v140, v11
v_mul_f32 v221, v141, v11
v_mul_f32 v222, v142, v11
v_mul_f32 v223, v143, v11
v_mfma_f32_32x32x16_bf16 v[40:55], v[160:163], a[108:111], v[40:55]
ds_read_b64_tr_b16 v[158:159], v9 offset:7168
buffer_load_dwordx4 v3, s[12:15], s60 offen offset:1024 lds
v_exp_f32 v220, v220
v_exp_f32 v221, v221
v_exp_f32 v222, v222
v_mfma_f32_32x32x16_bf16 v[56:71], v[164:167], a[104:107], v[56:71]
v_exp_f32 v223, v223
v_fma_f32 v220, v220, v13, v13
v_fma_f32 v221, v221, v13, v13
v_fma_f32 v222, v222, v13, v13
v_fma_f32 v223, v223, v13, v13
v_rcp_f32 v220, v220
v_rcp_f32 v221, v221
v_rcp_f32 v222, v222
v_rcp_f32 v223, v223
v_mfma_f32_32x32x16_bf16 v[72:87], v[164:167], a[108:111], v[72:87]
v_mul_f32 v220, v140, v220
v_mul_f32 v221, v141, v221
v_mul_f32 v222, v142, v222
v_mul_f32 v223, v143, v223
v_cvt_pk_bf16_f32 v178, v220, v221
v_cvt_pk_bf16_f32 v179, v222, v223
s_waitcnt vmcnt(11) lgkmcnt(0)
ds_read_b64_tr_b16 v[160:161], v8 offset:8192
ds_read_b64_tr_b16 v[162:163], v8 offset:9216
s_add_u32 m0, s38, 6144
v_mfma_f32_32x32x16_bf16 v[24:39], v[152:155], a[112:115], v[24:39]
ds_read_b64_tr_b16 v[164:165], v9 offset:8192
buffer_load_dwordx4 v2, s[12:15], s61 offen lds
v_mul_f32 v224, v144, v11
v_mul_f32 v225, v145, v11
v_mul_f32 v226, v146, v11
v_mul_f32 v227, v147, v11
v_mfma_f32_32x32x16_bf16 v[40:55], v[152:155], a[116:119], v[40:55]
ds_read_b64_tr_b16 v[166:167], v9 offset:9216
buffer_load_dwordx4 v3, s[12:15], s61 offen offset:1024 lds
v_exp_f32 v224, v224
v_exp_f32 v225, v225
v_exp_f32 v226, v226
v_mfma_f32_32x32x16_bf16 v[56:71], v[156:159], a[112:115], v[56:71]
v_exp_f32 v227, v227
v_fma_f32 v224, v224, v13, v13
v_fma_f32 v225, v225, v13, v13
v_fma_f32 v226, v226, v13, v13
v_fma_f32 v227, v227, v13, v13
v_rcp_f32 v224, v224
v_rcp_f32 v225, v225
v_rcp_f32 v226, v226
v_rcp_f32 v227, v227
v_mfma_f32_32x32x16_bf16 v[72:87], v[156:159], a[116:119], v[72:87]
v_mul_f32 v224, v144, v224
v_mul_f32 v225, v145, v225
v_mul_f32 v226, v146, v226
v_mul_f32 v227, v147, v227
v_cvt_pk_bf16_f32 v180, v224, v225
v_cvt_pk_bf16_f32 v181, v226, v227
s_waitcnt vmcnt(11) lgkmcnt(0)
ds_read_b64_tr_b16 v[152:153], v8 offset:10240
ds_read_b64_tr_b16 v[154:155], v8 offset:11264
s_add_u32 m0, s38, 8192
v_mfma_f32_32x32x16_bf16 v[24:39], v[160:163], a[120:123], v[24:39]
ds_read_b64_tr_b16 v[156:157], v9 offset:10240
buffer_load_dwordx4 v2, s[12:15], s62 offen lds
v_mul_f32 v228, v148, v11
v_mul_f32 v229, v149, v11
v_mul_f32 v230, v150, v11
v_mul_f32 v231, v151, v11
v_mfma_f32_32x32x16_bf16 v[40:55], v[160:163], a[124:127], v[40:55]
ds_read_b64_tr_b16 v[158:159], v9 offset:11264
buffer_load_dwordx4 v3, s[12:15], s62 offen offset:1024 lds
v_exp_f32 v228, v228
v_exp_f32 v229, v229
v_exp_f32 v230, v230
v_mfma_f32_32x32x16_bf16 v[56:71], v[164:167], a[120:123], v[56:71]
v_exp_f32 v231, v231
v_fma_f32 v228, v228, v13, v13
v_fma_f32 v229, v229, v13, v13
v_fma_f32 v230, v230, v13, v13
v_fma_f32 v231, v231, v13, v13
v_rcp_f32 v228, v228
v_rcp_f32 v229, v229
v_rcp_f32 v230, v230
v_rcp_f32 v231, v231
v_mfma_f32_32x32x16_bf16 v[72:87], v[164:167], a[124:127], v[72:87]
v_mul_f32 v228, v148, v228
v_mul_f32 v229, v149, v229
v_mul_f32 v230, v150, v230
v_mul_f32 v231, v151, v231
v_cvt_pk_bf16_f32 v182, v228, v229
v_cvt_pk_bf16_f32 v183, v230, v231
s_waitcnt vmcnt(11) lgkmcnt(0)
ds_read_b64_tr_b16 v[160:161], v14 offset:0
ds_read_b64_tr_b16 v[162:163], v14 offset:1024
s_add_u32 m0, s38, 10240
v_mfma_f32_32x32x16_bf16 v[24:39], v[152:155], a[128:131], v[24:39]
ds_read_b64_tr_b16 v[164:165], v15 offset:0
buffer_load_dwordx4 v2, s[12:15], s63 offen lds
ds_write_b64 v16, v[232:233] offset:0
v_mfma_f32_32x32x16_bf16 v[40:55], v[152:155], a[132:135], v[40:55]
ds_read_b64_tr_b16 v[166:167], v15 offset:1024
buffer_load_dwordx4 v3, s[12:15], s63 offen offset:1024 lds
ds_write_b64 v16, v[234:235] offset:8
v_mfma_f32_32x32x16_bf16 v[56:71], v[156:159], a[128:131], v[56:71]
ds_write_b64 v16, v[236:237] offset:2048
ds_write_b64 v16, v[238:239] offset:2056
v_mfma_f32_32x32x16_bf16 v[72:87], v[156:159], a[132:135], v[72:87]
ds_write_b64 v16, v[240:241] offset:1024
s_waitcnt vmcnt(10) lgkmcnt(4)
ds_read_b64_tr_b16 v[152:153], v8 offset:0
ds_read_b64_tr_b16 v[154:155], v8 offset:1024
s_add_u32 m0, s33, 0
v_mfma_f32_32x32x16_bf16 v[24:39], v[160:163], a[136:139], v[24:39]
ds_read_b64_tr_b16 v[156:157], v9 offset:0
buffer_load_dwordx4 v2, s[12:15], s64 offen lds
ds_write_b64 v16, v[242:243] offset:1032
v_mfma_f32_32x32x16_bf16 v[40:55], v[160:163], a[140:143], v[40:55]
ds_read_b64_tr_b16 v[158:159], v9 offset:1024
buffer_load_dwordx4 v3, s[12:15], s64 offen offset:1024 lds
ds_write_b64 v16, v[244:245] offset:3072
v_mfma_f32_32x32x16_bf16 v[56:71], v[164:167], a[136:139], v[56:71]
ds_write_b64 v16, v[246:247] offset:3080
ds_write_b64 v16, v[248:249] offset:4096
ds_write_b64 v16, v[250:251] offset:4104
v_mfma_f32_32x32x16_bf16 v[72:87], v[164:167], a[140:143], v[72:87]
ds_write_b64 v16, v[252:253] offset:6144
s_waitcnt vmcnt(10) lgkmcnt(5)
ds_read_b64_tr_b16 v[160:161], v8 offset:2048
ds_read_b64_tr_b16 v[162:163], v8 offset:3072
s_add_u32 m0, s38, 0
v_mfma_f32_32x32x16_bf16 v[24:39], v[152:155], a[144:147], v[24:39]
ds_read_b64_tr_b16 v[164:165], v9 offset:2048
buffer_load_dwordx4 v2, s[12:15], s65 offen lds
v_mfma_f32_32x32x16_bf16 v[40:55], v[152:155], a[148:151], v[40:55]
ds_read_b64_tr_b16 v[166:167], v9 offset:3072
buffer_load_dwordx4 v3, s[12:15], s65 offen offset:1024 lds
ds_write_b64 v16, v[254:255] offset:6152
ds_write_b64 v16, v[176:177] offset:5120
v_mfma_f32_32x32x16_bf16 v[56:71], v[156:159], a[144:147], v[56:71]
ds_write_b64 v16, v[178:179] offset:5128
ds_write_b64 v16, v[180:181] offset:7168
v_mfma_f32_32x32x16_bf16 v[72:87], v[156:159], a[148:151], v[72:87]
ds_write_b64 v16, v[182:183] offset:7176
s_waitcnt lgkmcnt(0)
s_barrier
v_add_u32 v10, 49152, v17
s_waitcnt vmcnt(10) lgkmcnt(5)
ds_read_b64_tr_b16 v[152:153], v8 offset:4096
ds_read_b64_tr_b16 v[154:155], v8 offset:5120
s_add_u32 m0, s38, 2048
v_mfma_f32_32x32x16_bf16 v[24:39], v[160:163], a[152:155], v[24:39]
ds_read_b64_tr_b16 v[156:157], v9 offset:4096
buffer_load_dwordx4 v2, s[12:15], s66 offen lds
ds_read_b128 a[160:163], v10 offset:32768
ds_read_b128 a[164:167], v10 offset:33792
v_mfma_f32_32x32x16_bf16 v[40:55], v[160:163], a[156:159], v[40:55]
ds_read_b64_tr_b16 v[158:159], v9 offset:5120
buffer_load_dwordx4 v3, s[12:15], s66 offen offset:1024 lds
v_and_b32 v114, 31, v1
v_cmp_eq_u32 vcc, 22, v114
v_mov_b32 v115, 18
s_nop 0
v_cndmask_b32 v114, v114, v115, vcc
v_cmp_ge_u32 vcc, 18, v114
v_lshrrev_b32 v23, 5, v1
v_lshlrev_b32 v114, 4, v114
v_mfma_f32_32x32x16_bf16 v[56:71], v[164:167], a[152:155], v[56:71]
v_mul_u32_u24 v115, 608, v23
v_add_u32 v115, v114, v115
v_mov_b32 v89, 0x7f000000
v_cndmask_b32 v90, v89, v115, vcc
v_cndmask_b32 v91, v89, v114, vcc
v_and_b32 v115, 31, v1
v_mul_u32_u24 v114, 456, v115
v_lshl_add_u32 v114, v23, 4, v114
v_add_u32 v112, s91, v114
v_mfma_f32_32x32x16_bf16 v[72:87], v[164:167], a[156:159], v[72:87]
s_mul_i32 s93, s5, 36
s_add_u32 s93, s93, 152064
v_mul_u32_u24 v114, 176, v115
v_lshl_add_u32 v114, v23, 3, v114
v_add_u32 v113, s93, v114
s_waitcnt vmcnt(10) lgkmcnt(0)
ds_read_b64_tr_b16 v[160:161], v8 offset:6144
ds_read_b64_tr_b16 v[162:163], v8 offset:7168
s_add_u32 m0, s38, 4096
v_mfma_f32_32x32x16_bf16 v[24:39], v[152:155], a[160:163], v[24:39]
ds_read_b64_tr_b16 v[164:165], v9 offset:6144
buffer_load_dwordx4 v2, s[12:15], s67 offen lds
ds_read_b128 a[168:171], v10 offset:34816
ds_read_b128 a[172:175], v10 offset:35840
v_mfma_f32_32x32x16_bf16 v[40:55], v[152:155], a[164:167], v[40:55]
ds_read_b64_tr_b16 v[166:167], v9 offset:7168
buffer_load_dwordx4 v3, s[12:15], s67 offen offset:1024 lds
v_cmp_ne_u32 vcc, s39, v22
s_and_b32 vcc_lo, vcc_lo, 0xffff
s_mov_b32 vcc_hi, 0
s_cbranch_vccnz L_c2_slow
L_c2_ret:
v_mfma_f32_32x32x16_bf16 v[56:71], v[156:159], a[160:163], v[56:71]
buffer_load_dwordx4 v[92:95], v90, s[20:23], s97 offen sc1
buffer_load_dwordx4 v[96:99], v90, s[20:23], s97 offen offset:304 sc1
buffer_load_dwordx4 v[100:103], v91, s[20:23], s97 offen offset:1216 sc1
v_mfma_f32_32x32x16_bf16 v[72:87], v[156:159], a[164:167], v[72:87]
s_waitcnt vmcnt(13) lgkmcnt(0)
ds_read_b64_tr_b16 v[152:153], v8 offset:8192
ds_read_b64_tr_b16 v[154:155], v8 offset:9216
s_add_u32 m0, s38, 6144
v_mfma_f32_32x32x16_bf16 v[24:39], v[160:163], a[168:171], v[24:39]
ds_read_b64_tr_b16 v[156:157], v9 offset:8192
buffer_load_dwordx4 v2, s[12:15], s68 offen lds
ds_read_b128 a[176:179], v10 offset:36864
ds_read_b128 a[180:183], v10 offset:37888
v_mfma_f32_32x32x16_bf16 v[40:55], v[160:163], a[172:175], v[40:55]
ds_read_b64_tr_b16 v[158:159], v9 offset:9216
buffer_load_dwordx4 v3, s[12:15], s68 offen offset:1024 lds
v_mfma_f32_32x32x16_bf16 v[56:71], v[164:167], a[168:171], v[56:71]
ds_read_b64 v[232:233], v112 offset:0
ds_read_b64 v[234:235], v112 offset:8
v_mfma_f32_32x32x16_bf16 v[72:87], v[164:167], a[172:175], v[72:87]
s_waitcnt vmcnt(13) lgkmcnt(2)
ds_read_b64_tr_b16 v[160:161], v8 offset:10240
ds_read_b64_tr_b16 v[162:163], v8 offset:11264
s_add_u32 m0, s38, 8192
v_mfma_f32_32x32x16_bf16 v[24:39], v[152:155], a[176:179], v[24:39]
ds_read_b64_tr_b16 v[164:165], v9 offset:10240
buffer_load_dwordx4 v2, s[12:15], s69 offen lds
ds_read_b128 a[184:187], v10 offset:38912
ds_read_b128 a[188:191], v10 offset:39936
v_mfma_f32_32x32x16_bf16 v[40:55], v[152:155], a[180:183], v[40:55]
ds_read_b64_tr_b16 v[166:167], v9 offset:11264
buffer_load_dwordx4 v3, s[12:15], s69 offen offset:1024 lds
v_mfma_f32_32x32x16_bf16 v[56:71], v[156:159], a[176:179], v[56:71]
ds_read_b64 v[236:237], v112 offset:32
ds_read_b64 v[238:239], v112 offset:40
v_mfma_f32_32x32x16_bf16 v[72:87], v[156:159], a[180:183], v[72:87]
s_waitcnt vmcnt(13) lgkmcnt(2)
ds_read_b64_tr_b16 v[152:153], v14 offset:0
ds_read_b64_tr_b16 v[154:155], v14 offset:1024
s_add_u32 m0, s38, 10240
v_mfma_f32_32x32x16_bf16 v[24:39], v[160:163], a[184:187], v[24:39]
ds_read_b64_tr_b16 v[156:157], v15 offset:0
buffer_load_dwordx4 v2, s[12:15], s70 offen lds
ds_read_b128 a[192:195], v10 offset:40960
ds_read_b128 a[196:199], v10 offset:41984
v_mfma_f32_32x32x16_bf16 v[40:55], v[160:163], a[188:191], v[40:55]
ds_read_b64_tr_b16 v[158:159], v15 offset:1024
buffer_load_dwordx4 v3, s[12:15], s70 offen offset:1024 lds
v_mfma_f32_32x32x16_bf16 v[56:71], v[164:167], a[184:187], v[56:71]
ds_read_b64 v[240:241], v112 offset:14592
ds_read_b64 v[242:243], v112 offset:14600
v_mfma_f32_32x32x16_bf16 v[72:87], v[164:167], a[188:191], v[72:87]
s_waitcnt vmcnt(13) lgkmcnt(2)
ds_read_b64_tr_b16 v[160:161], v8 offset:0
ds_read_b64_tr_b16 v[162:163], v8 offset:1024
s_add_u32 m0, s33, 0
v_mfma_f32_32x32x16_bf16 v[24:39], v[152:155], a[192:195], v[24:39]
ds_read_b64_tr_b16 v[164:165], v9 offset:0
buffer_load_dwordx4 v2, s[12:15], s71 offen lds
ds_read_b128 a[200:203], v10 offset:43008
ds_read_b128 a[204:207], v10 offset:44032
v_mfma_f32_32x32x16_bf16 v[40:55], v[152:155], a[196:199], v[40:55]
ds_read_b64_tr_b16 v[166:167], v9 offset:1024
buffer_load_dwordx4 v3, s[12:15], s71 offen offset:1024 lds
v_mfma_f32_32x32x16_bf16 v[56:71], v[156:159], a[192:195], v[56:71]
ds_read_b64 v[244:245], v112 offset:14624
ds_read_b64 v[246:247], v112 offset:14632
v_mfma_f32_32x32x16_bf16 v[72:87], v[156:159], a[196:199], v[72:87]
s_waitcnt vmcnt(13) lgkmcnt(2)
ds_read_b64_tr_b16 v[152:153], v8 offset:2048
ds_read_b64_tr_b16 v[154:155], v8 offset:3072
s_add_u32 m0, s38, 0
v_mfma_f32_32x32x16_bf16 v[24:39], v[160:163], a[200:203], v[24:39]
ds_read_b64_tr_b16 v[156:157], v9 offset:2048
buffer_load_dwordx4 v2, s[12:15], s72 offen lds
ds_read_b128 a[208:211], v10 offset:45056
ds_read_b128 a[212:215], v10 offset:46080
v_mfma_f32_32x32x16_bf16 v[40:55], v[160:163], a[204:207], v[40:55]
ds_read_b64_tr_b16 v[158:159], v9 offset:3072
buffer_load_dwordx4 v3, s[12:15], s72 offen offset:1024 lds
v_mfma_f32_32x32x16_bf16 v[56:71], v[164:167], a[200:203], v[56:71]
v_mfma_f32_32x32x16_bf16 v[72:87], v[164:167], a[204:207], v[72:87]
s_waitcnt vmcnt(13) lgkmcnt(0)
ds_read_b64_tr_b16 v[160:161], v8 offset:4096
ds_read_b64_tr_b16 v[162:163], v8 offset:5120
s_add_u32 m0, s38, 2048
v_mfma_f32_32x32x16_bf16 v[24:39], v[152:155], a[208:211], v[24:39]
ds_read_b64_tr_b16 v[164:165], v9 offset:4096
buffer_load_dwordx4 v2, s[12:15], s73 offen lds
ds_read_b128 a[216:219], v10 offset:47104
ds_read_b128 a[220:223], v10 offset:48128
v_mfma_f32_32x32x16_bf16 v[40:55], v[152:155], a[212:215], v[40:55]
ds_read_b64_tr_b16 v[166:167], v9 offset:5120
buffer_load_dwordx4 v3, s[12:15], s73 offen offset:1024 lds
v_mfma_f32_32x32x16_bf16 v[56:71], v[156:159], a[208:211], v[56:71]
s_waitcnt vmcnt(12)
v_cndmask_b32_e64 v92, v92, 0, s[98:99]
v_cndmask_b32_e64 v93, v93, 0, s[98:99]
v_cndmask_b32_e64 v100, 0, v100, s[100:101]
v_cndmask_b32_e64 v101, 0, v101, s[100:101]
v_cndmask_b32_e64 v102, 0, v102, s[98:99]
v_cndmask_b32_e64 v103, 0, v103, s[98:99]
v_mfma_f32_32x32x16_bf16 v[72:87], v[156:159], a[212:215], v[72:87]
v_cvt_pk_bf16_f32 v104, v92, v93
v_cvt_pk_bf16_f32 v105, v94, v95
v_cvt_pk_bf16_f32 v106, v96, v97
v_cvt_pk_bf16_f32 v107, v98, v99
s_waitcnt vmcnt(10) lgkmcnt(0)
ds_read_b64_tr_b16 v[152:153], v8 offset:6144
ds_read_b64_tr_b16 v[154:155], v8 offset:7168
s_add_u32 m0, s38, 4096
v_mfma_f32_32x32x16_bf16 v[24:39], v[160:163], a[216:219], v[24:39]
ds_read_b64_tr_b16 v[156:157], v9 offset:6144
buffer_load_dwordx4 v2, s[12:15], s74 offen lds
ds_read_b128 a[224:227], v10 offset:49152
ds_read_b128 a[228:231], v10 offset:50176
v_cvt_pk_bf16_f32 v108, v100, v101
v_cvt_pk_bf16_f32 v109, v102, v103
v_mov_b32 v110, 0
v_mov_b32 v111, 0
v_mfma_f32_32x32x16_bf16 v[40:55], v[160:163], a[220:223], v[40:55]
ds_read_b64_tr_b16 v[158:159], v9 offset:7168
buffer_load_dwordx4 v3, s[12:15], s74 offen offset:1024 lds
v_mfma_f32_32x32x16_bf16 v[56:71], v[164:167], a[216:219], v[56:71]
v_mfma_f32_32x32x16_bf16 v[120:135], v[104:107], v[232:235], 0
v_mfma_f32_32x32x16_bf16 v[72:87], v[164:167], a[220:223], v[72:87]
v_mfma_f32_32x32x16_bf16 v[136:151], v[104:107], v[240:243], 0
s_waitcnt vmcnt(10) lgkmcnt(0)
ds_read_b64_tr_b16 v[160:161], v8 offset:8192
ds_read_b64_tr_b16 v[162:163], v8 offset:9216
s_add_u32 m0, s38, 6144
v_mfma_f32_32x32x16_bf16 v[24:39], v[152:155], a[224:227], v[24:39]
ds_read_b64_tr_b16 v[164:165], v9 offset:8192
buffer_load_dwordx4 v2, s[12:15], s75 offen lds
ds_read_b128 a[232:235], v10 offset:51200
ds_read_b128 a[236:239], v10 offset:52224
v_mfma_f32_32x32x16_bf16 v[40:55], v[152:155], a[228:231], v[40:55]
ds_read_b64_tr_b16 v[166:167], v9 offset:9216
buffer_load_dwordx4 v3, s[12:15], s75 offen offset:1024 lds
v_mfma_f32_32x32x16_bf16 v[120:135], v[108:111], v[236:239], v[120:135]
v_mfma_f32_32x32x16_bf16 v[56:71], v[156:159], a[224:227], v[56:71]
v_mfma_f32_32x32x16_bf16 v[136:151], v[108:111], v[244:247], v[136:151]
v_mfma_f32_32x32x16_bf16 v[72:87], v[156:159], a[228:231], v[72:87]
s_waitcnt vmcnt(10) lgkmcnt(0)
ds_read_b64_tr_b16 v[152:153], v8 offset:10240
ds_read_b64_tr_b16 v[154:155], v8 offset:11264
s_add_u32 m0, s38, 8192
v_mfma_f32_32x32x16_bf16 v[24:39], v[160:163], a[232:235], v[24:39]
ds_read_b64_tr_b16 v[156:157], v9 offset:10240
buffer_load_dwordx4 v2, s[28:31], s76 offen lds
ds_read_b128 a[240:243], v10 offset:53248
ds_read_b128 a[244:247], v10 offset:54272
v_mfma_f32_32x32x16_bf16 v[40:55], v[160:163], a[236:239], v[40:55]
ds_read_b64_tr_b16 v[158:159], v9 offset:11264
buffer_load_dwordx4 v3, s[28:31], s76 offen offset:1024 lds
v_mfma_f32_32x32x16_bf16 v[56:71], v[164:167], a[232:235], v[56:71]
v_mfma_f32_32x32x16_bf16 v[72:87], v[164:167], a[236:239], v[72:87]
s_waitcnt vmcnt(10) lgkmcnt(0)
ds_read_b64_tr_b16 v[160:161], v14 offset:0
ds_read_b64_tr_b16 v[162:163], v14 offset:1024
s_add_u32 m0, s38, 10240
v_mfma_f32_32x32x16_bf16 v[24:39], v[152:155], a[240:243], v[24:39]
ds_read_b64_tr_b16 v[164:165], v15 offset:0
buffer_load_dwordx4 v2, s[28:31], s77 offen lds
ds_read_b128 a[248:251], v10 offset:55296
ds_read_b128 a[252:255], v10 offset:56320
v_add_f32 v114, 0x358637bd, v130
v_mfma_f32_32x32x16_bf16 v[40:55], v[152:155], a[244:247], v[40:55]
ds_read_b64_tr_b16 v[166:167], v15 offset:1024
buffer_load_dwordx4 v3, s[28:31], s77 offen offset:1024 lds
v_rcp_f32 v114, v114
v_mfma_f32_32x32x16_bf16 v[56:71], v[156:159], a[240:243], v[56:71]
v_mul_f32 v120, v120, v114
v_mul_f32 v121, v121, v114
v_mul_f32 v122, v122, v114
v_mul_f32 v123, v123, v114
v_mul_f32 v124, v124, v114
v_mul_f32 v125, v125, v114
v_mfma_f32_32x32x16_bf16 v[72:87], v[156:159], a[244:247], v[72:87]
v_mul_f32 v126, v126, v114
v_mul_f32 v127, v127, v114
v_mul_f32 v128, v128, v114
v_mul_f32 v129, v129, v114
s_waitcnt vmcnt(10) lgkmcnt(0)
ds_read_b64_tr_b16 v[152:153], v8 offset:0
ds_read_b64_tr_b16 v[154:155], v8 offset:1024
s_add_u32 m0, s33, 0
v_mfma_f32_32x32x16_bf16 v[24:39], v[160:163], a[248:251], v[24:39]
ds_read_b64_tr_b16 v[156:157], v9 offset:0
buffer_load_dwordx4 v2, s[28:31], s78 offen lds
ds_read_b128 v[184:187], v10 offset:57344
ds_read_b128 v[188:191], v10 offset:58368
v_cvt_pk_bf16_f32 v120, v120, v121
v_cvt_pk_bf16_f32 v121, v122, v123
v_add_f32 v114, 0x358637bd, v146
v_mfma_f32_32x32x16_bf16 v[40:55], v[160:163], a[252:255], v[40:55]
ds_read_b64_tr_b16 v[158:159], v9 offset:1024
buffer_load_dwordx4 v3, s[28:31], s78 offen offset:1024 lds
v_cvt_pk_bf16_f32 v122, v124, v125
v_cvt_pk_bf16_f32 v123, v126, v127
v_cvt_pk_bf16_f32 v124, v128, v129
v_rcp_f32 v114, v114
v_mfma_f32_32x32x16_bf16 v[56:71], v[164:167], a[248:251], v[56:71]
ds_write_b32 v113, v120 offset:0
ds_write_b32 v113, v121 offset:4
ds_write_b32 v113, v122 offset:16
ds_write_b32 v113, v123 offset:20
v_mul_f32 v136, v136, v114
v_mul_f32 v137, v137, v114
v_mul_f32 v138, v138, v114
v_mul_f32 v139, v139, v114
v_mul_f32 v140, v140, v114
v_mul_f32 v141, v141, v114
v_mfma_f32_32x32x16_bf16 v[72:87], v[164:167], a[252:255], v[72:87]
s_mov_b64 exec, s[100:101]
ds_write_b32 v113, v124 offset:32
s_mov_b64 exec, -1
v_mul_f32 v142, v142, v114
v_mul_f32 v143, v143, v114
v_mul_f32 v144, v144, v114
v_mul_f32 v145, v145, v114
s_waitcnt vmcnt(10) lgkmcnt(5)
ds_read_b64_tr_b16 v[160:161], v8 offset:2048
ds_read_b64_tr_b16 v[162:163], v8 offset:3072
s_add_u32 m0, s38, 0
v_mfma_f32_32x32x16_bf16 v[24:39], v[152:155], v[184:187], v[24:39]
ds_read_b64_tr_b16 v[164:165], v9 offset:2048
buffer_load_dwordx4 v2, s[28:31], s79 offen lds
ds_read_b128 v[192:195], v10 offset:59392
ds_read_b128 v[196:199], v10 offset:60416
v_cvt_pk_bf16_f32 v136, v136, v137
v_cvt_pk_bf16_f32 v137, v138, v139
v_mfma_f32_32x32x16_bf16 v[40:55], v[152:155], v[188:191], v[40:55]
ds_read_b64_tr_b16 v[166:167], v9 offset:3072
buffer_load_dwordx4 v3, s[28:31], s79 offen offset:1024 lds
v_cvt_pk_bf16_f32 v138, v140, v141
v_cvt_pk_bf16_f32 v139, v142, v143
v_cvt_pk_bf16_f32 v140, v144, v145
v_mfma_f32_32x32x16_bf16 v[56:71], v[156:159], v[184:187], v[56:71]
ds_write_b32 v113, v136 offset:5632
ds_write_b32 v113, v137 offset:5636
ds_write_b32 v113, v138 offset:5648
ds_write_b32 v113, v139 offset:5652
v_mfma_f32_32x32x16_bf16 v[72:87], v[156:159], v[188:191], v[72:87]
s_mov_b64 exec, s[100:101]
ds_write_b32 v113, v140 offset:5664
s_mov_b64 exec, -1
s_waitcnt vmcnt(10) lgkmcnt(5)
ds_read_b64_tr_b16 v[152:153], v8 offset:4096
ds_read_b64_tr_b16 v[154:155], v8 offset:5120
s_add_u32 m0, s38, 2048
v_mfma_f32_32x32x16_bf16 v[24:39], v[160:163], v[192:195], v[24:39]
ds_read_b64_tr_b16 v[156:157], v9 offset:4096
buffer_load_dwordx4 v2, s[28:31], s80 offen lds
ds_read_b128 v[200:203], v10 offset:61440
ds_read_b128 v[204:207], v10 offset:62464
v_mfma_f32_32x32x16_bf16 v[40:55], v[160:163], v[196:199], v[40:55]
ds_read_b64_tr_b16 v[158:159], v9 offset:5120
buffer_load_dwordx4 v3, s[28:31], s80 offen offset:1024 lds
v_mfma_f32_32x32x16_bf16 v[56:71], v[164:167], v[192:195], v[56:71]
v_mfma_f32_32x32x16_bf16 v[72:87], v[164:167], v[196:199], v[72:87]
s_waitcnt vmcnt(10) lgkmcnt(0)
ds_read_b64_tr_b16 v[160:161], v8 offset:6144
ds_read_b64_tr_b16 v[162:163], v8 offset:7168
s_add_u32 m0, s38, 4096
v_mfma_f32_32x32x16_bf16 v[24:39], v[152:155], v[200:203], v[24:39]
ds_read_b64_tr_b16 v[164:165], v9 offset:6144
buffer_load_dwordx4 v4, s[16:19], s40 offen lds
ds_read_b128 v[208:211], v10 offset:63488
ds_read_b128 v[212:215], v10 offset:64512
v_mfma_f32_32x32x16_bf16 v[40:55], v[152:155], v[204:207], v[40:55]
ds_read_b64_tr_b16 v[166:167], v9 offset:7168
buffer_load_dwordx4 v5, s[16:19], s40 offen offset:1024 lds
v_and_b32 v23, 31, v1
v_mul_u32_u24 v23, 176, v23
v_lshrrev_b32 v22, 5, v1
v_lshl_add_u32 v23, v22, 4, v23
v_add_u32 v16, 152064, v23
v_mfma_f32_32x32x16_bf16 v[56:71], v[156:159], v[200:203], v[56:71]
v_mfma_f32_32x32x16_bf16 v[72:87], v[156:159], v[204:207], v[72:87]
s_waitcnt lgkmcnt(0)
s_barrier
s_waitcnt vmcnt(10) lgkmcnt(0)
ds_read_b64_tr_b16 v[152:153], v6 offset:8192
ds_read_b64_tr_b16 v[154:155], v6 offset:8704
s_add_u32 m0, s38, 6144
v_mfma_f32_32x32x16_bf16 v[24:39], v[160:163], v[208:211], v[24:39]
ds_read_b64_tr_b16 v[156:157], v7 offset:8192
buffer_load_dwordx4 v4, s[16:19], s41 offen lds
ds_read_b128 v[216:219], v16 offset:0
ds_read_b128 v[220:223], v16 offset:5632
v_mfma_f32_32x32x16_bf16 v[40:55], v[160:163], v[212:215], v[40:55]
ds_read_b64_tr_b16 v[158:159], v7 offset:8704
buffer_load_dwordx4 v5, s[16:19], s41 offen offset:1024 lds
v_mfma_f32_32x32x16_bf16 v[56:71], v[164:167], v[208:211], v[56:71]
v_mfma_f32_32x32x16_bf16 v[72:87], v[164:167], v[212:215], v[72:87]
s_waitcnt vmcnt(10) lgkmcnt(0)
ds_read_b64_tr_b16 v[160:161], v6 offset:10240
ds_read_b64_tr_b16 v[162:163], v6 offset:10752
s_add_u32 m0, s38, 8192
v_mfma_f32_32x32x16_bf16 v[24:39], v[152:155], v[216:219], v[24:39]
ds_read_b64_tr_b16 v[164:165], v7 offset:10240
buffer_load_dwordx4 v4, s[16:19], s42 offen lds
ds_read_b128 v[224:227], v16 offset:32
ds_read_b128 v[228:231], v16 offset:5664
v_mfma_f32_32x32x16_bf16 v[40:55], v[152:155], v[220:223], v[40:55]
ds_read_b64_tr_b16 v[166:167], v7 offset:10752
buffer_load_dwordx4 v5, s[16:19], s42 offen offset:1024 lds
v_mfma_f32_32x32x16_bf16 v[56:71], v[156:159], v[216:219], v[56:71]
v_mfma_f32_32x32x16_bf16 v[72:87], v[156:159], v[220:223], v[72:87]
s_waitcnt vmcnt(10) lgkmcnt(0)
ds_read_b64_tr_b16 v[152:153], v172 offset:0
ds_read_b64_tr_b16 v[154:155], v172 offset:512
s_add_u32 m0, s38, 10240
v_mfma_f32_32x32x16_bf16 v[24:39], v[160:163], v[224:227], v[24:39]
ds_read_b64_tr_b16 v[156:157], v173 offset:0
buffer_load_dwordx4 v4, s[16:19], s43 offen lds
ds_read_b128 v[216:219], v16 offset:64
ds_read_b128 v[220:223], v16 offset:5696
v_mfma_f32_32x32x16_bf16 v[40:55], v[160:163], v[228:231], v[40:55]
ds_read_b64_tr_b16 v[158:159], v173 offset:512
buffer_load_dwordx4 v5, s[16:19], s43 offen offset:1024 lds
v_mfma_f32_32x32x16_bf16 v[56:71], v[164:167], v[224:227], v[56:71]
v_mfma_f32_32x32x16_bf16 v[72:87], v[164:167], v[228:231], v[72:87]
s_waitcnt vmcnt(10) lgkmcnt(0)
ds_read_b64_tr_b16 v[160:161], v6 offset:0
ds_read_b64_tr_b16 v[162:163], v6 offset:512
s_add_u32 m0, s33, 0
v_mfma_f32_32x32x16_bf16 v[24:39], v[152:155], v[216:219], v[24:39]
ds_read_b64_tr_b16 v[164:165], v7 offset:0
buffer_load_dwordx4 v4, s[16:19], s44 offen lds
ds_read_b128 v[224:227], v16 offset:96
ds_read_b128 v[228:231], v16 offset:5728
v_mfma_f32_32x32x16_bf16 v[40:55], v[152:155], v[220:223], v[40:55]
ds_read_b64_tr_b16 v[166:167], v7 offset:512
buffer_load_dwordx4 v5, s[16:19], s44 offen offset:1024 lds
v_mfma_f32_32x32x16_bf16 v[56:71], v[156:159], v[216:219], v[56:71]
v_mfma_f32_32x32x16_bf16 v[72:87], v[156:159], v[220:223], v[72:87]
s_waitcnt vmcnt(10) lgkmcnt(0)
ds_read_b64_tr_b16 v[152:153], v6 offset:2048
ds_read_b64_tr_b16 v[154:155], v6 offset:2560
s_add_u32 m0, s38, 0
v_mfma_f32_32x32x16_bf16 v[24:39], v[160:163], v[224:227], v[24:39]
ds_read_b64_tr_b16 v[156:157], v7 offset:2048
buffer_load_dwordx4 v4, s[16:19], s45 offen lds
ds_read_b128 v[216:219], v16 offset:128
ds_read_b128 v[220:223], v16 offset:5760
v_mfma_f32_32x32x16_bf16 v[40:55], v[160:163], v[228:231], v[40:55]
ds_read_b64_tr_b16 v[158:159], v7 offset:2560
buffer_load_dwordx4 v5, s[16:19], s45 offen offset:1024 lds
v_mfma_f32_32x32x16_bf16 v[56:71], v[164:167], v[224:227], v[56:71]
v_mfma_f32_32x32x16_bf16 v[72:87], v[164:167], v[228:231], v[72:87]
s_waitcnt vmcnt(10) lgkmcnt(0)
ds_read_b64_tr_b16 v[160:161], v8 offset:4096
ds_read_b64_tr_b16 v[162:163], v8 offset:5120
s_add_u32 m0, s38, 2048
v_mfma_f32_32x32x16_bf16 v[88:103], v[152:155], v[216:219], v[24:39]
ds_read_b64_tr_b16 v[164:165], v9 offset:4096
buffer_load_dwordx4 v4, s[16:19], s46 offen lds
v_mfma_f32_32x32x16_bf16 v[104:119], v[152:155], v[220:223], v[40:55]
ds_read_b64_tr_b16 v[166:167], v9 offset:5120
buffer_load_dwordx4 v5, s[16:19], s46 offen offset:1024 lds
v_mfma_f32_32x32x16_bf16 v[120:135], v[156:159], v[216:219], v[56:71]
v_mfma_f32_32x32x16_bf16 v[136:151], v[156:159], v[220:223], v[72:87]
s_add_u32 s95, s4, s5
s_add_u32 s95, s95, 0
s_and_b32 s95, s95, 7
s_cmp_eq_u32 s5, 0
s_cselect_b32 s95, 8, s95
s_mul_i32 s100, s6, 9
s_add_u32 s100, s100, s95
s_lshl_b32 s100, s100, 13
s_lshl_b32 s99, s3, 4
s_add_u32 s99, s99, s95
s_lshl_b32 s99, s99, 10
s_lshl_b32 s93, s4, 7
s_add_u32 s99, s99, s93
s_add_u32 s99, s99, 22282240
v_mov_b32 v2, v4
v_mov_b32 v3, v5
s_lshl_b32 s93, s4, 7
v_mul_u32_u24 v4, 1152, v18
v_add3_u32 v4, v4, v19, s93
v_add_u32 v5, 8192, v4
s_mul_i32 s92, s5, 165888
s_add_u32 s92, s92, s7
s_add_u32 s81, s92, 0
s_add_u32 s82, s92, 18432
s_add_u32 s83, s92, 36864
s_add_u32 s84, s92, 55296
s_add_u32 s85, s92, 73728
s_add_u32 s86, s92, 92160
s_add_u32 s87, s92, 110592
s_add_u32 s88, s92, 129024
s_add_u32 s89, s92, 147456
s_mul_i32 s90, s5, 18432
s_add_u32 s90, s90, s2
s_add_u32 s32, s2, 73728
s_cmp_eq_u32 s5, 3
s_cselect_b32 s32, s32, 0x7f000000
s_barrier
s_waitcnt vmcnt(10) lgkmcnt(0)
ds_read_b64_tr_b16 v[152:153], v8 offset:6144
ds_read_b64_tr_b16 v[154:155], v8 offset:7168
s_add_u32 m0, s38, 4096
v_mfma_f32_32x32x16_bf16 v[24:39], v[160:163], a[0:3], 0
ds_read_b64_tr_b16 v[156:157], v9 offset:6144
buffer_load_dwordx4 v2, s[12:15], s47 offen lds
v_cvt_pk_bf16_f32 v88, v88, v89
v_mfma_f32_32x32x16_bf16 v[40:55], v[160:163], a[4:7], 0
ds_read_b64_tr_b16 v[158:159], v9 offset:7168
buffer_load_dwordx4 v3, s[12:15], s47 offen offset:1024 lds
v_cvt_pk_bf16_f32 v89, v90, v91
v_cvt_pk_bf16_f32 v90, v92, v93
v_mfma_f32_32x32x16_bf16 v[56:71], v[164:167], a[0:3], 0
v_cvt_pk_bf16_f32 v91, v94, v95
v_cvt_pk_bf16_f32 v96, v96, v97
v_cvt_pk_bf16_f32 v97, v98, v99
v_mfma_f32_32x32x16_bf16 v[72:87], v[164:167], a[4:7], 0
v_cvt_pk_bf16_f32 v98, v100, v101
v_cvt_pk_bf16_f32 v99, v102, v103
s_waitcnt vmcnt(10) lgkmcnt(0)
ds_read_b64_tr_b16 v[160:161], v8 offset:8192
ds_read_b64_tr_b16 v[162:163], v8 offset:9216
s_add_u32 m0, s38, 6144
v_mfma_f32_32x32x16_bf16 v[24:39], v[152:155], a[8:11], v[24:39]
ds_read_b64_tr_b16 v[164:165], v9 offset:8192
buffer_load_dwordx4 v2, s[12:15], s48 offen lds
v_cvt_pk_bf16_f32 v104, v104, v105
v_mfma_f32_32x32x16_bf16 v[40:55], v[152:155], a[12:15], v[40:55]
ds_read_b64_tr_b16 v[166:167], v9 offset:9216
buffer_load_dwordx4 v3, s[12:15], s48 offen offset:1024 lds
v_cvt_pk_bf16_f32 v105, v106, v107
v_cvt_pk_bf16_f32 v106, v108, v109
v_mfma_f32_32x32x16_bf16 v[56:71], v[156:159], a[8:11], v[56:71]
v_cvt_pk_bf16_f32 v107, v110, v111
v_cvt_pk_bf16_f32 v112, v112, v113
v_cvt_pk_bf16_f32 v113, v114, v115
v_mfma_f32_32x32x16_bf16 v[72:87], v[156:159], a[12:15], v[72:87]
v_cvt_pk_bf16_f32 v114, v116, v117
v_cvt_pk_bf16_f32 v115, v118, v119
s_waitcnt vmcnt(10) lgkmcnt(0)
ds_read_b64_tr_b16 v[152:153], v8 offset:10240
ds_read_b64_tr_b16 v[154:155], v8 offset:11264
s_add_u32 m0, s38, 8192
v_mfma_f32_32x32x16_bf16 v[24:39], v[160:163], a[16:19], v[24:39]
ds_read_b64_tr_b16 v[156:157], v9 offset:10240
buffer_load_dwordx4 v2, s[12:15], s49 offen lds
v_cvt_pk_bf16_f32 v120, v120, v121
v_mfma_f32_32x32x16_bf16 v[40:55], v[160:163], a[20:23], v[40:55]
ds_read_b64_tr_b16 v[158:159], v9 offset:11264
buffer_load_dwordx4 v3, s[12:15], s49 offen offset:1024 lds
v_cvt_pk_bf16_f32 v121, v122, v123
v_cvt_pk_bf16_f32 v122, v124, v125
v_mfma_f32_32x32x16_bf16 v[56:71], v[164:167], a[16:19], v[56:71]
v_cvt_pk_bf16_f32 v123, v126, v127
v_cvt_pk_bf16_f32 v128, v128, v129
v_cvt_pk_bf16_f32 v129, v130, v131
buffer_store_dwordx4 v[88:91], v17, s[20:23], s100 offen offset:0 sc1
v_mfma_f32_32x32x16_bf16 v[72:87], v[164:167], a[20:23], v[72:87]
v_cvt_pk_bf16_f32 v130, v132, v133
v_cvt_pk_bf16_f32 v131, v134, v135
s_waitcnt vmcnt(11) lgkmcnt(0)
ds_read_b64_tr_b16 v[160:161], v14 offset:0
ds_read_b64_tr_b16 v[162:163], v14 offset:1024
s_add_u32 m0, s38, 10240
v_mfma_f32_32x32x16_bf16 v[24:39], v[152:155], a[24:27], v[24:39]
ds_read_b64_tr_b16 v[164:165], v15 offset:0
buffer_load_dwordx4 v2, s[12:15], s50 offen lds
v_cvt_pk_bf16_f32 v136, v136, v137
v_mfma_f32_32x32x16_bf16 v[40:55], v[152:155], a[28:31], v[40:55]
ds_read_b64_tr_b16 v[166:167], v15 offset:1024
buffer_load_dwordx4 v3, s[12:15], s50 offen offset:1024 lds
v_cvt_pk_bf16_f32 v137, v138, v139
v_cvt_pk_bf16_f32 v138, v140, v141
v_mfma_f32_32x32x16_bf16 v[56:71], v[156:159], a[24:27], v[56:71]
v_cvt_pk_bf16_f32 v139, v142, v143
v_cvt_pk_bf16_f32 v144, v144, v145
v_cvt_pk_bf16_f32 v145, v146, v147
v_mfma_f32_32x32x16_bf16 v[72:87], v[156:159], a[28:31], v[72:87]
v_cvt_pk_bf16_f32 v146, v148, v149
v_cvt_pk_bf16_f32 v147, v150, v151
s_waitcnt vmcnt(11) lgkmcnt(0)
ds_read_b64_tr_b16 v[152:153], v8 offset:0
ds_read_b64_tr_b16 v[154:155], v8 offset:1024
s_add_u32 m0, s33, 0
v_mfma_f32_32x32x16_bf16 v[24:39], v[160:163], a[32:35], v[24:39]
ds_read_b64_tr_b16 v[156:157], v9 offset:0
buffer_load_dwordx4 v2, s[12:15], s51 offen lds
v_mfma_f32_32x32x16_bf16 v[40:55], v[160:163], a[36:39], v[40:55]
ds_read_b64_tr_b16 v[158:159], v9 offset:1024
buffer_load_dwordx4 v3, s[12:15], s51 offen offset:1024 lds
v_mfma_f32_32x32x16_bf16 v[56:71], v[164:167], a[32:35], v[56:71]
v_mfma_f32_32x32x16_bf16 v[72:87], v[164:167], a[36:39], v[72:87]
s_waitcnt vmcnt(11) lgkmcnt(0)
ds_read_b64_tr_b16 v[160:161], v8 offset:2048
ds_read_b64_tr_b16 v[162:163], v8 offset:3072
s_add_u32 m0, s38, 0
v_mfma_f32_32x32x16_bf16 v[24:39], v[152:155], a[40:43], v[24:39]
ds_read_b64_tr_b16 v[164:165], v9 offset:2048
buffer_load_dwordx4 v2, s[12:15], s52 offen lds
v_mfma_f32_32x32x16_bf16 v[40:55], v[152:155], a[44:47], v[40:55]
ds_read_b64_tr_b16 v[166:167], v9 offset:3072
buffer_load_dwordx4 v3, s[12:15], s52 offen offset:1024 lds
v_mfma_f32_32x32x16_bf16 v[56:71], v[156:159], a[40:43], v[56:71]
v_mfma_f32_32x32x16_bf16 v[72:87], v[156:159], a[44:47], v[72:87]
s_waitcnt vmcnt(11) lgkmcnt(0)
ds_read_b64_tr_b16 v[152:153], v8 offset:4096
ds_read_b64_tr_b16 v[154:155], v8 offset:5120
s_add_u32 m0, s38, 2048
v_mfma_f32_32x32x16_bf16 v[24:39], v[160:163], a[48:51], v[24:39]
ds_read_b64_tr_b16 v[156:157], v9 offset:4096
buffer_load_dwordx4 v2, s[12:15], s53 offen lds
v_mfma_f32_32x32x16_bf16 v[40:55], v[160:163], a[52:55], v[40:55]
ds_read_b64_tr_b16 v[158:159], v9 offset:5120
buffer_load_dwordx4 v3, s[12:15], s53 offen offset:1024 lds
v_mfma_f32_32x32x16_bf16 v[56:71], v[164:167], a[48:51], v[56:71]
buffer_store_dwordx4 v[96:99], v17, s[20:23], s100 offen offset:1024 sc1
v_mfma_f32_32x32x16_bf16 v[72:87], v[164:167], a[52:55], v[72:87]
s_waitcnt vmcnt(12) lgkmcnt(0)
ds_read_b64_tr_b16 v[160:161], v8 offset:6144
ds_read_b64_tr_b16 v[162:163], v8 offset:7168
s_add_u32 m0, s38, 4096
v_mfma_f32_32x32x16_bf16 v[24:39], v[152:155], a[56:59], v[24:39]
ds_read_b64_tr_b16 v[164:165], v9 offset:6144
buffer_load_dwordx4 v2, s[12:15], s54 offen lds
v_mfma_f32_32x32x16_bf16 v[40:55], v[152:155], a[60:63], v[40:55]
ds_read_b64_tr_b16 v[166:167], v9 offset:7168
buffer_load_dwordx4 v3, s[12:15], s54 offen offset:1024 lds
v_mfma_f32_32x32x16_bf16 v[56:71], v[156:159], a[56:59], v[56:71]
v_mfma_f32_32x32x16_bf16 v[72:87], v[156:159], a[60:63], v[72:87]
s_waitcnt vmcnt(12) lgkmcnt(0)
ds_read_b64_tr_b16 v[152:153], v8 offset:8192
ds_read_b64_tr_b16 v[154:155], v8 offset:9216
s_add_u32 m0, s38, 6144
v_mfma_f32_32x32x16_bf16 v[24:39], v[160:163], a[64:67], v[24:39]
ds_read_b64_tr_b16 v[156:157], v9 offset:8192
buffer_load_dwordx4 v2, s[12:15], s55 offen lds
v_mfma_f32_32x32x16_bf16 v[40:55], v[160:163], a[68:71], v[40:55]
ds_read_b64_tr_b16 v[158:159], v9 offset:9216
buffer_load_dwordx4 v3, s[12:15], s55 offen offset:1024 lds
v_mfma_f32_32x32x16_bf16 v[56:71], v[164:167], a[64:67], v[56:71]
v_mfma_f32_32x32x16_bf16 v[72:87], v[164:167], a[68:71], v[72:87]
s_waitcnt vmcnt(11) lgkmcnt(0)
ds_read_b64_tr_b16 v[160:161], v8 offset:10240
ds_read_b64_tr_b16 v[162:163], v8 offset:11264
s_add_u32 m0, s38, 8192
v_mfma_f32_32x32x16_bf16 v[24:39], v[152:155], a[72:75], v[24:39]
ds_read_b64_tr_b16 v[164:165], v9 offset:10240
buffer_load_dwordx4 v2, s[12:15], s56 offen lds
v_mfma_f32_32x32x16_bf16 v[40:55], v[152:155], a[76:79], v[40:55]
ds_read_b64_tr_b16 v[166:167], v9 offset:11264
buffer_load_dwordx4 v3, s[12:15], s56 offen offset:1024 lds
v_mfma_f32_32x32x16_bf16 v[56:71], v[156:159], a[72:75], v[56:71]
v_mfma_f32_32x32x16_bf16 v[72:87], v[156:159], a[76:79], v[72:87]
s_waitcnt vmcnt(11) lgkmcnt(0)
ds_read_b64_tr_b16 v[152:153], v14 offset:0
ds_read_b64_tr_b16 v[154:155], v14 offset:1024
s_add_u32 m0, s38, 10240
v_mfma_f32_32x32x16_bf16 v[24:39], v[160:163], a[80:83], v[24:39]
ds_read_b64_tr_b16 v[156:157], v15 offset:0
buffer_load_dwordx4 v2, s[12:15], s57 offen lds
v_mfma_f32_32x32x16_bf16 v[40:55], v[160:163], a[84:87], v[40:55]
ds_read_b64_tr_b16 v[158:159], v15 offset:1024
buffer_load_dwordx4 v3, s[12:15], s57 offen offset:1024 lds
v_mfma_f32_32x32x16_bf16 v[56:71], v[164:167], a[80:83], v[56:71]
buffer_store_dwordx4 v[104:107], v17, s[20:23], s100 offen offset:2048 sc1
v_mfma_f32_32x32x16_bf16 v[72:87], v[164:167], a[84:87], v[72:87]
s_waitcnt vmcnt(12) lgkmcnt(0)
ds_read_b64_tr_b16 v[160:161], v8 offset:0
ds_read_b64_tr_b16 v[162:163], v8 offset:1024
s_add_u32 m0, s33, 0
v_mfma_f32_32x32x16_bf16 v[24:39], v[152:155], a[88:91], v[24:39]
ds_read_b64_tr_b16 v[164:165], v9 offset:0
buffer_load_dwordx4 v2, s[12:15], s58 offen lds
v_mfma_f32_32x32x16_bf16 v[40:55], v[152:155], a[92:95], v[40:55]
ds_read_b64_tr_b16 v[166:167], v9 offset:1024
buffer_load_dwordx4 v3, s[12:15], s58 offen offset:1024 lds
v_mfma_f32_32x32x16_bf16 v[56:71], v[156:159], a[88:91], v[56:71]
v_mfma_f32_32x32x16_bf16 v[72:87], v[156:159], a[92:95], v[72:87]
s_waitcnt vmcnt(12) lgkmcnt(0)
ds_read_b64_tr_b16 v[152:153], v8 offset:2048
ds_read_b64_tr_b16 v[154:155], v8 offset:3072
s_add_u32 m0, s38, 0
v_mfma_f32_32x32x16_bf16 v[24:39], v[160:163], a[96:99], v[24:39]
ds_read_b64_tr_b16 v[156:157], v9 offset:2048
buffer_load_dwordx4 v2, s[12:15], s59 offen lds
v_mfma_f32_32x32x16_bf16 v[40:55], v[160:163], a[100:103], v[40:55]
ds_read_b64_tr_b16 v[158:159], v9 offset:3072
buffer_load_dwordx4 v3, s[12:15], s59 offen offset:1024 lds
v_mfma_f32_32x32x16_bf16 v[56:71], v[164:167], a[96:99], v[56:71]
v_mfma_f32_32x32x16_bf16 v[72:87], v[164:167], a[100:103], v[72:87]
s_waitcnt vmcnt(11) lgkmcnt(0)
ds_read_b64_tr_b16 v[160:161], v8 offset:4096
ds_read_b64_tr_b16 v[162:163], v8 offset:5120
s_add_u32 m0, s38, 2048
v_mfma_f32_32x32x16_bf16 v[24:39], v[152:155], a[104:107], v[24:39]
ds_read_b64_tr_b16 v[164:165], v9 offset:4096
buffer_load_dwordx4 v2, s[12:15], s60 offen lds
v_mfma_f32_32x32x16_bf16 v[40:55], v[152:155], a[108:111], v[40:55]
ds_read_b64_tr_b16 v[166:167], v9 offset:5120
buffer_load_dwordx4 v3, s[12:15], s60 offen offset:1024 lds
v_mfma_f32_32x32x16_bf16 v[56:71], v[156:159], a[104:107], v[56:71]
v_mfma_f32_32x32x16_bf16 v[72:87], v[156:159], a[108:111], v[72:87]
s_waitcnt vmcnt(11) lgkmcnt(0)
ds_read_b64_tr_b16 v[152:153], v8 offset:6144
ds_read_b64_tr_b16 v[154:155], v8 offset:7168
s_add_u32 m0, s38, 4096
v_mfma_f32_32x32x16_bf16 v[24:39], v[160:163], a[112:115], v[24:39]
ds_read_b64_tr_b16 v[156:157], v9 offset:6144
buffer_load_dwordx4 v2, s[12:15], s61 offen lds
v_mfma_f32_32x32x16_bf16 v[40:55], v[160:163], a[116:119], v[40:55]
ds_read_b64_tr_b16 v[158:159], v9 offset:7168
buffer_load_dwordx4 v3, s[12:15], s61 offen offset:1024 lds
v_mfma_f32_32x32x16_bf16 v[56:71], v[164:167], a[112:115], v[56:71]
buffer_store_dwordx4 v[112:115], v17, s[20:23], s100 offen offset:3072 sc1
v_mfma_f32_32x32x16_bf16 v[72:87], v[164:167], a[116:119], v[72:87]
s_waitcnt vmcnt(12) lgkmcnt(0)
ds_read_b64_tr_b16 v[160:161], v8 offset:8192
ds_read_b64_tr_b16 v[162:163], v8 offset:9216
s_add_u32 m0, s38, 6144
v_mfma_f32_32x32x16_bf16 v[24:39], v[152:155], a[120:123], v[24:39]
ds_read_b64_tr_b16 v[164:165], v9 offset:8192
buffer_load_dwordx4 v2, s[12:15], s62 offen lds
v_mfma_f32_32x32x16_bf16 v[40:55], v[152:155], a[124:127], v[40:55]
ds_read_b64_tr_b16 v[166:167], v9 offset:9216
buffer_load_dwordx4 v3, s[12:15], s62 offen offset:1024 lds
v_mfma_f32_32x32x16_bf16 v[56:71], v[156:159], a[120:123], v[56:71]
v_mfma_f32_32x32x16_bf16 v[72:87], v[156:159], a[124:127], v[72:87]
s_waitcnt vmcnt(12) lgkmcnt(0)
ds_read_b64_tr_b16 v[152:153], v8 offset:10240
ds_read_b64_tr_b16 v[154:155], v8 offset:11264
s_add_u32 m0, s38, 8192
v_mfma_f32_32x32x16_bf16 v[24:39], v[160:163], a[128:131], v[24:39]
ds_read_b64_tr_b16 v[156:157], v9 offset:10240
buffer_load_dwordx4 v2, s[12:15], s63 offen lds
v_mfma_f32_32x32x16_bf16 v[40:55], v[160:163], a[132:135], v[40:55]
ds_read_b64_tr_b16 v[158:159], v9 offset:11264
buffer_load_dwordx4 v3, s[12:15], s63 offen offset:1024 lds
v_mfma_f32_32x32x16_bf16 v[56:71], v[164:167], a[128:131], v[56:71]
v_mfma_f32_32x32x16_bf16 v[72:87], v[164:167], a[132:135], v[72:87]
s_waitcnt vmcnt(11) lgkmcnt(0)
ds_read_b64_tr_b16 v[160:161], v14 offset:0
ds_read_b64_tr_b16 v[162:163], v14 offset:1024
s_add_u32 m0, s38, 10240
v_mfma_f32_32x32x16_bf16 v[24:39], v[152:155], a[136:139], v[24:39]
ds_read_b64_tr_b16 v[164:165], v15 offset:0
buffer_load_dwordx4 v2, s[12:15], s64 offen lds
v_mfma_f32_32x32x16_bf16 v[40:55], v[152:155], a[140:143], v[40:55]
ds_read_b64_tr_b16 v[166:167], v15 offset:1024
buffer_load_dwordx4 v3, s[12:15], s64 offen offset:1024 lds
v_mfma_f32_32x32x16_bf16 v[56:71], v[156:159], a[136:139], v[56:71]
v_mfma_f32_32x32x16_bf16 v[72:87], v[156:159], a[140:143], v[72:87]
s_waitcnt vmcnt(11) lgkmcnt(0)
ds_read_b64_tr_b16 v[152:153], v8 offset:0
ds_read_b64_tr_b16 v[154:155], v8 offset:1024
s_add_u32 m0, s33, 0
v_mfma_f32_32x32x16_bf16 v[24:39], v[160:163], a[144:147], v[24:39]
ds_read_b64_tr_b16 v[156:157], v9 offset:0
buffer_load_dwordx4 v2, s[12:15], s65 offen lds
v_mfma_f32_32x32x16_bf16 v[40:55], v[160:163], a[148:151], v[40:55]
ds_read_b64_tr_b16 v[158:159], v9 offset:1024
buffer_load_dwordx4 v3, s[12:15], s65 offen offset:1024 lds
v_mfma_f32_32x32x16_bf16 v[56:71], v[164:167], a[144:147], v[56:71]
s_add_u32 s100, s100, 4096
buffer_store_dwordx4 v[120:123], v17, s[20:23], s100 offen offset:0 sc1
v_mfma_f32_32x32x16_bf16 v[72:87], v[164:167], a[148:151], v[72:87]
s_waitcnt vmcnt(12) lgkmcnt(0)
ds_read_b64_tr_b16 v[160:161], v8 offset:2048
ds_read_b64_tr_b16 v[162:163], v8 offset:3072
s_add_u32 m0, s38, 0
v_mfma_f32_32x32x16_bf16 v[24:39], v[152:155], a[152:155], v[24:39]
ds_read_b64_tr_b16 v[164:165], v9 offset:2048
buffer_load_dwordx4 v2, s[12:15], s66 offen lds
v_mfma_f32_32x32x16_bf16 v[40:55], v[152:155], a[156:159], v[40:55]
ds_read_b64_tr_b16 v[166:167], v9 offset:3072
buffer_load_dwordx4 v3, s[12:15], s66 offen offset:1024 lds
v_mfma_f32_32x32x16_bf16 v[56:71], v[156:159], a[152:155], v[56:71]
v_mfma_f32_32x32x16_bf16 v[72:87], v[156:159], a[156:159], v[72:87]
s_waitcnt vmcnt(12) lgkmcnt(0)
ds_read_b64_tr_b16 v[152:153], v8 offset:4096
ds_read_b64_tr_b16 v[154:155], v8 offset:5120
s_add_u32 m0, s38, 2048
v_mfma_f32_32x32x16_bf16 v[24:39], v[160:163], a[160:163], v[24:39]
ds_read_b64_tr_b16 v[156:157], v9 offset:4096
buffer_load_dwordx4 v2, s[12:15], s67 offen lds
v_mfma_f32_32x32x16_bf16 v[40:55], v[160:163], a[164:167], v[40:55]
ds_read_b64_tr_b16 v[158:159], v9 offset:5120
buffer_load_dwordx4 v3, s[12:15], s67 offen offset:1024 lds
v_mfma_f32_32x32x16_bf16 v[56:71], v[164:167], a[160:163], v[56:71]
v_mfma_f32_32x32x16_bf16 v[72:87], v[164:167], a[164:167], v[72:87]
s_waitcnt vmcnt(11) lgkmcnt(0)
ds_read_b64_tr_b16 v[160:161], v8 offset:6144
ds_read_b64_tr_b16 v[162:163], v8 offset:7168
s_add_u32 m0, s38, 4096
v_mfma_f32_32x32x16_bf16 v[24:39], v[152:155], a[168:171], v[24:39]
ds_read_b64_tr_b16 v[164:165], v9 offset:6144
buffer_load_dwordx4 v2, s[12:15], s68 offen lds
v_mfma_f32_32x32x16_bf16 v[40:55], v[152:155], a[172:175], v[40:55]
ds_read_b64_tr_b16 v[166:167], v9 offset:7168
buffer_load_dwordx4 v3, s[12:15], s68 offen offset:1024 lds
v_mfma_f32_32x32x16_bf16 v[56:71], v[156:159], a[168:171], v[56:71]
v_mfma_f32_32x32x16_bf16 v[72:87], v[156:159], a[172:175], v[72:87]
s_waitcnt vmcnt(11) lgkmcnt(0)
ds_read_b64_tr_b16 v[152:153], v8 offset:8192
ds_read_b64_tr_b16 v[154:155], v8 offset:9216
s_add_u32 m0, s38, 6144
v_mfma_f32_32x32x16_bf16 v[24:39], v[160:163], a[176:179], v[24:39]
ds_read_b64_tr_b16 v[156:157], v9 offset:8192
buffer_load_dwordx4 v2, s[12:15], s69 offen lds
v_mfma_f32_32x32x16_bf16 v[40:55], v[160:163], a[180:183], v[40:55]
ds_read_b64_tr_b16 v[158:159], v9 offset:9216
buffer_load_dwordx4 v3, s[12:15], s69 offen offset:1024 lds
v_mfma_f32_32x32x16_bf16 v[56:71], v[164:167], a[176:179], v[56:71]
buffer_store_dwordx4 v[128:131], v17, s[20:23], s100 offen offset:1024 sc1
v_mfma_f32_32x32x16_bf16 v[72:87], v[164:167], a[180:183], v[72:87]
s_waitcnt vmcnt(12) lgkmcnt(0)
ds_read_b64_tr_b16 v[160:161], v8 offset:10240
ds_read_b64_tr_b16 v[162:163], v8 offset:11264
s_add_u32 m0, s38, 8192
v_mfma_f32_32x32x16_bf16 v[24:39], v[152:155], a[184:187], v[24:39]
ds_read_b64_tr_b16 v[164:165], v9 offset:10240
buffer_load_dwordx4 v2, s[12:15], s70 offen lds
v_mfma_f32_32x32x16_bf16 v[40:55], v[152:155], a[188:191], v[40:55]
ds_read_b64_tr_b16 v[166:167], v9 offset:11264
buffer_load_dwordx4 v3, s[12:15], s70 offen offset:1024 lds
v_mfma_f32_32x32x16_bf16 v[56:71], v[156:159], a[184:187], v[56:71]
v_mfma_f32_32x32x16_bf16 v[72:87], v[156:159], a[188:191], v[72:87]
s_waitcnt vmcnt(12) lgkmcnt(0)
ds_read_b64_tr_b16 v[152:153], v14 offset:0
ds_read_b64_tr_b16 v[154:155], v14 offset:1024
s_add_u32 m0, s38, 10240
v_mfma_f32_32x32x16_bf16 v[24:39], v[160:163], a[192:195], v[24:39]
ds_read_b64_tr_b16 v[156:157], v15 offset:0
buffer_load_dwordx4 v2, s[12:15], s71 offen lds
v_mfma_f32_32x32x16_bf16 v[40:55], v[160:163], a[196:199], v[40:55]
ds_read_b64_tr_b16 v[158:159], v15 offset:1024
buffer_load_dwordx4 v3, s[12:15], s71 offen offset:1024 lds
v_mfma_f32_32x32x16_bf16 v[56:71], v[164:167], a[192:195], v[56:71]
v_mfma_f32_32x32x16_bf16 v[72:87], v[164:167], a[196:199], v[72:87]
s_waitcnt vmcnt(11) lgkmcnt(0)
ds_read_b64_tr_b16 v[160:161], v8 offset:0
ds_read_b64_tr_b16 v[162:163], v8 offset:1024
s_add_u32 m0, s33, 0
v_mfma_f32_32x32x16_bf16 v[24:39], v[152:155], a[200:203], v[24:39]
ds_read_b64_tr_b16 v[164:165], v9 offset:0
buffer_load_dwordx4 v2, s[12:15], s72 offen lds
v_mfma_f32_32x32x16_bf16 v[40:55], v[152:155], a[204:207], v[40:55]
ds_read_b64_tr_b16 v[166:167], v9 offset:1024
buffer_load_dwordx4 v3, s[12:15], s72 offen offset:1024 lds
v_mfma_f32_32x32x16_bf16 v[56:71], v[156:159], a[200:203], v[56:71]
v_mfma_f32_32x32x16_bf16 v[72:87], v[156:159], a[204:207], v[72:87]
s_waitcnt vmcnt(11) lgkmcnt(0)
ds_read_b64_tr_b16 v[152:153], v8 offset:2048
ds_read_b64_tr_b16 v[154:155], v8 offset:3072
s_add_u32 m0, s38, 0
v_mfma_f32_32x32x16_bf16 v[24:39], v[160:163], a[208:211], v[24:39]
ds_read_b64_tr_b16 v[156:157], v9 offset:2048
buffer_load_dwordx4 v2, s[12:15], s73 offen lds
v_mfma_f32_32x32x16_bf16 v[40:55], v[160:163], a[212:215], v[40:55]
ds_read_b64_tr_b16 v[158:159], v9 offset:3072
buffer_load_dwordx4 v3, s[12:15], s73 offen offset:1024 lds
v_mfma_f32_32x32x16_bf16 v[56:71], v[164:167], a[208:211], v[56:71]
buffer_store_dwordx4 v[136:139], v17, s[20:23], s100 offen offset:2048 sc1
v_mfma_f32_32x32x16_bf16 v[72:87], v[164:167], a[212:215], v[72:87]
s_waitcnt vmcnt(12) lgkmcnt(0)
ds_read_b64_tr_b16 v[160:161], v8 offset:4096
ds_read_b64_tr_b16 v[162:163], v8 offset:5120
s_add_u32 m0, s38, 2048
v_mfma_f32_32x32x16_bf16 v[24:39], v[152:155], a[216:219], v[24:39]
ds_read_b64_tr_b16 v[164:165], v9 offset:4096
buffer_load_dwordx4 v2, s[12:15], s74 offen lds
v_mfma_f32_32x32x16_bf16 v[40:55], v[152:155], a[220:223], v[40:55]
ds_read_b64_tr_b16 v[166:167], v9 offset:5120
buffer_load_dwordx4 v3, s[12:15], s74 offen offset:1024 lds
v_mfma_f32_32x32x16_bf16 v[56:71], v[156:159], a[216:219], v[56:71]
v_mfma_f32_32x32x16_bf16 v[72:87], v[156:159], a[220:223], v[72:87]
s_waitcnt vmcnt(12) lgkmcnt(0)
ds_read_b64_tr_b16 v[152:153], v8 offset:6144
ds_read_b64_tr_b16 v[154:155], v8 offset:7168
s_add_u32 m0, s38, 4096
v_mfma_f32_32x32x16_bf16 v[24:39], v[160:163], a[224:227], v[24:39]
ds_read_b64_tr_b16 v[156:157], v9 offset:6144
buffer_load_dwordx4 v2, s[12:15], s75 offen lds
v_mfma_f32_32x32x16_bf16 v[40:55], v[160:163], a[228:231], v[40:55]
ds_read_b64_tr_b16 v[158:159], v9 offset:7168
buffer_load_dwordx4 v3, s[12:15], s75 offen offset:1024 lds
v_mfma_f32_32x32x16_bf16 v[56:71], v[164:167], a[224:227], v[56:71]
v_mfma_f32_32x32x16_bf16 v[72:87], v[164:167], a[228:231], v[72:87]
s_waitcnt vmcnt(11) lgkmcnt(0)
ds_read_b64_tr_b16 v[160:161], v8 offset:8192
ds_read_b64_tr_b16 v[162:163], v8 offset:9216
s_add_u32 m0, s38, 6144
v_mfma_f32_32x32x16_bf16 v[24:39], v[152:155], a[232:235], v[24:39]
ds_read_b64_tr_b16 v[164:165], v9 offset:8192
buffer_load_dwordx4 v2, s[28:31], s76 offen lds
v_mfma_f32_32x32x16_bf16 v[40:55], v[152:155], a[236:239], v[40:55]
ds_read_b64_tr_b16 v[166:167], v9 offset:9216
buffer_load_dwordx4 v3, s[28:31], s76 offen offset:1024 lds
v_mfma_f32_32x32x16_bf16 v[56:71], v[156:159], a[232:235], v[56:71]
v_mfma_f32_32x32x16_bf16 v[72:87], v[156:159], a[236:239], v[72:87]
s_waitcnt vmcnt(11) lgkmcnt(0)
ds_read_b64_tr_b16 v[152:153], v8 offset:10240
ds_read_b64_tr_b16 v[154:155], v8 offset:11264
s_add_u32 m0, s38, 8192
v_mfma_f32_32x32x16_bf16 v[24:39], v[160:163], a[240:243], v[24:39]
ds_read_b64_tr_b16 v[156:157], v9 offset:10240
buffer_load_dwordx4 v2, s[28:31], s77 offen lds
v_mfma_f32_32x32x16_bf16 v[40:55], v[160:163], a[244:247], v[40:55]
ds_read_b64_tr_b16 v[158:159], v9 offset:11264
buffer_load_dwordx4 v3, s[28:31], s77 offen offset:1024 lds
s_add_u32 m0, s33, 2048
v_mfma_f32_32x32x16_bf16 v[56:71], v[164:167], a[240:243], v[56:71]
buffer_load_dwordx4 v2, s[28:31], s78 offen lds
buffer_store_dwordx4 v[144:147], v17, s[20:23], s100 offen offset:3072 sc1
v_mfma_f32_32x32x16_bf16 v[72:87], v[164:167], a[244:247], v[72:87]
buffer_load_dwordx4 v3, s[28:31], s78 offen offset:1024 lds
s_waitcnt vmcnt(14) lgkmcnt(0)
ds_read_b64_tr_b16 v[160:161], v14 offset:0
ds_read_b64_tr_b16 v[162:163], v14 offset:1024
s_add_u32 m0, s38, 10240
v_mfma_f32_32x32x16_bf16 v[24:39], v[152:155], a[248:251], v[24:39]
ds_read_b64_tr_b16 v[164:165], v15 offset:0
buffer_load_dwordx4 v2, s[28:31], s79 offen lds
v_mfma_f32_32x32x16_bf16 v[40:55], v[152:155], a[252:255], v[40:55]
ds_read_b64_tr_b16 v[166:167], v15 offset:1024
buffer_load_dwordx4 v3, s[28:31], s79 offen offset:1024 lds
s_add_u32 m0, s33, 4096
v_mfma_f32_32x32x16_bf16 v[56:71], v[156:159], a[248:251], v[56:71]
buffer_load_dwordx4 v2, s[28:31], s80 offen lds
v_mfma_f32_32x32x16_bf16 v[72:87], v[156:159], a[252:255], v[72:87]
buffer_load_dwordx4 v3, s[28:31], s80 offen offset:1024 lds
s_waitcnt vmcnt(16) lgkmcnt(0)
ds_read_b64_tr_b16 v[152:153], v8 offset:0
ds_read_b64_tr_b16 v[154:155], v8 offset:1024
s_add_u32 m0, s33, 0
v_mfma_f32_32x32x16_bf16 v[24:39], v[160:163], v[184:187], v[24:39]
ds_read_b64_tr_b16 v[156:157], v9 offset:0
buffer_load_dwordx4 v4, s[16:19], s81 offen lds
v_mfma_f32_32x32x16_bf16 v[40:55], v[160:163], v[188:191], v[40:55]
ds_read_b64_tr_b16 v[158:159], v9 offset:1024
buffer_load_dwordx4 v5, s[16:19], s81 offen offset:1024 lds
s_add_u32 m0, s33, 6144
v_mfma_f32_32x32x16_bf16 v[56:71], v[164:167], v[184:187], v[56:71]
buffer_load_dwordx4 v4, s[16:19], s82 offen lds
v_mfma_f32_32x32x16_bf16 v[72:87], v[164:167], v[188:191], v[72:87]
buffer_load_dwordx4 v5, s[16:19], s82 offen offset:1024 lds
s_waitcnt vmcnt(17) lgkmcnt(0)
ds_read_b64_tr_b16 v[160:161], v8 offset:2048
ds_read_b64_tr_b16 v[162:163], v8 offset:3072
s_add_u32 m0, s38, 0
v_mfma_f32_32x32x16_bf16 v[24:39], v[152:155], v[192:195], v[24:39]
ds_read_b64_tr_b16 v[164:165], v9 offset:2048
buffer_load_dwordx4 v4, s[16:19], s83 offen lds
v_mfma_f32_32x32x16_bf16 v[40:55], v[152:155], v[196:199], v[40:55]
ds_read_b64_tr_b16 v[166:167], v9 offset:3072
buffer_load_dwordx4 v5, s[16:19], s83 offen offset:1024 lds
s_add_u32 m0, s33, 32768
v_mfma_f32_32x32x16_bf16 v[56:71], v[156:159], v[192:195], v[56:71]
buffer_load_dwordx4 v4, s[16:19], s84 offen lds
v_mfma_f32_32x32x16_bf16 v[72:87], v[156:159], v[196:199], v[72:87]
buffer_load_dwordx4 v5, s[16:19], s84 offen offset:1024 lds
s_waitcnt vmcnt(19) lgkmcnt(0)
ds_read_b64_tr_b16 v[152:153], v8 offset:4096
ds_read_b64_tr_b16 v[154:155], v8 offset:5120
s_add_u32 m0, s38, 2048
v_mfma_f32_32x32x16_bf16 v[24:39], v[160:163], v[200:203], v[24:39]
ds_read_b64_tr_b16 v[156:157], v9 offset:4096
buffer_load_dwordx4 v4, s[16:19], s85 offen lds
v_mfma_f32_32x32x16_bf16 v[40:55], v[160:163], v[204:207], v[40:55]
ds_read_b64_tr_b16 v[158:159], v9 offset:5120
buffer_load_dwordx4 v5, s[16:19], s85 offen offset:1024 lds
v_mfma_f32_32x32x16_bf16 v[56:71], v[164:167], v[200:203], v[56:71]
v_mfma_f32_32x32x16_bf16 v[72:87], v[164:167], v[204:207], v[72:87]
s_waitcnt vmcnt(19) lgkmcnt(0)
ds_read_b64_tr_b16 v[160:161], v6 offset:6144
ds_read_b64_tr_b16 v[162:163], v6 offset:6656
s_add_u32 m0, s38, 4096
v_mfma_f32_32x32x16_bf16 v[24:39], v[152:155], v[208:211], v[24:39]
ds_read_b64_tr_b16 v[164:165], v7 offset:6144
buffer_load_dwordx4 v4, s[16:19], s86 offen lds
ds_read_b128 v[216:219], v16 offset:0
ds_read_b128 v[220:223], v16 offset:5632
v_mfma_f32_32x32x16_bf16 v[40:55], v[152:155], v[212:215], v[40:55]
ds_read_b64_tr_b16 v[166:167], v7 offset:6656
buffer_load_dwordx4 v5, s[16:19], s86 offen offset:1024 lds
v_mfma_f32_32x32x16_bf16 v[56:71], v[156:159], v[208:211], v[56:71]
v_mfma_f32_32x32x16_bf16 v[72:87], v[156:159], v[212:215], v[72:87]
s_waitcnt vmcnt(19) lgkmcnt(0)
ds_read_b64_tr_b16 v[152:153], v6 offset:8192
ds_read_b64_tr_b16 v[154:155], v6 offset:8704
s_add_u32 m0, s38, 6144
v_mfma_f32_32x32x16_bf16 v[24:39], v[160:163], v[216:219], v[24:39]
ds_read_b64_tr_b16 v[156:157], v7 offset:8192
buffer_load_dwordx4 v4, s[16:19], s87 offen lds
ds_read_b128 v[224:227], v16 offset:32
ds_read_b128 v[228:231], v16 offset:5664
v_mfma_f32_32x32x16_bf16 v[40:55], v[160:163], v[220:223], v[40:55]
ds_read_b64_tr_b16 v[158:159], v7 offset:8704
buffer_load_dwordx4 v5, s[16:19], s87 offen offset:1024 lds
v_mfma_f32_32x32x16_bf16 v[56:71], v[164:167], v[216:219], v[56:71]
v_mfma_f32_32x32x16_bf16 v[72:87], v[164:167], v[220:223], v[72:87]
s_waitcnt vmcnt(18) lgkmcnt(0)
ds_read_b64_tr_b16 v[160:161], v172 offset:2048
ds_read_b64_tr_b16 v[162:163], v172 offset:2560
s_add_u32 m0, s38, 8192
v_mfma_f32_32x32x16_bf16 v[24:39], v[152:155], v[224:227], v[24:39]
ds_read_b64_tr_b16 v[164:165], v173 offset:2048
buffer_load_dwordx4 v4, s[16:19], s88 offen lds
ds_read_b128 v[216:219], v16 offset:64
ds_read_b128 v[220:223], v16 offset:5696
v_mfma_f32_32x32x16_bf16 v[40:55], v[152:155], v[228:231], v[40:55]
ds_read_b64_tr_b16 v[166:167], v173 offset:2560
buffer_load_dwordx4 v5, s[16:19], s88 offen offset:1024 lds
v_mfma_f32_32x32x16_bf16 v[56:71], v[156:159], v[224:227], v[56:71]
v_mfma_f32_32x32x16_bf16 v[72:87], v[156:159], v[228:231], v[72:87]
s_waitcnt vmcnt(18) lgkmcnt(0)
ds_read_b64_tr_b16 v[152:153], v6 offset:10240
ds_read_b64_tr_b16 v[154:155], v6 offset:10752
s_add_u32 m0, s33, 2048
v_mfma_f32_32x32x16_bf16 v[24:39], v[160:163], v[216:219], v[24:39]
ds_read_b64_tr_b16 v[156:157], v7 offset:10240
buffer_load_dwordx4 v4, s[16:19], s89 offen lds
ds_read_b128 v[224:227], v16 offset:96
ds_read_b128 v[228:231], v16 offset:5728
v_mfma_f32_32x32x16_bf16 v[40:55], v[160:163], v[220:223], v[40:55]
ds_read_b64_tr_b16 v[158:159], v7 offset:10752
buffer_load_dwordx4 v5, s[16:19], s89 offen offset:1024 lds
v_mfma_f32_32x32x16_bf16 v[56:71], v[164:167], v[216:219], v[56:71]
v_mfma_f32_32x32x16_bf16 v[72:87], v[164:167], v[220:223], v[72:87]
s_waitcnt vmcnt(18) lgkmcnt(0)
ds_read_b64_tr_b16 v[160:161], v172 offset:4096
ds_read_b64_tr_b16 v[162:163], v172 offset:4608
s_add_u32 m0, s38, 10240
v_mfma_f32_32x32x16_bf16 v[24:39], v[152:155], v[224:227], v[24:39]
ds_read_b64_tr_b16 v[164:165], v173 offset:4096
buffer_load_dwordx4 v4, s[28:31], s90 offen lds
ds_read_b128 v[216:219], v16 offset:128
ds_read_b128 v[220:223], v16 offset:5760
v_mfma_f32_32x32x16_bf16 v[40:55], v[152:155], v[228:231], v[40:55]
ds_read_b64_tr_b16 v[166:167], v173 offset:4608
buffer_load_dwordx4 v5, s[28:31], s90 offen offset:1024 lds
v_mfma_f32_32x32x16_bf16 v[56:71], v[156:159], v[224:227], v[56:71]
v_mfma_f32_32x32x16_bf16 v[72:87], v[156:159], v[228:231], v[72:87]
s_waitcnt vmcnt(18) lgkmcnt(0)
ds_read_b64_tr_b16 v[152:153], v14 offset:0
ds_read_b64_tr_b16 v[154:155], v14 offset:1024
s_add_u32 m0, s33, 4096
v_mfma_f32_32x32x16_bf16 v[88:103], v[160:163], v[216:219], v[24:39]
ds_read_b64_tr_b16 v[156:157], v15 offset:0
buffer_load_dwordx4 v4, s[28:31], s32 offen lds
v_mfma_f32_32x32x16_bf16 v[104:119], v[160:163], v[220:223], v[40:55]
ds_read_b64_tr_b16 v[158:159], v15 offset:1024
buffer_load_dwordx4 v5, s[28:31], s32 offen offset:1024 lds
v_mfma_f32_32x32x16_bf16 v[120:135], v[164:167], v[216:219], v[56:71]
v_mov_b32 v21, s39
v_mov_b32 v22, 0
v_cmp_eq_u32 vcc, 0, v1
s_and_saveexec_b64 s[0:1], vcc
buffer_store_dword v21, v22, s[20:23], s99 offen sc1
s_mov_b64 exec, s[0:1]
v_mfma_f32_32x32x16_bf16 v[136:151], v[164:167], v[220:223], v[72:87]
s_add_u32 s95, s4, s5
s_add_u32 s95, s95, 4
s_and_b32 s95, s95, 7
s_mul_i32 s101, s6, 9
s_add_u32 s101, s101, s95
s_lshl_b32 s101, s101, 13
s_lshl_b32 s91, s3, 4
s_add_u32 s91, s91, s95
s_lshl_b32 s91, s91, 10
s_lshl_b32 s93, s4, 7
s_add_u32 s91, s91, s93
s_add_u32 s91, s91, 22282240
s_lshl_b32 s94, s5, 11
s_add_u32 s92, s4, 7
s_and_b32 s92, s92, 7
s_lshl_b32 s40, s3, 3
s_add_u32 s40, s40, s92
s_mul_i32 s40, s40, 9
s_add_u32 s40, s40, s4
s_lshl_b32 s40, s40, 13
s_add_u32 s40, s40, s94
s_add_u32 s92, s4, 6
s_and_b32 s92, s92, 7
s_lshl_b32 s41, s3, 3
s_add_u32 s41, s41, s92
s_mul_i32 s41, s41, 9
s_add_u32 s41, s41, s4
s_lshl_b32 s41, s41, 13
s_add_u32 s41, s41, s94
s_add_u32 s92, s4, 5
s_and_b32 s92, s92, 7
s_lshl_b32 s42, s3, 3
s_add_u32 s42, s42, s92
s_mul_i32 s42, s42, 9
s_add_u32 s42, s42, s4
s_lshl_b32 s42, s42, 13
s_add_u32 s42, s42, s94
s_add_u32 s92, s4, 4
s_and_b32 s92, s92, 7
s_lshl_b32 s43, s3, 3
s_add_u32 s43, s43, s92
s_mul_i32 s43, s43, 9
s_add_u32 s43, s43, s4
s_lshl_b32 s43, s43, 13
s_add_u32 s43, s43, s94
s_add_u32 s92, s4, 3
s_and_b32 s92, s92, 7
s_lshl_b32 s44, s3, 3
s_add_u32 s44, s44, s92
s_mul_i32 s44, s44, 9
s_add_u32 s44, s44, s4
s_lshl_b32 s44, s44, 13
s_add_u32 s44, s44, s94
s_add_u32 s92, s4, 2
s_and_b32 s92, s92, 7
s_lshl_b32 s45, s3, 3
s_add_u32 s45, s45, s92
s_mul_i32 s45, s45, 9
s_add_u32 s45, s45, s4
s_lshl_b32 s45, s45, 13
s_add_u32 s45, s45, s94
s_add_u32 s92, s4, 1
s_and_b32 s92, s92, 7
s_lshl_b32 s46, s3, 3
s_add_u32 s46, s46, s92
s_mul_i32 s46, s46, 9
s_add_u32 s46, s46, s4
s_lshl_b32 s46, s46, 13
s_add_u32 s46, s46, s94
s_lshl_b32 s94, s4, 10
s_mov_b32 s92, 0
s_lshl_b32 s47, s3, 3
s_add_u32 s47, s47, s92
s_mul_i32 s47, s47, 9
s_add_u32 s47, s47, 8
s_lshl_b32 s47, s47, 13
s_add_u32 s47, s47, s94
s_mov_b32 s92, 1
s_lshl_b32 s48, s3, 3
s_add_u32 s48, s48, s92
s_mul_i32 s48, s48, 9
s_add_u32 s48, s48, 8
s_lshl_b32 s48, s48, 13
s_add_u32 s48, s48, s94
s_mov_b32 s92, 2
s_lshl_b32 s49, s3, 3
s_add_u32 s49, s49, s92
s_mul_i32 s49, s49, 9
s_add_u32 s49, s49, 8
s_lshl_b32 s49, s49, 13
s_add_u32 s49, s49, s94
s_mov_b32 s92, 3
s_lshl_b32 s50, s3, 3
s_add_u32 s50, s50, s92
s_mul_i32 s50, s50, 9
s_add_u32 s50, s50, 8
s_lshl_b32 s50, s50, 13
s_add_u32 s50, s50, s94
s_mov_b32 s92, 4
s_lshl_b32 s51, s3, 3
s_add_u32 s51, s51, s92
s_mul_i32 s51, s51, 9
s_add_u32 s51, s51, 8
s_lshl_b32 s51, s51, 13
s_add_u32 s51, s51, s94
s_mov_b32 s92, 5
s_lshl_b32 s52, s3, 3
s_add_u32 s52, s52, s92
s_mul_i32 s52, s52, 9
s_add_u32 s52, s52, 8
s_lshl_b32 s52, s52, 13
s_add_u32 s52, s52, s94
s_mov_b32 s92, 6
s_lshl_b32 s53, s3, 3
s_add_u32 s53, s53, s92
s_mul_i32 s53, s53, 9
s_add_u32 s53, s53, 8
s_lshl_b32 s53, s53, 13
s_add_u32 s53, s53, s94
s_mov_b32 s92, 7
s_lshl_b32 s54, s3, 3
s_add_u32 s54, s54, s92
s_mul_i32 s54, s54, 9
s_add_u32 s54, s54, 8
s_lshl_b32 s54, s54, 13
s_add_u32 s54, s54, s94
s_lshl_b32 s55, 0xe0e0, s4
s_lshr_b32 s55, s55, 8
s_and_b32 s55, s55, 0xff
s_lshl_b32 s92, 1, s4
s_or_b32 s92, s92, s55
s_andn2_b32 s56, 0xff, s92
s_mov_b32 s57, 0x00003f80
s_mov_b32 s58, 0x3f800000
s_lshl_b32 s96, s3, 4
s_add_u32 s96, s96, s4
s_lshl_b32 s96, s96, 10
s_add_u32 s96, s96, 22282240
s_lshl_b32 s97, s3, 4
s_add_u32 s97, s97, 8
s_lshl_b32 s97, s97, 10
s_add_u32 s97, s97, 22282240
s_bfe_u32 s93, s4, 0x10001
s_lshl_b32 s93, s93, 5
s_lshl_b32 s60, s3, 6
s_add_u32 s60, s60, s93
s_mul_i32 s60, s60, 1152
s_lshr_b32 s93, s4, 2
s_lshl_b32 s93, s93, 6
s_add_u32 s60, s60, s93
s_and_b32 s93, s4, 1
s_lshl_b32 s93, s93, 5
s_add_u32 s60, s60, s93
s_add_u32 s60, s60, 1024
v_and_b32 v21, 31, v1
v_mul_u32_u24 v21, 1152, v21
v_lshrrev_b32 v22, 5, v1
v_lshl_add_u32 v10, v22, 4, v21
v_min_u32 v11, 7, v1
v_lshlrev_b32 v11, 7, v11
s_cmp_eq_u32 s5, 1
s_cbranch_scc1 L_sp1
s_cmp_eq_u32 s5, 2
s_cbranch_scc1 L_sp2
s_cmp_eq_u32 s5, 3
s_cbranch_scc1 L_sp3
L_sp0:
s_lshl_b32 s59, s3, 6
s_add_u32 s59, s59, 0
s_mul_i32 s59, s59, 1152
s_lshl_b32 s93, s4, 7
s_add_u32 s59, s59, s93
s_add_u32 s59, s59, 0
s_waitcnt vmcnt(19) lgkmcnt(0)
ds_read_b64_tr_b16 v[160:161], v14 offset:6144
ds_read_b64_tr_b16 v[162:163], v14 offset:7168
v_mfma_f32_32x32x16_bf16 v[24:39], v[152:155], a[0:3], 0
ds_read_b64_tr_b16 v[164:165], v15 offset:6144
v_cvt_pk_bf16_f32 v88, v88, v89
v_cvt_pk_bf16_f32 v89, v90, v91
v_cvt_pk_bf16_f32 v90, v92, v93
v_cvt_pk_bf16_f32 v91, v94, v95
v_cvt_pk_bf16_f32 v96, v96, v97
v_mfma_f32_32x32x16_bf16 v[40:55], v[152:155], a[4:7], 0
ds_read_b64_tr_b16 v[166:167], v15 offset:7168
v_cvt_pk_bf16_f32 v97, v98, v99
v_cvt_pk_bf16_f32 v98, v100, v101
v_cvt_pk_bf16_f32 v99, v102, v103
v_cvt_pk_bf16_f32 v104, v104, v105
v_cvt_pk_bf16_f32 v105, v106, v107
v_cvt_pk_bf16_f32 v106, v108, v109
v_mfma_f32_32x32x16_bf16 v[56:71], v[156:159], a[0:3], 0
v_cvt_pk_bf16_f32 v107, v110, v111
v_cvt_pk_bf16_f32 v112, v112, v113
v_cvt_pk_bf16_f32 v113, v114, v115
v_cvt_pk_bf16_f32 v114, v116, v117
v_cvt_pk_bf16_f32 v115, v118, v119
v_cvt_pk_bf16_f32 v120, v120, v121
v_cvt_pk_bf16_f32 v121, v122, v123
v_cvt_pk_bf16_f32 v122, v124, v125
v_cvt_pk_bf16_f32 v123, v126, v127
v_cvt_pk_bf16_f32 v128, v128, v129
v_cvt_pk_bf16_f32 v129, v130, v131
v_cvt_pk_bf16_f32 v130, v132, v133
v_cvt_pk_bf16_f32 v131, v134, v135
v_cvt_pk_bf16_f32 v136, v136, v137
v_mfma_f32_32x32x16_bf16 v[72:87], v[156:159], a[4:7], 0
v_cvt_pk_bf16_f32 v137, v138, v139
v_cvt_pk_bf16_f32 v138, v140, v141
v_cvt_pk_bf16_f32 v139, v142, v143
v_cvt_pk_bf16_f32 v144, v144, v145
v_cvt_pk_bf16_f32 v145, v146, v147
v_cvt_pk_bf16_f32 v146, v148, v149
v_cvt_pk_bf16_f32 v147, v150, v151
s_waitcnt vmcnt(17) lgkmcnt(0)
ds_read_b64_tr_b16 v[152:153], v8 offset:0
ds_read_b64_tr_b16 v[154:155], v8 offset:1024
v_mfma_f32_32x32x16_bf16 v[24:39], v[160:163], a[8:11], v[24:39]
ds_read_b64_tr_b16 v[156:157], v9 offset:0
buffer_store_dwordx4 v[88:91], v17, s[20:23], s101 offen offset:0 sc1
v_mfma_f32_32x32x16_bf16 v[40:55], v[160:163], a[12:15], v[40:55]
ds_read_b64_tr_b16 v[158:159], v9 offset:1024
buffer_store_dwordx4 v[96:99], v17, s[20:23], s101 offen offset:1024 sc1
v_mfma_f32_32x32x16_bf16 v[56:71], v[164:167], a[8:11], v[56:71]
buffer_store_dwordx4 v[104:107], v17, s[20:23], s101 offen offset:2048 sc1
v_mfma_f32_32x32x16_bf16 v[72:87], v[164:167], a[12:15], v[72:87]
buffer_store_dwordx4 v[112:115], v17, s[20:23], s101 offen offset:3072 sc1
s_waitcnt vmcnt(19) lgkmcnt(0)
ds_read_b64_tr_b16 v[160:161], v14 offset:32768
ds_read_b64_tr_b16 v[162:163], v14 offset:33792
v_mfma_f32_32x32x16_bf16 v[24:39], v[152:155], a[16:19], v[24:39]
ds_read_b64_tr_b16 v[164:165], v15 offset:32768
s_add_u32 s101, s101, 4096
v_mfma_f32_32x32x16_bf16 v[40:55], v[152:155], a[20:23], v[40:55]
ds_read_b64_tr_b16 v[166:167], v15 offset:33792
buffer_store_dwordx4 v[120:123], v17, s[20:23], s101 offen offset:0 sc1
v_mfma_f32_32x32x16_bf16 v[56:71], v[156:159], a[16:19], v[56:71]
buffer_store_dwordx4 v[128:131], v17, s[20:23], s101 offen offset:1024 sc1
buffer_store_dwordx4 v[136:139], v17, s[20:23], s101 offen offset:2048 sc1
v_mfma_f32_32x32x16_bf16 v[72:87], v[156:159], a[20:23], v[72:87]
buffer_store_dwordx4 v[144:147], v17, s[20:23], s101 offen offset:3072 sc1
s_waitcnt vmcnt(21) lgkmcnt(0)
ds_read_b64_tr_b16 v[152:153], v8 offset:2048
ds_read_b64_tr_b16 v[154:155], v8 offset:3072
v_mfma_f32_32x32x16_bf16 v[24:39], v[160:163], a[24:27], v[24:39]
ds_read_b64_tr_b16 v[156:157], v9 offset:2048
v_mfma_f32_32x32x16_bf16 v[40:55], v[160:163], a[28:31], v[40:55]
ds_read_b64_tr_b16 v[158:159], v9 offset:3072
v_mfma_f32_32x32x16_bf16 v[56:71], v[164:167], a[24:27], v[56:71]
buffer_load_dword v22, v11, s[20:23], s96 offen sc1
v_mfma_f32_32x32x16_bf16 v[72:87], v[164:167], a[28:31], v[72:87]
s_waitcnt vmcnt(20) lgkmcnt(0)
ds_read_b64_tr_b16 v[160:161], v8 offset:4096
ds_read_b64_tr_b16 v[162:163], v8 offset:5120
v_mfma_f32_32x32x16_bf16 v[24:39], v[152:155], a[32:35], v[24:39]
ds_read_b64_tr_b16 v[164:165], v9 offset:4096
v_mfma_f32_32x32x16_bf16 v[40:55], v[152:155], a[36:39], v[40:55]
ds_read_b64_tr_b16 v[166:167], v9 offset:5120
v_mfma_f32_32x32x16_bf16 v[56:71], v[156:159], a[32:35], v[56:71]
buffer_load_dwordx4 v[176:179], v10, s[8:11], s59 offen offset:0
buffer_load_dwordx4 v[180:183], v10, s[8:11], s59 offen offset:32
v_mfma_f32_32x32x16_bf16 v[72:87], v[156:159], a[36:39], v[72:87]
s_waitcnt vmcnt(20) lgkmcnt(0)
ds_read_b64_tr_b16 v[152:153], v8 offset:6144
ds_read_b64_tr_b16 v[154:155], v8 offset:7168
v_mfma_f32_32x32x16_bf16 v[24:39], v[160:163], a[40:43], v[24:39]
ds_read_b64_tr_b16 v[156:157], v9 offset:6144
v_mfma_f32_32x32x16_bf16 v[40:55], v[160:163], a[44:47], v[40:55]
ds_read_b64_tr_b16 v[158:159], v9 offset:7168
v_mfma_f32_32x32x16_bf16 v[56:71], v[164:167], a[40:43], v[56:71]
v_mfma_f32_32x32x16_bf16 v[72:87], v[164:167], a[44:47], v[72:87]
s_waitcnt vmcnt(18) lgkmcnt(0)
ds_read_b64_tr_b16 v[160:161], v8 offset:8192
ds_read_b64_tr_b16 v[162:163], v8 offset:9216
v_mfma_f32_32x32x16_bf16 v[24:39], v[152:155], a[48:51], v[24:39]
ds_read_b64_tr_b16 v[164:165], v9 offset:8192
v_mfma_f32_32x32x16_bf16 v[40:55], v[152:155], a[52:55], v[40:55]
ds_read_b64_tr_b16 v[166:167], v9 offset:9216
v_mfma_f32_32x32x16_bf16 v[56:71], v[156:159], a[48:51], v[56:71]
v_mfma_f32_32x32x16_bf16 v[72:87], v[156:159], a[52:55], v[72:87]
s_waitcnt vmcnt(16) lgkmcnt(0)
ds_read_b64_tr_b16 v[152:153], v14 offset:2048
ds_read_b64_tr_b16 v[154:155], v14 offset:3072
v_mfma_f32_32x32x16_bf16 v[24:39], v[160:163], a[56:59], v[24:39]
ds_read_b64_tr_b16 v[156:157], v15 offset:2048
ds_read_b128 v[216:219], v16 offset:0
ds_read_b128 v[220:223], v16 offset:5632
v_mfma_f32_32x32x16_bf16 v[40:55], v[160:163], a[60:63], v[40:55]
ds_read_b64_tr_b16 v[158:159], v15 offset:3072
v_mfma_f32_32x32x16_bf16 v[56:71], v[164:167], a[56:59], v[56:71]
v_mfma_f32_32x32x16_bf16 v[72:87], v[164:167], a[60:63], v[72:87]
s_waitcnt vmcnt(14) lgkmcnt(0)
ds_read_b64_tr_b16 v[160:161], v6 offset:10240
ds_read_b64_tr_b16 v[162:163], v6 offset:10752
v_mfma_f32_32x32x16_bf16 v[24:39], v[152:155], a[64:67], v[24:39]
ds_read_b64_tr_b16 v[164:165], v7 offset:10240
v_mfma_f32_32x32x16_bf16 v[40:55], v[152:155], a[68:71], v[40:55]
ds_read_b64_tr_b16 v[166:167], v7 offset:10752
v_mfma_f32_32x32x16_bf16 v[56:71], v[156:159], a[64:67], v[56:71]
v_mfma_f32_32x32x16_bf16 v[72:87], v[156:159], a[68:71], v[72:87]
s_waitcnt vmcnt(3)
v_mov_b32 v12, s39
v_mov_b32 v13, 0
v_cmp_eq_u32 vcc, 0, v1
s_and_saveexec_b64 s[0:1], vcc
buffer_store_dword v12, v13, s[20:23], s91 offen sc1
s_mov_b64 exec, s[0:1]
s_waitcnt lgkmcnt(0)
v_mfma_f32_32x32x16_bf16 v[24:39], v[160:163], v[216:219], v[24:39]
v_mfma_f32_32x32x16_bf16 v[40:55], v[160:163], v[220:223], v[40:55]
v_mfma_f32_32x32x16_bf16 v[56:71], v[164:167], v[216:219], v[56:71]
v_mfma_f32_32x32x16_bf16 v[72:87], v[164:167], v[220:223], v[72:87]
s_waitcnt vmcnt(3)
v_cmp_ne_u32 vcc, s39, v22
s_and_b32 vcc_lo, vcc_lo, s55
s_mov_b32 vcc_hi, 0
s_cbranch_vccnz L_ce0_slow
L_ce0_ret:
buffer_load_dwordx4 v[88:91], v17, s[20:23], s40 offen offset:0 sc1
buffer_load_dwordx4 v[92:95], v17, s[20:23], s40 offen offset:1024 sc1
buffer_load_dwordx4 v[96:99], v17, s[20:23], s41 offen offset:0 sc1
buffer_load_dwordx4 v[100:103], v17, s[20:23], s41 offen offset:1024 sc1
buffer_load_dwordx4 v[104:107], v17, s[20:23], s42 offen offset:0 sc1
buffer_load_dwordx4 v[108:111], v17, s[20:23], s42 offen offset:1024 sc1
buffer_load_dword v22, v11, s[20:23], s96 offen sc1
v_add_u32 v21, s38, v17
ds_write_b128 v21, v[40:43] offset:0
ds_write_b128 v21, v[44:47] offset:1024
ds_write_b128 v21, v[48:51] offset:2048
ds_write_b128 v21, v[52:55] offset:3072
ds_write_b128 v21, v[56:59] offset:4096
ds_write_b128 v21, v[60:63] offset:5120
ds_write_b128 v21, v[64:67] offset:6144
ds_write_b128 v21, v[68:71] offset:7168
ds_write_b128 v21, v[72:75] offset:8192
ds_write_b128 v21, v[76:79] offset:9216
ds_write_b128 v21, v[80:83] offset:10240
ds_write_b128 v21, v[84:87] offset:11264
s_waitcnt lgkmcnt(0)
s_barrier
v_add_u32 v21, 0, v17
ds_read_b128 v[184:187], v21 offset:12288
ds_read_b128 v[188:191], v21 offset:13312
ds_read_b128 v[192:195], v21 offset:14336
ds_read_b128 v[196:199], v21 offset:15360
ds_read_b128 v[200:203], v21 offset:24576
ds_read_b128 v[204:207], v21 offset:25600
ds_read_b128 v[208:211], v21 offset:26624
ds_read_b128 v[212:215], v21 offset:27648
ds_read_b128 v[216:219], v21 offset:36864
ds_read_b128 v[220:223], v21 offset:37888
ds_read_b128 v[224:227], v21 offset:38912
ds_read_b128 v[228:231], v21 offset:39936
s_waitcnt lgkmcnt(8)
v_add_f32 v24, v24, v184
v_add_f32 v25, v25, v185
v_add_f32 v26, v26, v186
v_add_f32 v27, v27, v187
v_add_f32 v28, v28, v188
v_add_f32 v29, v29, v189
v_add_f32 v30, v30, v190
v_add_f32 v31, v31, v191
v_add_f32 v32, v32, v192
v_add_f32 v33, v33, v193
v_add_f32 v34, v34, v194
v_add_f32 v35, v35, v195
v_add_f32 v36, v36, v196
v_add_f32 v37, v37, v197
v_add_f32 v38, v38, v198
v_add_f32 v39, v39, v199
s_waitcnt lgkmcnt(4)
v_add_f32 v24, v24, v200
v_add_f32 v25, v25, v201
v_add_f32 v26, v26, v202
v_add_f32 v27, v27, v203
v_add_f32 v28, v28, v204
v_add_f32 v29, v29, v205
v_add_f32 v30, v30, v206
v_add_f32 v31, v31, v207
v_add_f32 v32, v32, v208
v_add_f32 v33, v33, v209
v_add_f32 v34, v34, v210
v_add_f32 v35, v35, v211
v_add_f32 v36, v36, v212
v_add_f32 v37, v37, v213
v_add_f32 v38, v38, v214
v_add_f32 v39, v39, v215
s_waitcnt lgkmcnt(0)
v_add_f32 v24, v24, v216
v_add_f32 v25, v25, v217
v_add_f32 v26, v26, v218
v_add_f32 v27, v27, v219
v_add_f32 v28, v28, v220
v_add_f32 v29, v29, v221
v_add_f32 v30, v30, v222
v_add_f32 v31, v31, v223
v_add_f32 v32, v32, v224
v_add_f32 v33, v33, v225
v_add_f32 v34, v34, v226
v_add_f32 v35, v35, v227
v_add_f32 v36, v36, v228
v_add_f32 v37, v37, v229
v_add_f32 v38, v38, v230
v_add_f32 v39, v39, v231
s_waitcnt vmcnt(1)
v_dot2_f32_bf16 v24, v88, s57, v24
v_dot2_f32_bf16 v25, v88, s58, v25
v_dot2_f32_bf16 v26, v89, s57, v26
v_dot2_f32_bf16 v27, v89, s58, v27
v_dot2_f32_bf16 v28, v90, s57, v28
v_dot2_f32_bf16 v29, v90, s58, v29
v_dot2_f32_bf16 v30, v91, s57, v30
v_dot2_f32_bf16 v31, v91, s58, v31
v_dot2_f32_bf16 v32, v92, s57, v32
v_dot2_f32_bf16 v33, v92, s58, v33
v_dot2_f32_bf16 v34, v93, s57, v34
v_dot2_f32_bf16 v35, v93, s58, v35
v_dot2_f32_bf16 v36, v94, s57, v36
v_dot2_f32_bf16 v37, v94, s58, v37
v_dot2_f32_bf16 v38, v95, s57, v38
v_dot2_f32_bf16 v39, v95, s58, v39
v_dot2_f32_bf16 v24, v96, s57, v24
v_dot2_f32_bf16 v25, v96, s58, v25
v_dot2_f32_bf16 v26, v97, s57, v26
v_dot2_f32_bf16 v27, v97, s58, v27
v_dot2_f32_bf16 v28, v98, s57, v28
v_dot2_f32_bf16 v29, v98, s58, v29
v_dot2_f32_bf16 v30, v99, s57, v30
v_dot2_f32_bf16 v31, v99, s58, v31
v_dot2_f32_bf16 v32, v100, s57, v32
v_dot2_f32_bf16 v33, v100, s58, v33
v_dot2_f32_bf16 v34, v101, s57, v34
v_dot2_f32_bf16 v35, v101, s58, v35
v_dot2_f32_bf16 v36, v102, s57, v36
v_dot2_f32_bf16 v37, v102, s58, v37
v_dot2_f32_bf16 v38, v103, s57, v38
v_dot2_f32_bf16 v39, v103, s58, v39
v_dot2_f32_bf16 v24, v104, s57, v24
v_dot2_f32_bf16 v25, v104, s58, v25
v_dot2_f32_bf16 v26, v105, s57, v26
v_dot2_f32_bf16 v27, v105, s58, v27
v_dot2_f32_bf16 v28, v106, s57, v28
v_dot2_f32_bf16 v29, v106, s58, v29
v_dot2_f32_bf16 v30, v107, s57, v30
v_dot2_f32_bf16 v31, v107, s58, v31
v_dot2_f32_bf16 v32, v108, s57, v32
v_dot2_f32_bf16 v33, v108, s58, v33
v_dot2_f32_bf16 v34, v109, s57, v34
v_dot2_f32_bf16 v35, v109, s58, v35
v_dot2_f32_bf16 v36, v110, s57, v36
v_dot2_f32_bf16 v37, v110, s58, v37
v_dot2_f32_bf16 v38, v111, s57, v38
v_dot2_f32_bf16 v39, v111, s58, v39
s_waitcnt vmcnt(0)
v_cmp_ne_u32 vcc, s39, v22
s_and_b32 vcc_lo, vcc_lo, s56
s_mov_b32 vcc_hi, 0
s_cbranch_vccnz L_cl0_slow
L_cl0_ret:
buffer_load_dwordx4 v[184:187], v17, s[20:23], s43 offen offset:0 sc1
buffer_load_dwordx4 v[188:191], v17, s[20:23], s43 offen offset:1024 sc1
buffer_load_dwordx4 v[192:195], v17, s[20:23], s44 offen offset:0 sc1
buffer_load_dwordx4 v[196:199], v17, s[20:23], s44 offen offset:1024 sc1
buffer_load_dwordx4 v[200:203], v17, s[20:23], s45 offen offset:0 sc1
buffer_load_dwordx4 v[204:207], v17, s[20:23], s45 offen offset:1024 sc1
buffer_load_dwordx4 v[208:211], v17, s[20:23], s46 offen offset:0 sc1
buffer_load_dwordx4 v[212:215], v17, s[20:23], s46 offen offset:1024 sc1
s_waitcnt vmcnt(6)
v_dot2_f32_bf16 v24, v184, s57, v24
v_dot2_f32_bf16 v25, v184, s58, v25
v_dot2_f32_bf16 v26, v185, s57, v26
v_dot2_f32_bf16 v27, v185, s58, v27
v_dot2_f32_bf16 v28, v186, s57, v28
v_dot2_f32_bf16 v29, v186, s58, v29
v_dot2_f32_bf16 v30, v187, s57, v30
v_dot2_f32_bf16 v31, v187, s58, v31
v_dot2_f32_bf16 v32, v188, s57, v32
v_dot2_f32_bf16 v33, v188, s58, v33
v_dot2_f32_bf16 v34, v189, s57, v34
v_dot2_f32_bf16 v35, v189, s58, v35
v_dot2_f32_bf16 v36, v190, s57, v36
v_dot2_f32_bf16 v37, v190, s58, v37
v_dot2_f32_bf16 v38, v191, s57, v38
v_dot2_f32_bf16 v39, v191, s58, v39
s_waitcnt vmcnt(4)
v_dot2_f32_bf16 v24, v192, s57, v24
v_dot2_f32_bf16 v25, v192, s58, v25
v_dot2_f32_bf16 v26, v193, s57, v26
v_dot2_f32_bf16 v27, v193, s58, v27
v_dot2_f32_bf16 v28, v194, s57, v28
v_dot2_f32_bf16 v29, v194, s58, v29
v_dot2_f32_bf16 v30, v195, s57, v30
v_dot2_f32_bf16 v31, v195, s58, v31
v_dot2_f32_bf16 v32, v196, s57, v32
v_dot2_f32_bf16 v33, v196, s58, v33
v_dot2_f32_bf16 v34, v197, s57, v34
v_dot2_f32_bf16 v35, v197, s58, v35
v_dot2_f32_bf16 v36, v198, s57, v36
v_dot2_f32_bf16 v37, v198, s58, v37
v_dot2_f32_bf16 v38, v199, s57, v38
v_dot2_f32_bf16 v39, v199, s58, v39
s_waitcnt vmcnt(2)
v_dot2_f32_bf16 v24, v200, s57, v24
v_dot2_f32_bf16 v25, v200, s58, v25
v_dot2_f32_bf16 v26, v201, s57, v26
v_dot2_f32_bf16 v27, v201, s58, v27
v_dot2_f32_bf16 v28, v202, s57, v28
v_dot2_f32_bf16 v29, v202, s58, v29
v_dot2_f32_bf16 v30, v203, s57, v30
v_dot2_f32_bf16 v31, v203, s58, v31
v_dot2_f32_bf16 v32, v204, s57, v32
v_dot2_f32_bf16 v33, v204, s58, v33
v_dot2_f32_bf16 v34, v205, s57, v34
v_dot2_f32_bf16 v35, v205, s58, v35
v_dot2_f32_bf16 v36, v206, s57, v36
v_dot2_f32_bf16 v37, v206, s58, v37
v_dot2_f32_bf16 v38, v207, s57, v38
v_dot2_f32_bf16 v39, v207, s58, v39
s_waitcnt vmcnt(0)
v_dot2_f32_bf16 v24, v208, s57, v24
v_dot2_f32_bf16 v25, v208, s58, v25
v_dot2_f32_bf16 v26, v209, s57, v26
v_dot2_f32_bf16 v27, v209, s58, v27
v_dot2_f32_bf16 v28, v210, s57, v28
v_dot2_f32_bf16 v29, v210, s58, v29
v_dot2_f32_bf16 v30, v211, s57, v30
v_dot2_f32_bf16 v31, v211, s58, v31
v_dot2_f32_bf16 v32, v212, s57, v32
v_dot2_f32_bf16 v33, v212, s58, v33
v_dot2_f32_bf16 v34, v213, s57, v34
v_dot2_f32_bf16 v35, v213, s58, v35
v_dot2_f32_bf16 v36, v214, s57, v36
v_dot2_f32_bf16 v37, v214, s58, v37
v_dot2_f32_bf16 v38, v215, s57, v38
v_dot2_f32_bf16 v39, v215, s58, v39
s_nop 3
v_permlane32_swap_b32 v24, v28
v_permlane32_swap_b32 v25, v29
v_permlane32_swap_b32 v26, v30
v_permlane32_swap_b32 v27, v31
v_permlane32_swap_b32 v32, v36
v_permlane32_swap_b32 v33, v37
v_permlane32_swap_b32 v34, v38
v_permlane32_swap_b32 v35, v39
s_nop 1
v_dot2_f32_bf16 v24, v176, s57, v24
v_dot2_f32_bf16 v25, v176, s58, v25
v_dot2_f32_bf16 v26, v177, s57, v26
v_dot2_f32_bf16 v27, v177, s58, v27
v_dot2_f32_bf16 v28, v178, s57, v28
v_dot2_f32_bf16 v29, v178, s58, v29
v_dot2_f32_bf16 v30, v179, s57, v30
v_dot2_f32_bf16 v31, v179, s58, v31
v_dot2_f32_bf16 v32, v180, s57, v32
v_dot2_f32_bf16 v33, v180, s58, v33
v_dot2_f32_bf16 v34, v181, s57, v34
v_dot2_f32_bf16 v35, v181, s58, v35
v_dot2_f32_bf16 v36, v182, s57, v36
v_dot2_f32_bf16 v37, v182, s58, v37
v_dot2_f32_bf16 v38, v183, s57, v38
v_dot2_f32_bf16 v39, v183, s58, v39
s_nop 3
v_cvt_pk_bf16_f32 v176, v24, v25
v_cvt_pk_bf16_f32 v177, v26, v27
v_cvt_pk_bf16_f32 v178, v28, v29
v_cvt_pk_bf16_f32 v179, v30, v31
buffer_store_dwordx4 v[176:179], v10, s[24:27], s59 offen offset:0
v_cvt_pk_bf16_f32 v180, v32, v33
v_cvt_pk_bf16_f32 v181, v34, v35
v_cvt_pk_bf16_f32 v182, v36, v37
v_cvt_pk_bf16_f32 v183, v38, v39
buffer_store_dwordx4 v[180:183], v10, s[24:27], s59 offen offset:32
s_branch L_fin
L_sp1:
s_lshl_b32 s59, s3, 6
s_add_u32 s59, s59, 32
s_mul_i32 s59, s59, 1152
s_lshl_b32 s93, s4, 7
s_add_u32 s59, s59, s93
s_add_u32 s59, s59, 0
s_waitcnt vmcnt(19) lgkmcnt(0)
ds_read_b64_tr_b16 v[160:161], v14 offset:6144
ds_read_b64_tr_b16 v[162:163], v14 offset:7168
v_mfma_f32_32x32x16_bf16 v[24:39], v[152:155], a[72:75], 0
ds_read_b64_tr_b16 v[164:165], v15 offset:6144
v_cvt_pk_bf16_f32 v88, v88, v89
v_cvt_pk_bf16_f32 v89, v90, v91
v_cvt_pk_bf16_f32 v90, v92, v93
v_cvt_pk_bf16_f32 v91, v94, v95
v_cvt_pk_bf16_f32 v96, v96, v97
v_mfma_f32_32x32x16_bf16 v[40:55], v[152:155], a[76:79], 0
ds_read_b64_tr_b16 v[166:167], v15 offset:7168
v_cvt_pk_bf16_f32 v97, v98, v99
v_cvt_pk_bf16_f32 v98, v100, v101
v_cvt_pk_bf16_f32 v99, v102, v103
v_cvt_pk_bf16_f32 v104, v104, v105
v_cvt_pk_bf16_f32 v105, v106, v107
v_cvt_pk_bf16_f32 v106, v108, v109
v_mfma_f32_32x32x16_bf16 v[56:71], v[156:159], a[72:75], 0
v_cvt_pk_bf16_f32 v107, v110, v111
v_cvt_pk_bf16_f32 v112, v112, v113
v_cvt_pk_bf16_f32 v113, v114, v115
v_cvt_pk_bf16_f32 v114, v116, v117
v_cvt_pk_bf16_f32 v115, v118, v119
v_cvt_pk_bf16_f32 v120, v120, v121
v_cvt_pk_bf16_f32 v121, v122, v123
v_cvt_pk_bf16_f32 v122, v124, v125
v_cvt_pk_bf16_f32 v123, v126, v127
v_cvt_pk_bf16_f32 v128, v128, v129
v_cvt_pk_bf16_f32 v129, v130, v131
v_cvt_pk_bf16_f32 v130, v132, v133
v_cvt_pk_bf16_f32 v131, v134, v135
v_cvt_pk_bf16_f32 v136, v136, v137
v_mfma_f32_32x32x16_bf16 v[72:87], v[156:159], a[76:79], 0
v_cvt_pk_bf16_f32 v137, v138, v139
v_cvt_pk_bf16_f32 v138, v140, v141
v_cvt_pk_bf16_f32 v139, v142, v143
v_cvt_pk_bf16_f32 v144, v144, v145
v_cvt_pk_bf16_f32 v145, v146, v147
v_cvt_pk_bf16_f32 v146, v148, v149
v_cvt_pk_bf16_f32 v147, v150, v151
s_waitcnt vmcnt(17) lgkmcnt(0)
ds_read_b64_tr_b16 v[152:153], v8 offset:0
ds_read_b64_tr_b16 v[154:155], v8 offset:1024
v_mfma_f32_32x32x16_bf16 v[24:39], v[160:163], a[80:83], v[24:39]
ds_read_b64_tr_b16 v[156:157], v9 offset:0
buffer_store_dwordx4 v[88:91], v17, s[20:23], s101 offen offset:0 sc1
v_mfma_f32_32x32x16_bf16 v[40:55], v[160:163], a[84:87], v[40:55]
ds_read_b64_tr_b16 v[158:159], v9 offset:1024
buffer_store_dwordx4 v[96:99], v17, s[20:23], s101 offen offset:1024 sc1
v_mfma_f32_32x32x16_bf16 v[56:71], v[164:167], a[80:83], v[56:71]
buffer_store_dwordx4 v[104:107], v17, s[20:23], s101 offen offset:2048 sc1
v_mfma_f32_32x32x16_bf16 v[72:87], v[164:167], a[84:87], v[72:87]
buffer_store_dwordx4 v[112:115], v17, s[20:23], s101 offen offset:3072 sc1
s_waitcnt vmcnt(19) lgkmcnt(0)
ds_read_b64_tr_b16 v[160:161], v14 offset:32768
ds_read_b64_tr_b16 v[162:163], v14 offset:33792
v_mfma_f32_32x32x16_bf16 v[24:39], v[152:155], a[88:91], v[24:39]
ds_read_b64_tr_b16 v[164:165], v15 offset:32768
s_add_u32 s101, s101, 4096
v_mfma_f32_32x32x16_bf16 v[40:55], v[152:155], a[92:95], v[40:55]
ds_read_b64_tr_b16 v[166:167], v15 offset:33792
buffer_store_dwordx4 v[120:123], v17, s[20:23], s101 offen offset:0 sc1
v_mfma_f32_32x32x16_bf16 v[56:71], v[156:159], a[88:91], v[56:71]
buffer_store_dwordx4 v[128:131], v17, s[20:23], s101 offen offset:1024 sc1
buffer_store_dwordx4 v[136:139], v17, s[20:23], s101 offen offset:2048 sc1
v_mfma_f32_32x32x16_bf16 v[72:87], v[156:159], a[92:95], v[72:87]
buffer_store_dwordx4 v[144:147], v17, s[20:23], s101 offen offset:3072 sc1
s_waitcnt vmcnt(21) lgkmcnt(0)
ds_read_b64_tr_b16 v[152:153], v8 offset:2048
ds_read_b64_tr_b16 v[154:155], v8 offset:3072
v_mfma_f32_32x32x16_bf16 v[24:39], v[160:163], a[96:99], v[24:39]
ds_read_b64_tr_b16 v[156:157], v9 offset:2048
v_mfma_f32_32x32x16_bf16 v[40:55], v[160:163], a[100:103], v[40:55]
ds_read_b64_tr_b16 v[158:159], v9 offset:3072
v_mfma_f32_32x32x16_bf16 v[56:71], v[164:167], a[96:99], v[56:71]
buffer_load_dword v22, v11, s[20:23], s96 offen sc1
v_mfma_f32_32x32x16_bf16 v[72:87], v[164:167], a[100:103], v[72:87]
s_waitcnt vmcnt(20) lgkmcnt(0)
ds_read_b64_tr_b16 v[160:161], v8 offset:4096
ds_read_b64_tr_b16 v[162:163], v8 offset:5120
v_mfma_f32_32x32x16_bf16 v[24:39], v[152:155], a[104:107], v[24:39]
ds_read_b64_tr_b16 v[164:165], v9 offset:4096
v_mfma_f32_32x32x16_bf16 v[40:55], v[152:155], a[108:111], v[40:55]
ds_read_b64_tr_b16 v[166:167], v9 offset:5120
v_mfma_f32_32x32x16_bf16 v[56:71], v[156:159], a[104:107], v[56:71]
buffer_load_dwordx4 v[176:179], v10, s[8:11], s59 offen offset:0
buffer_load_dwordx4 v[180:183], v10, s[8:11], s59 offen offset:32
v_mfma_f32_32x32x16_bf16 v[72:87], v[156:159], a[108:111], v[72:87]
s_waitcnt vmcnt(20) lgkmcnt(0)
ds_read_b64_tr_b16 v[152:153], v8 offset:6144
ds_read_b64_tr_b16 v[154:155], v8 offset:7168
v_mfma_f32_32x32x16_bf16 v[24:39], v[160:163], a[112:115], v[24:39]
ds_read_b64_tr_b16 v[156:157], v9 offset:6144
v_mfma_f32_32x32x16_bf16 v[40:55], v[160:163], a[116:119], v[40:55]
ds_read_b64_tr_b16 v[158:159], v9 offset:7168
v_mfma_f32_32x32x16_bf16 v[56:71], v[164:167], a[112:115], v[56:71]
v_mfma_f32_32x32x16_bf16 v[72:87], v[164:167], a[116:119], v[72:87]
s_waitcnt vmcnt(18) lgkmcnt(0)
ds_read_b64_tr_b16 v[160:161], v8 offset:8192
ds_read_b64_tr_b16 v[162:163], v8 offset:9216
v_mfma_f32_32x32x16_bf16 v[24:39], v[152:155], a[120:123], v[24:39]
ds_read_b64_tr_b16 v[164:165], v9 offset:8192
v_mfma_f32_32x32x16_bf16 v[40:55], v[152:155], a[124:127], v[40:55]
ds_read_b64_tr_b16 v[166:167], v9 offset:9216
v_mfma_f32_32x32x16_bf16 v[56:71], v[156:159], a[120:123], v[56:71]
v_mfma_f32_32x32x16_bf16 v[72:87], v[156:159], a[124:127], v[72:87]
s_waitcnt vmcnt(16) lgkmcnt(0)
ds_read_b64_tr_b16 v[152:153], v14 offset:2048
ds_read_b64_tr_b16 v[154:155], v14 offset:3072
v_mfma_f32_32x32x16_bf16 v[24:39], v[160:163], a[160:163], v[24:39]
ds_read_b64_tr_b16 v[156:157], v15 offset:2048
ds_read_b128 v[216:219], v16 offset:32
ds_read_b128 v[220:223], v16 offset:5664
v_mfma_f32_32x32x16_bf16 v[40:55], v[160:163], a[164:167], v[40:55]
ds_read_b64_tr_b16 v[158:159], v15 offset:3072
v_mfma_f32_32x32x16_bf16 v[56:71], v[164:167], a[160:163], v[56:71]
v_mfma_f32_32x32x16_bf16 v[72:87], v[164:167], a[164:167], v[72:87]
s_waitcnt vmcnt(14) lgkmcnt(0)
ds_read_b64_tr_b16 v[160:161], v6 offset:10240
ds_read_b64_tr_b16 v[162:163], v6 offset:10752
v_mfma_f32_32x32x16_bf16 v[24:39], v[152:155], a[168:171], v[24:39]
ds_read_b64_tr_b16 v[164:165], v7 offset:10240
v_mfma_f32_32x32x16_bf16 v[40:55], v[152:155], a[172:175], v[40:55]
ds_read_b64_tr_b16 v[166:167], v7 offset:10752
v_mfma_f32_32x32x16_bf16 v[56:71], v[156:159], a[168:171], v[56:71]
v_mfma_f32_32x32x16_bf16 v[72:87], v[156:159], a[172:175], v[72:87]
s_waitcnt vmcnt(3)
v_mov_b32 v12, s39
v_mov_b32 v13, 0
v_cmp_eq_u32 vcc, 0, v1
s_and_saveexec_b64 s[0:1], vcc
buffer_store_dword v12, v13, s[20:23], s91 offen sc1
s_mov_b64 exec, s[0:1]
s_waitcnt lgkmcnt(0)
v_mfma_f32_32x32x16_bf16 v[24:39], v[160:163], v[216:219], v[24:39]
v_mfma_f32_32x32x16_bf16 v[40:55], v[160:163], v[220:223], v[40:55]
v_mfma_f32_32x32x16_bf16 v[56:71], v[164:167], v[216:219], v[56:71]
v_mfma_f32_32x32x16_bf16 v[72:87], v[164:167], v[220:223], v[72:87]
s_waitcnt vmcnt(3)
v_cmp_ne_u32 vcc, s39, v22
s_and_b32 vcc_lo, vcc_lo, s55
s_mov_b32 vcc_hi, 0
s_cbranch_vccnz L_ce1_slow
L_ce1_ret:
buffer_load_dwordx4 v[88:91], v17, s[20:23], s40 offen offset:0 sc1
buffer_load_dwordx4 v[92:95], v17, s[20:23], s40 offen offset:1024 sc1
buffer_load_dwordx4 v[96:99], v17, s[20:23], s41 offen offset:0 sc1
buffer_load_dwordx4 v[100:103], v17, s[20:23], s41 offen offset:1024 sc1
buffer_load_dwordx4 v[104:107], v17, s[20:23], s42 offen offset:0 sc1
buffer_load_dwordx4 v[108:111], v17, s[20:23], s42 offen offset:1024 sc1
buffer_load_dword v22, v11, s[20:23], s96 offen sc1
v_add_u32 v21, s38, v17
ds_write_b128 v21, v[24:27] offset:0
ds_write_b128 v21, v[28:31] offset:1024
ds_write_b128 v21, v[32:35] offset:2048
ds_write_b128 v21, v[36:39] offset:3072
ds_write_b128 v21, v[56:59] offset:4096
ds_write_b128 v21, v[60:63] offset:5120
ds_write_b128 v21, v[64:67] offset:6144
ds_write_b128 v21, v[68:71] offset:7168
ds_write_b128 v21, v[72:75] offset:8192
ds_write_b128 v21, v[76:79] offset:9216
ds_write_b128 v21, v[80:83] offset:10240
ds_write_b128 v21, v[84:87] offset:11264
s_waitcnt lgkmcnt(0)
s_barrier
v_add_u32 v21, 0, v17
ds_read_b128 v[184:187], v21 offset:0
ds_read_b128 v[188:191], v21 offset:1024
ds_read_b128 v[192:195], v21 offset:2048
ds_read_b128 v[196:199], v21 offset:3072
ds_read_b128 v[200:203], v21 offset:28672
ds_read_b128 v[204:207], v21 offset:29696
ds_read_b128 v[208:211], v21 offset:30720
ds_read_b128 v[212:215], v21 offset:31744
ds_read_b128 v[216:219], v21 offset:40960
ds_read_b128 v[220:223], v21 offset:41984
ds_read_b128 v[224:227], v21 offset:43008
ds_read_b128 v[228:231], v21 offset:44032
s_waitcnt lgkmcnt(8)
v_add_f32 v40, v40, v184
v_add_f32 v41, v41, v185
v_add_f32 v42, v42, v186
v_add_f32 v43, v43, v187
v_add_f32 v44, v44, v188
v_add_f32 v45, v45, v189
v_add_f32 v46, v46, v190
v_add_f32 v47, v47, v191
v_add_f32 v48, v48, v192
v_add_f32 v49, v49, v193
v_add_f32 v50, v50, v194
v_add_f32 v51, v51, v195
v_add_f32 v52, v52, v196
v_add_f32 v53, v53, v197
v_add_f32 v54, v54, v198
v_add_f32 v55, v55, v199
s_waitcnt lgkmcnt(4)
v_add_f32 v40, v40, v200
v_add_f32 v41, v41, v201
v_add_f32 v42, v42, v202
v_add_f32 v43, v43, v203
v_add_f32 v44, v44, v204
v_add_f32 v45, v45, v205
v_add_f32 v46, v46, v206
v_add_f32 v47, v47, v207
v_add_f32 v48, v48, v208
v_add_f32 v49, v49, v209
v_add_f32 v50, v50, v210
v_add_f32 v51, v51, v211
v_add_f32 v52, v52, v212
v_add_f32 v53, v53, v213
v_add_f32 v54, v54, v214
v_add_f32 v55, v55, v215
s_waitcnt lgkmcnt(0)
v_add_f32 v40, v40, v216
v_add_f32 v41, v41, v217
v_add_f32 v42, v42, v218
v_add_f32 v43, v43, v219
v_add_f32 v44, v44, v220
v_add_f32 v45, v45, v221
v_add_f32 v46, v46, v222
v_add_f32 v47, v47, v223
v_add_f32 v48, v48, v224
v_add_f32 v49, v49, v225
v_add_f32 v50, v50, v226
v_add_f32 v51, v51, v227
v_add_f32 v52, v52, v228
v_add_f32 v53, v53, v229
v_add_f32 v54, v54, v230
v_add_f32 v55, v55, v231
s_waitcnt vmcnt(1)
v_dot2_f32_bf16 v40, v88, s57, v40
v_dot2_f32_bf16 v41, v88, s58, v41
v_dot2_f32_bf16 v42, v89, s57, v42
v_dot2_f32_bf16 v43, v89, s58, v43
v_dot2_f32_bf16 v44, v90, s57, v44
v_dot2_f32_bf16 v45, v90, s58, v45
v_dot2_f32_bf16 v46, v91, s57, v46
v_dot2_f32_bf16 v47, v91, s58, v47
v_dot2_f32_bf16 v48, v92, s57, v48
v_dot2_f32_bf16 v49, v92, s58, v49
v_dot2_f32_bf16 v50, v93, s57, v50
v_dot2_f32_bf16 v51, v93, s58, v51
v_dot2_f32_bf16 v52, v94, s57, v52
v_dot2_f32_bf16 v53, v94, s58, v53
v_dot2_f32_bf16 v54, v95, s57, v54
v_dot2_f32_bf16 v55, v95, s58, v55
v_dot2_f32_bf16 v40, v96, s57, v40
v_dot2_f32_bf16 v41, v96, s58, v41
v_dot2_f32_bf16 v42, v97, s57, v42
v_dot2_f32_bf16 v43, v97, s58, v43
v_dot2_f32_bf16 v44, v98, s57, v44
v_dot2_f32_bf16 v45, v98, s58, v45
v_dot2_f32_bf16 v46, v99, s57, v46
v_dot2_f32_bf16 v47, v99, s58, v47
v_dot2_f32_bf16 v48, v100, s57, v48
v_dot2_f32_bf16 v49, v100, s58, v49
v_dot2_f32_bf16 v50, v101, s57, v50
v_dot2_f32_bf16 v51, v101, s58, v51
v_dot2_f32_bf16 v52, v102, s57, v52
v_dot2_f32_bf16 v53, v102, s58, v53
v_dot2_f32_bf16 v54, v103, s57, v54
v_dot2_f32_bf16 v55, v103, s58, v55
v_dot2_f32_bf16 v40, v104, s57, v40
v_dot2_f32_bf16 v41, v104, s58, v41
v_dot2_f32_bf16 v42, v105, s57, v42
v_dot2_f32_bf16 v43, v105, s58, v43
v_dot2_f32_bf16 v44, v106, s57, v44
v_dot2_f32_bf16 v45, v106, s58, v45
v_dot2_f32_bf16 v46, v107, s57, v46
v_dot2_f32_bf16 v47, v107, s58, v47
v_dot2_f32_bf16 v48, v108, s57, v48
v_dot2_f32_bf16 v49, v108, s58, v49
v_dot2_f32_bf16 v50, v109, s57, v50
v_dot2_f32_bf16 v51, v109, s58, v51
v_dot2_f32_bf16 v52, v110, s57, v52
v_dot2_f32_bf16 v53, v110, s58, v53
v_dot2_f32_bf16 v54, v111, s57, v54
v_dot2_f32_bf16 v55, v111, s58, v55
s_waitcnt vmcnt(0)
v_cmp_ne_u32 vcc, s39, v22
s_and_b32 vcc_lo, vcc_lo, s56
s_mov_b32 vcc_hi, 0
s_cbranch_vccnz L_cl1_slow
L_cl1_ret:
buffer_load_dwordx4 v[184:187], v17, s[20:23], s43 offen offset:0 sc1
buffer_load_dwordx4 v[188:191], v17, s[20:23], s43 offen offset:1024 sc1
buffer_load_dwordx4 v[192:195], v17, s[20:23], s44 offen offset:0 sc1
buffer_load_dwordx4 v[196:199], v17, s[20:23], s44 offen offset:1024 sc1
buffer_load_dwordx4 v[200:203], v17, s[20:23], s45 offen offset:0 sc1
buffer_load_dwordx4 v[204:207], v17, s[20:23], s45 offen offset:1024 sc1
buffer_load_dwordx4 v[208:211], v17, s[20:23], s46 offen offset:0 sc1
buffer_load_dwordx4 v[212:215], v17, s[20:23], s46 offen offset:1024 sc1
s_waitcnt vmcnt(6)
v_dot2_f32_bf16 v40, v184, s57, v40
v_dot2_f32_bf16 v41, v184, s58, v41
v_dot2_f32_bf16 v42, v185, s57, v42
v_dot2_f32_bf16 v43, v185, s58, v43
v_dot2_f32_bf16 v44, v186, s57, v44
v_dot2_f32_bf16 v45, v186, s58, v45
v_dot2_f32_bf16 v46, v187, s57, v46
v_dot2_f32_bf16 v47, v187, s58, v47
v_dot2_f32_bf16 v48, v188, s57, v48
v_dot2_f32_bf16 v49, v188, s58, v49
v_dot2_f32_bf16 v50, v189, s57, v50
v_dot2_f32_bf16 v51, v189, s58, v51
v_dot2_f32_bf16 v52, v190, s57, v52
v_dot2_f32_bf16 v53, v190, s58, v53
v_dot2_f32_bf16 v54, v191, s57, v54
v_dot2_f32_bf16 v55, v191, s58, v55
s_waitcnt vmcnt(4)
v_dot2_f32_bf16 v40, v192, s57, v40
v_dot2_f32_bf16 v41, v192, s58, v41
v_dot2_f32_bf16 v42, v193, s57, v42
v_dot2_f32_bf16 v43, v193, s58, v43
v_dot2_f32_bf16 v44, v194, s57, v44
v_dot2_f32_bf16 v45, v194, s58, v45
v_dot2_f32_bf16 v46, v195, s57, v46
v_dot2_f32_bf16 v47, v195, s58, v47
v_dot2_f32_bf16 v48, v196, s57, v48
v_dot2_f32_bf16 v49, v196, s58, v49
v_dot2_f32_bf16 v50, v197, s57, v50
v_dot2_f32_bf16 v51, v197, s58, v51
v_dot2_f32_bf16 v52, v198, s57, v52
v_dot2_f32_bf16 v53, v198, s58, v53
v_dot2_f32_bf16 v54, v199, s57, v54
v_dot2_f32_bf16 v55, v199, s58, v55
s_waitcnt vmcnt(2)
v_dot2_f32_bf16 v40, v200, s57, v40
v_dot2_f32_bf16 v41, v200, s58, v41
v_dot2_f32_bf16 v42, v201, s57, v42
v_dot2_f32_bf16 v43, v201, s58, v43
v_dot2_f32_bf16 v44, v202, s57, v44
v_dot2_f32_bf16 v45, v202, s58, v45
v_dot2_f32_bf16 v46, v203, s57, v46
v_dot2_f32_bf16 v47, v203, s58, v47
v_dot2_f32_bf16 v48, v204, s57, v48
v_dot2_f32_bf16 v49, v204, s58, v49
v_dot2_f32_bf16 v50, v205, s57, v50
v_dot2_f32_bf16 v51, v205, s58, v51
v_dot2_f32_bf16 v52, v206, s57, v52
v_dot2_f32_bf16 v53, v206, s58, v53
v_dot2_f32_bf16 v54, v207, s57, v54
v_dot2_f32_bf16 v55, v207, s58, v55
s_waitcnt vmcnt(0)
v_dot2_f32_bf16 v40, v208, s57, v40
v_dot2_f32_bf16 v41, v208, s58, v41
v_dot2_f32_bf16 v42, v209, s57, v42
v_dot2_f32_bf16 v43, v209, s58, v43
v_dot2_f32_bf16 v44, v210, s57, v44
v_dot2_f32_bf16 v45, v210, s58, v45
v_dot2_f32_bf16 v46, v211, s57, v46
v_dot2_f32_bf16 v47, v211, s58, v47
v_dot2_f32_bf16 v48, v212, s57, v48
v_dot2_f32_bf16 v49, v212, s58, v49
v_dot2_f32_bf16 v50, v213, s57, v50
v_dot2_f32_bf16 v51, v213, s58, v51
v_dot2_f32_bf16 v52, v214, s57, v52
v_dot2_f32_bf16 v53, v214, s58, v53
v_dot2_f32_bf16 v54, v215, s57, v54
v_dot2_f32_bf16 v55, v215, s58, v55
s_nop 3
v_permlane32_swap_b32 v40, v44
v_permlane32_swap_b32 v41, v45
v_permlane32_swap_b32 v42, v46
v_permlane32_swap_b32 v43, v47
v_permlane32_swap_b32 v48, v52
v_permlane32_swap_b32 v49, v53
v_permlane32_swap_b32 v50, v54
v_permlane32_swap_b32 v51, v55
s_nop 1
v_dot2_f32_bf16 v40, v176, s57, v40
v_dot2_f32_bf16 v41, v176, s58, v41
v_dot2_f32_bf16 v42, v177, s57, v42
v_dot2_f32_bf16 v43, v177, s58, v43
v_dot2_f32_bf16 v44, v178, s57, v44
v_dot2_f32_bf16 v45, v178, s58, v45
v_dot2_f32_bf16 v46, v179, s57, v46
v_dot2_f32_bf16 v47, v179, s58, v47
v_dot2_f32_bf16 v48, v180, s57, v48
v_dot2_f32_bf16 v49, v180, s58, v49
v_dot2_f32_bf16 v50, v181, s57, v50
v_dot2_f32_bf16 v51, v181, s58, v51
v_dot2_f32_bf16 v52, v182, s57, v52
v_dot2_f32_bf16 v53, v182, s58, v53
v_dot2_f32_bf16 v54, v183, s57, v54
v_dot2_f32_bf16 v55, v183, s58, v55
s_nop 3
v_cvt_pk_bf16_f32 v176, v40, v41
v_cvt_pk_bf16_f32 v177, v42, v43
v_cvt_pk_bf16_f32 v178, v44, v45
v_cvt_pk_bf16_f32 v179, v46, v47
buffer_store_dwordx4 v[176:179], v10, s[24:27], s59 offen offset:0
v_cvt_pk_bf16_f32 v180, v48, v49
v_cvt_pk_bf16_f32 v181, v50, v51
v_cvt_pk_bf16_f32 v182, v52, v53
v_cvt_pk_bf16_f32 v183, v54, v55
buffer_store_dwordx4 v[180:183], v10, s[24:27], s59 offen offset:32
s_branch L_fin
L_sp2:
s_lshl_b32 s59, s3, 6
s_add_u32 s59, s59, 0
s_mul_i32 s59, s59, 1152
s_lshl_b32 s93, s4, 7
s_add_u32 s59, s59, s93
s_add_u32 s59, s59, 64
s_waitcnt vmcnt(19) lgkmcnt(0)
ds_read_b64_tr_b16 v[160:161], v14 offset:6144
ds_read_b64_tr_b16 v[162:163], v14 offset:7168
v_mfma_f32_32x32x16_bf16 v[24:39], v[152:155], a[176:179], 0
ds_read_b64_tr_b16 v[164:165], v15 offset:6144
v_cvt_pk_bf16_f32 v88, v88, v89
v_cvt_pk_bf16_f32 v89, v90, v91
v_cvt_pk_bf16_f32 v90, v92, v93
v_cvt_pk_bf16_f32 v91, v94, v95
v_cvt_pk_bf16_f32 v96, v96, v97
v_mfma_f32_32x32x16_bf16 v[40:55], v[152:155], a[180:183], 0
ds_read_b64_tr_b16 v[166:167], v15 offset:7168
v_cvt_pk_bf16_f32 v97, v98, v99
v_cvt_pk_bf16_f32 v98, v100, v101
v_cvt_pk_bf16_f32 v99, v102, v103
v_cvt_pk_bf16_f32 v104, v104, v105
v_cvt_pk_bf16_f32 v105, v106, v107
v_cvt_pk_bf16_f32 v106, v108, v109
v_mfma_f32_32x32x16_bf16 v[56:71], v[156:159], a[176:179], 0
v_cvt_pk_bf16_f32 v107, v110, v111
v_cvt_pk_bf16_f32 v112, v112, v113
v_cvt_pk_bf16_f32 v113, v114, v115
v_cvt_pk_bf16_f32 v114, v116, v117
v_cvt_pk_bf16_f32 v115, v118, v119
v_cvt_pk_bf16_f32 v120, v120, v121
v_cvt_pk_bf16_f32 v121, v122, v123
v_cvt_pk_bf16_f32 v122, v124, v125
v_cvt_pk_bf16_f32 v123, v126, v127
v_cvt_pk_bf16_f32 v128, v128, v129
v_cvt_pk_bf16_f32 v129, v130, v131
v_cvt_pk_bf16_f32 v130, v132, v133
v_cvt_pk_bf16_f32 v131, v134, v135
v_cvt_pk_bf16_f32 v136, v136, v137
v_mfma_f32_32x32x16_bf16 v[72:87], v[156:159], a[180:183], 0
v_cvt_pk_bf16_f32 v137, v138, v139
v_cvt_pk_bf16_f32 v138, v140, v141
v_cvt_pk_bf16_f32 v139, v142, v143
v_cvt_pk_bf16_f32 v144, v144, v145
v_cvt_pk_bf16_f32 v145, v146, v147
v_cvt_pk_bf16_f32 v146, v148, v149
v_cvt_pk_bf16_f32 v147, v150, v151
s_waitcnt vmcnt(17) lgkmcnt(0)
ds_read_b64_tr_b16 v[152:153], v8 offset:0
ds_read_b64_tr_b16 v[154:155], v8 offset:1024
v_mfma_f32_32x32x16_bf16 v[24:39], v[160:163], a[184:187], v[24:39]
ds_read_b64_tr_b16 v[156:157], v9 offset:0
buffer_store_dwordx4 v[88:91], v17, s[20:23], s101 offen offset:0 sc1
v_mfma_f32_32x32x16_bf16 v[40:55], v[160:163], a[188:191], v[40:55]
ds_read_b64_tr_b16 v[158:159], v9 offset:1024
buffer_store_dwordx4 v[96:99], v17, s[20:23], s101 offen offset:1024 sc1
v_mfma_f32_32x32x16_bf16 v[56:71], v[164:167], a[184:187], v[56:71]
buffer_store_dwordx4 v[104:107], v17, s[20:23], s101 offen offset:2048 sc1
v_mfma_f32_32x32x16_bf16 v[72:87], v[164:167], a[188:191], v[72:87]
buffer_store_dwordx4 v[112:115], v17, s[20:23], s101 offen offset:3072 sc1
s_waitcnt vmcnt(19) lgkmcnt(0)
ds_read_b64_tr_b16 v[160:161], v14 offset:32768
ds_read_b64_tr_b16 v[162:163], v14 offset:33792
v_mfma_f32_32x32x16_bf16 v[24:39], v[152:155], a[192:195], v[24:39]
ds_read_b64_tr_b16 v[164:165], v15 offset:32768
s_add_u32 s101, s101, 4096
v_mfma_f32_32x32x16_bf16 v[40:55], v[152:155], a[196:199], v[40:55]
ds_read_b64_tr_b16 v[166:167], v15 offset:33792
buffer_store_dwordx4 v[120:123], v17, s[20:23], s101 offen offset:0 sc1
v_mfma_f32_32x32x16_bf16 v[56:71], v[156:159], a[192:195], v[56:71]
buffer_store_dwordx4 v[128:131], v17, s[20:23], s101 offen offset:1024 sc1
buffer_store_dwordx4 v[136:139], v17, s[20:23], s101 offen offset:2048 sc1
v_mfma_f32_32x32x16_bf16 v[72:87], v[156:159], a[196:199], v[72:87]
buffer_store_dwordx4 v[144:147], v17, s[20:23], s101 offen offset:3072 sc1
s_waitcnt vmcnt(21) lgkmcnt(0)
ds_read_b64_tr_b16 v[152:153], v8 offset:2048
ds_read_b64_tr_b16 v[154:155], v8 offset:3072
v_mfma_f32_32x32x16_bf16 v[24:39], v[160:163], a[200:203], v[24:39]
ds_read_b64_tr_b16 v[156:157], v9 offset:2048
v_mfma_f32_32x32x16_bf16 v[40:55], v[160:163], a[204:207], v[40:55]
ds_read_b64_tr_b16 v[158:159], v9 offset:3072
v_mfma_f32_32x32x16_bf16 v[56:71], v[164:167], a[200:203], v[56:71]
buffer_load_dword v22, v11, s[20:23], s96 offen sc1
v_mfma_f32_32x32x16_bf16 v[72:87], v[164:167], a[204:207], v[72:87]
s_waitcnt vmcnt(20) lgkmcnt(0)
ds_read_b64_tr_b16 v[160:161], v8 offset:4096
ds_read_b64_tr_b16 v[162:163], v8 offset:5120
v_mfma_f32_32x32x16_bf16 v[24:39], v[152:155], a[208:211], v[24:39]
ds_read_b64_tr_b16 v[164:165], v9 offset:4096
v_mfma_f32_32x32x16_bf16 v[40:55], v[152:155], a[212:215], v[40:55]
ds_read_b64_tr_b16 v[166:167], v9 offset:5120
v_mfma_f32_32x32x16_bf16 v[56:71], v[156:159], a[208:211], v[56:71]
buffer_load_dwordx4 v[176:179], v10, s[8:11], s59 offen offset:0
buffer_load_dwordx4 v[180:183], v10, s[8:11], s59 offen offset:32
v_mfma_f32_32x32x16_bf16 v[72:87], v[156:159], a[212:215], v[72:87]
s_waitcnt vmcnt(20) lgkmcnt(0)
ds_read_b64_tr_b16 v[152:153], v8 offset:6144
ds_read_b64_tr_b16 v[154:155], v8 offset:7168
v_mfma_f32_32x32x16_bf16 v[24:39], v[160:163], a[216:219], v[24:39]
ds_read_b64_tr_b16 v[156:157], v9 offset:6144
v_mfma_f32_32x32x16_bf16 v[40:55], v[160:163], a[220:223], v[40:55]
ds_read_b64_tr_b16 v[158:159], v9 offset:7168
v_mfma_f32_32x32x16_bf16 v[56:71], v[164:167], a[216:219], v[56:71]
v_mfma_f32_32x32x16_bf16 v[72:87], v[164:167], a[220:223], v[72:87]
s_waitcnt vmcnt(18) lgkmcnt(0)
ds_read_b64_tr_b16 v[160:161], v8 offset:8192
ds_read_b64_tr_b16 v[162:163], v8 offset:9216
v_mfma_f32_32x32x16_bf16 v[24:39], v[152:155], a[224:227], v[24:39]
ds_read_b64_tr_b16 v[164:165], v9 offset:8192
v_mfma_f32_32x32x16_bf16 v[40:55], v[152:155], a[228:231], v[40:55]
ds_read_b64_tr_b16 v[166:167], v9 offset:9216
v_mfma_f32_32x32x16_bf16 v[56:71], v[156:159], a[224:227], v[56:71]
v_mfma_f32_32x32x16_bf16 v[72:87], v[156:159], a[228:231], v[72:87]
s_waitcnt vmcnt(16) lgkmcnt(0)
ds_read_b64_tr_b16 v[152:153], v14 offset:2048
ds_read_b64_tr_b16 v[154:155], v14 offset:3072
v_mfma_f32_32x32x16_bf16 v[24:39], v[160:163], a[232:235], v[24:39]
ds_read_b64_tr_b16 v[156:157], v15 offset:2048
ds_read_b128 v[216:219], v16 offset:64
ds_read_b128 v[220:223], v16 offset:5696
v_mfma_f32_32x32x16_bf16 v[40:55], v[160:163], a[236:239], v[40:55]
ds_read_b64_tr_b16 v[158:159], v15 offset:3072
v_mfma_f32_32x32x16_bf16 v[56:71], v[164:167], a[232:235], v[56:71]
v_mfma_f32_32x32x16_bf16 v[72:87], v[164:167], a[236:239], v[72:87]
s_waitcnt vmcnt(14) lgkmcnt(0)
ds_read_b64_tr_b16 v[160:161], v6 offset:10240
ds_read_b64_tr_b16 v[162:163], v6 offset:10752
v_mfma_f32_32x32x16_bf16 v[24:39], v[152:155], a[240:243], v[24:39]
ds_read_b64_tr_b16 v[164:165], v7 offset:10240
v_mfma_f32_32x32x16_bf16 v[40:55], v[152:155], a[244:247], v[40:55]
ds_read_b64_tr_b16 v[166:167], v7 offset:10752
v_mfma_f32_32x32x16_bf16 v[56:71], v[156:159], a[240:243], v[56:71]
v_mfma_f32_32x32x16_bf16 v[72:87], v[156:159], a[244:247], v[72:87]
s_waitcnt vmcnt(3)
v_mov_b32 v12, s39
v_mov_b32 v13, 0
v_cmp_eq_u32 vcc, 0, v1
s_and_saveexec_b64 s[0:1], vcc
buffer_store_dword v12, v13, s[20:23], s91 offen sc1
s_mov_b64 exec, s[0:1]
s_waitcnt lgkmcnt(0)
v_mfma_f32_32x32x16_bf16 v[24:39], v[160:163], v[216:219], v[24:39]
v_mfma_f32_32x32x16_bf16 v[40:55], v[160:163], v[220:223], v[40:55]
v_mfma_f32_32x32x16_bf16 v[56:71], v[164:167], v[216:219], v[56:71]
v_mfma_f32_32x32x16_bf16 v[72:87], v[164:167], v[220:223], v[72:87]
s_waitcnt vmcnt(3)
v_cmp_ne_u32 vcc, s39, v22
s_and_b32 vcc_lo, vcc_lo, s55
s_mov_b32 vcc_hi, 0
s_cbranch_vccnz L_ce2_slow
L_ce2_ret:
buffer_load_dwordx4 v[88:91], v17, s[20:23], s40 offen offset:0 sc1
buffer_load_dwordx4 v[92:95], v17, s[20:23], s40 offen offset:1024 sc1
buffer_load_dwordx4 v[96:99], v17, s[20:23], s41 offen offset:0 sc1
buffer_load_dwordx4 v[100:103], v17, s[20:23], s41 offen offset:1024 sc1
buffer_load_dwordx4 v[104:107], v17, s[20:23], s42 offen offset:0 sc1
buffer_load_dwordx4 v[108:111], v17, s[20:23], s42 offen offset:1024 sc1
buffer_load_dword v22, v11, s[20:23], s96 offen sc1
v_add_u32 v21, s38, v17
ds_write_b128 v21, v[24:27] offset:0
ds_write_b128 v21, v[28:31] offset:1024
ds_write_b128 v21, v[32:35] offset:2048
ds_write_b128 v21, v[36:39] offset:3072
ds_write_b128 v21, v[40:43] offset:4096
ds_write_b128 v21, v[44:47] offset:5120
ds_write_b128 v21, v[48:51] offset:6144
ds_write_b128 v21, v[52:55] offset:7168
ds_write_b128 v21, v[72:75] offset:8192
ds_write_b128 v21, v[76:79] offset:9216
ds_write_b128 v21, v[80:83] offset:10240
ds_write_b128 v21, v[84:87] offset:11264
s_waitcnt lgkmcnt(0)
s_barrier
v_add_u32 v21, 0, v17
ds_read_b128 v[184:187], v21 offset:4096
ds_read_b128 v[188:191], v21 offset:5120
ds_read_b128 v[192:195], v21 offset:6144
ds_read_b128 v[196:199], v21 offset:7168
ds_read_b128 v[200:203], v21 offset:16384
ds_read_b128 v[204:207], v21 offset:17408
ds_read_b128 v[208:211], v21 offset:18432
ds_read_b128 v[212:215], v21 offset:19456
ds_read_b128 v[216:219], v21 offset:45056
ds_read_b128 v[220:223], v21 offset:46080
ds_read_b128 v[224:227], v21 offset:47104
ds_read_b128 v[228:231], v21 offset:48128
s_waitcnt lgkmcnt(8)
v_add_f32 v56, v56, v184
v_add_f32 v57, v57, v185
v_add_f32 v58, v58, v186
v_add_f32 v59, v59, v187
v_add_f32 v60, v60, v188
v_add_f32 v61, v61, v189
v_add_f32 v62, v62, v190
v_add_f32 v63, v63, v191
v_add_f32 v64, v64, v192
v_add_f32 v65, v65, v193
v_add_f32 v66, v66, v194
v_add_f32 v67, v67, v195
v_add_f32 v68, v68, v196
v_add_f32 v69, v69, v197
v_add_f32 v70, v70, v198
v_add_f32 v71, v71, v199
s_waitcnt lgkmcnt(4)
v_add_f32 v56, v56, v200
v_add_f32 v57, v57, v201
v_add_f32 v58, v58, v202
v_add_f32 v59, v59, v203
v_add_f32 v60, v60, v204
v_add_f32 v61, v61, v205
v_add_f32 v62, v62, v206
v_add_f32 v63, v63, v207
v_add_f32 v64, v64, v208
v_add_f32 v65, v65, v209
v_add_f32 v66, v66, v210
v_add_f32 v67, v67, v211
v_add_f32 v68, v68, v212
v_add_f32 v69, v69, v213
v_add_f32 v70, v70, v214
v_add_f32 v71, v71, v215
s_waitcnt lgkmcnt(0)
v_add_f32 v56, v56, v216
v_add_f32 v57, v57, v217
v_add_f32 v58, v58, v218
v_add_f32 v59, v59, v219
v_add_f32 v60, v60, v220
v_add_f32 v61, v61, v221
v_add_f32 v62, v62, v222
v_add_f32 v63, v63, v223
v_add_f32 v64, v64, v224
v_add_f32 v65, v65, v225
v_add_f32 v66, v66, v226
v_add_f32 v67, v67, v227
v_add_f32 v68, v68, v228
v_add_f32 v69, v69, v229
v_add_f32 v70, v70, v230
v_add_f32 v71, v71, v231
s_waitcnt vmcnt(1)
v_dot2_f32_bf16 v56, v88, s57, v56
v_dot2_f32_bf16 v57, v88, s58, v57
v_dot2_f32_bf16 v58, v89, s57, v58
v_dot2_f32_bf16 v59, v89, s58, v59
v_dot2_f32_bf16 v60, v90, s57, v60
v_dot2_f32_bf16 v61, v90, s58, v61
v_dot2_f32_bf16 v62, v91, s57, v62
v_dot2_f32_bf16 v63, v91, s58, v63
v_dot2_f32_bf16 v64, v92, s57, v64
v_dot2_f32_bf16 v65, v92, s58, v65
v_dot2_f32_bf16 v66, v93, s57, v66
v_dot2_f32_bf16 v67, v93, s58, v67
v_dot2_f32_bf16 v68, v94, s57, v68
v_dot2_f32_bf16 v69, v94, s58, v69
v_dot2_f32_bf16 v70, v95, s57, v70
v_dot2_f32_bf16 v71, v95, s58, v71
v_dot2_f32_bf16 v56, v96, s57, v56
v_dot2_f32_bf16 v57, v96, s58, v57
v_dot2_f32_bf16 v58, v97, s57, v58
v_dot2_f32_bf16 v59, v97, s58, v59
v_dot2_f32_bf16 v60, v98, s57, v60
v_dot2_f32_bf16 v61, v98, s58, v61
v_dot2_f32_bf16 v62, v99, s57, v62
v_dot2_f32_bf16 v63, v99, s58, v63
v_dot2_f32_bf16 v64, v100, s57, v64
v_dot2_f32_bf16 v65, v100, s58, v65
v_dot2_f32_bf16 v66, v101, s57, v66
v_dot2_f32_bf16 v67, v101, s58, v67
v_dot2_f32_bf16 v68, v102, s57, v68
v_dot2_f32_bf16 v69, v102, s58, v69
v_dot2_f32_bf16 v70, v103, s57, v70
v_dot2_f32_bf16 v71, v103, s58, v71
v_dot2_f32_bf16 v56, v104, s57, v56
v_dot2_f32_bf16 v57, v104, s58, v57
v_dot2_f32_bf16 v58, v105, s57, v58
v_dot2_f32_bf16 v59, v105, s58, v59
v_dot2_f32_bf16 v60, v106, s57, v60
v_dot2_f32_bf16 v61, v106, s58, v61
v_dot2_f32_bf16 v62, v107, s57, v62
v_dot2_f32_bf16 v63, v107, s58, v63
v_dot2_f32_bf16 v64, v108, s57, v64
v_dot2_f32_bf16 v65, v108, s58, v65
v_dot2_f32_bf16 v66, v109, s57, v66
v_dot2_f32_bf16 v67, v109, s58, v67
v_dot2_f32_bf16 v68, v110, s57, v68
v_dot2_f32_bf16 v69, v110, s58, v69
v_dot2_f32_bf16 v70, v111, s57, v70
v_dot2_f32_bf16 v71, v111, s58, v71
s_waitcnt vmcnt(0)
v_cmp_ne_u32 vcc, s39, v22
s_and_b32 vcc_lo, vcc_lo, s56
s_mov_b32 vcc_hi, 0
s_cbranch_vccnz L_cl2_slow
L_cl2_ret:
buffer_load_dwordx4 v[184:187], v17, s[20:23], s43 offen offset:0 sc1
buffer_load_dwordx4 v[188:191], v17, s[20:23], s43 offen offset:1024 sc1
buffer_load_dwordx4 v[192:195], v17, s[20:23], s44 offen offset:0 sc1
buffer_load_dwordx4 v[196:199], v17, s[20:23], s44 offen offset:1024 sc1
buffer_load_dwordx4 v[200:203], v17, s[20:23], s45 offen offset:0 sc1
buffer_load_dwordx4 v[204:207], v17, s[20:23], s45 offen offset:1024 sc1
buffer_load_dwordx4 v[208:211], v17, s[20:23], s46 offen offset:0 sc1
buffer_load_dwordx4 v[212:215], v17, s[20:23], s46 offen offset:1024 sc1
s_waitcnt vmcnt(6)
v_dot2_f32_bf16 v56, v184, s57, v56
v_dot2_f32_bf16 v57, v184, s58, v57
v_dot2_f32_bf16 v58, v185, s57, v58
v_dot2_f32_bf16 v59, v185, s58, v59
v_dot2_f32_bf16 v60, v186, s57, v60
v_dot2_f32_bf16 v61, v186, s58, v61
v_dot2_f32_bf16 v62, v187, s57, v62
v_dot2_f32_bf16 v63, v187, s58, v63
v_dot2_f32_bf16 v64, v188, s57, v64
v_dot2_f32_bf16 v65, v188, s58, v65
v_dot2_f32_bf16 v66, v189, s57, v66
v_dot2_f32_bf16 v67, v189, s58, v67
v_dot2_f32_bf16 v68, v190, s57, v68
v_dot2_f32_bf16 v69, v190, s58, v69
v_dot2_f32_bf16 v70, v191, s57, v70
v_dot2_f32_bf16 v71, v191, s58, v71
s_waitcnt vmcnt(4)
v_dot2_f32_bf16 v56, v192, s57, v56
v_dot2_f32_bf16 v57, v192, s58, v57
v_dot2_f32_bf16 v58, v193, s57, v58
v_dot2_f32_bf16 v59, v193, s58, v59
v_dot2_f32_bf16 v60, v194, s57, v60
v_dot2_f32_bf16 v61, v194, s58, v61
v_dot2_f32_bf16 v62, v195, s57, v62
v_dot2_f32_bf16 v63, v195, s58, v63
v_dot2_f32_bf16 v64, v196, s57, v64
v_dot2_f32_bf16 v65, v196, s58, v65
v_dot2_f32_bf16 v66, v197, s57, v66
v_dot2_f32_bf16 v67, v197, s58, v67
v_dot2_f32_bf16 v68, v198, s57, v68
v_dot2_f32_bf16 v69, v198, s58, v69
v_dot2_f32_bf16 v70, v199, s57, v70
v_dot2_f32_bf16 v71, v199, s58, v71
s_waitcnt vmcnt(2)
v_dot2_f32_bf16 v56, v200, s57, v56
v_dot2_f32_bf16 v57, v200, s58, v57
v_dot2_f32_bf16 v58, v201, s57, v58
v_dot2_f32_bf16 v59, v201, s58, v59
v_dot2_f32_bf16 v60, v202, s57, v60
v_dot2_f32_bf16 v61, v202, s58, v61
v_dot2_f32_bf16 v62, v203, s57, v62
v_dot2_f32_bf16 v63, v203, s58, v63
v_dot2_f32_bf16 v64, v204, s57, v64
v_dot2_f32_bf16 v65, v204, s58, v65
v_dot2_f32_bf16 v66, v205, s57, v66
v_dot2_f32_bf16 v67, v205, s58, v67
v_dot2_f32_bf16 v68, v206, s57, v68
v_dot2_f32_bf16 v69, v206, s58, v69
v_dot2_f32_bf16 v70, v207, s57, v70
v_dot2_f32_bf16 v71, v207, s58, v71
s_waitcnt vmcnt(0)
v_dot2_f32_bf16 v56, v208, s57, v56
v_dot2_f32_bf16 v57, v208, s58, v57
v_dot2_f32_bf16 v58, v209, s57, v58
v_dot2_f32_bf16 v59, v209, s58, v59
v_dot2_f32_bf16 v60, v210, s57, v60
v_dot2_f32_bf16 v61, v210, s58, v61
v_dot2_f32_bf16 v62, v211, s57, v62
v_dot2_f32_bf16 v63, v211, s58, v63
v_dot2_f32_bf16 v64, v212, s57, v64
v_dot2_f32_bf16 v65, v212, s58, v65
v_dot2_f32_bf16 v66, v213, s57, v66
v_dot2_f32_bf16 v67, v213, s58, v67
v_dot2_f32_bf16 v68, v214, s57, v68
v_dot2_f32_bf16 v69, v214, s58, v69
v_dot2_f32_bf16 v70, v215, s57, v70
v_dot2_f32_bf16 v71, v215, s58, v71
s_nop 3
v_permlane32_swap_b32 v56, v60
v_permlane32_swap_b32 v57, v61
v_permlane32_swap_b32 v58, v62
v_permlane32_swap_b32 v59, v63
v_permlane32_swap_b32 v64, v68
v_permlane32_swap_b32 v65, v69
v_permlane32_swap_b32 v66, v70
v_permlane32_swap_b32 v67, v71
s_nop 1
v_dot2_f32_bf16 v56, v176, s57, v56
v_dot2_f32_bf16 v57, v176, s58, v57
v_dot2_f32_bf16 v58, v177, s57, v58
v_dot2_f32_bf16 v59, v177, s58, v59
v_dot2_f32_bf16 v60, v178, s57, v60
v_dot2_f32_bf16 v61, v178, s58, v61
v_dot2_f32_bf16 v62, v179, s57, v62
v_dot2_f32_bf16 v63, v179, s58, v63
v_dot2_f32_bf16 v64, v180, s57, v64
v_dot2_f32_bf16 v65, v180, s58, v65
v_dot2_f32_bf16 v66, v181, s57, v66
v_dot2_f32_bf16 v67, v181, s58, v67
v_dot2_f32_bf16 v68, v182, s57, v68
v_dot2_f32_bf16 v69, v182, s58, v69
v_dot2_f32_bf16 v70, v183, s57, v70
v_dot2_f32_bf16 v71, v183, s58, v71
s_nop 3
v_cvt_pk_bf16_f32 v176, v56, v57
v_cvt_pk_bf16_f32 v177, v58, v59
v_cvt_pk_bf16_f32 v178, v60, v61
v_cvt_pk_bf16_f32 v179, v62, v63
buffer_store_dwordx4 v[176:179], v10, s[24:27], s59 offen offset:0
v_cvt_pk_bf16_f32 v180, v64, v65
v_cvt_pk_bf16_f32 v181, v66, v67
v_cvt_pk_bf16_f32 v182, v68, v69
v_cvt_pk_bf16_f32 v183, v70, v71
buffer_store_dwordx4 v[180:183], v10, s[24:27], s59 offen offset:32
s_branch L_fin
L_sp3:
s_lshl_b32 s59, s3, 6
s_add_u32 s59, s59, 32
s_mul_i32 s59, s59, 1152
s_lshl_b32 s93, s4, 7
s_add_u32 s59, s59, s93
s_add_u32 s59, s59, 64
s_waitcnt vmcnt(19) lgkmcnt(0)
ds_read_b64_tr_b16 v[160:161], v14 offset:6144
ds_read_b64_tr_b16 v[162:163], v14 offset:7168
v_mfma_f32_32x32x16_bf16 v[24:39], v[152:155], a[248:251], 0
ds_read_b64_tr_b16 v[164:165], v15 offset:6144
v_cvt_pk_bf16_f32 v88, v88, v89
v_cvt_pk_bf16_f32 v89, v90, v91
v_cvt_pk_bf16_f32 v90, v92, v93
v_cvt_pk_bf16_f32 v91, v94, v95
v_cvt_pk_bf16_f32 v96, v96, v97
v_mfma_f32_32x32x16_bf16 v[40:55], v[152:155], a[252:255], 0
ds_read_b64_tr_b16 v[166:167], v15 offset:7168
v_cvt_pk_bf16_f32 v97, v98, v99
v_cvt_pk_bf16_f32 v98, v100, v101
v_cvt_pk_bf16_f32 v99, v102, v103
v_cvt_pk_bf16_f32 v104, v104, v105
v_cvt_pk_bf16_f32 v105, v106, v107
v_cvt_pk_bf16_f32 v106, v108, v109
v_mfma_f32_32x32x16_bf16 v[56:71], v[156:159], a[248:251], 0
v_cvt_pk_bf16_f32 v107, v110, v111
v_cvt_pk_bf16_f32 v112, v112, v113
v_cvt_pk_bf16_f32 v113, v114, v115
v_cvt_pk_bf16_f32 v114, v116, v117
v_cvt_pk_bf16_f32 v115, v118, v119
v_cvt_pk_bf16_f32 v120, v120, v121
v_cvt_pk_bf16_f32 v121, v122, v123
v_cvt_pk_bf16_f32 v122, v124, v125
v_cvt_pk_bf16_f32 v123, v126, v127
v_cvt_pk_bf16_f32 v128, v128, v129
v_cvt_pk_bf16_f32 v129, v130, v131
v_cvt_pk_bf16_f32 v130, v132, v133
v_cvt_pk_bf16_f32 v131, v134, v135
v_cvt_pk_bf16_f32 v136, v136, v137
v_mfma_f32_32x32x16_bf16 v[72:87], v[156:159], a[252:255], 0
v_cvt_pk_bf16_f32 v137, v138, v139
v_cvt_pk_bf16_f32 v138, v140, v141
v_cvt_pk_bf16_f32 v139, v142, v143
v_cvt_pk_bf16_f32 v144, v144, v145
v_cvt_pk_bf16_f32 v145, v146, v147
v_cvt_pk_bf16_f32 v146, v148, v149
v_cvt_pk_bf16_f32 v147, v150, v151
s_waitcnt vmcnt(17) lgkmcnt(0)
ds_read_b64_tr_b16 v[152:153], v8 offset:0
ds_read_b64_tr_b16 v[154:155], v8 offset:1024
v_mfma_f32_32x32x16_bf16 v[24:39], v[160:163], v[184:187], v[24:39]
ds_read_b64_tr_b16 v[156:157], v9 offset:0
buffer_store_dwordx4 v[88:91], v17, s[20:23], s101 offen offset:0 sc1
v_mfma_f32_32x32x16_bf16 v[40:55], v[160:163], v[188:191], v[40:55]
ds_read_b64_tr_b16 v[158:159], v9 offset:1024
buffer_store_dwordx4 v[96:99], v17, s[20:23], s101 offen offset:1024 sc1
v_mfma_f32_32x32x16_bf16 v[56:71], v[164:167], v[184:187], v[56:71]
buffer_store_dwordx4 v[104:107], v17, s[20:23], s101 offen offset:2048 sc1
v_mfma_f32_32x32x16_bf16 v[72:87], v[164:167], v[188:191], v[72:87]
buffer_store_dwordx4 v[112:115], v17, s[20:23], s101 offen offset:3072 sc1
s_waitcnt vmcnt(19) lgkmcnt(0)
ds_read_b64_tr_b16 v[160:161], v14 offset:32768
ds_read_b64_tr_b16 v[162:163], v14 offset:33792
v_mfma_f32_32x32x16_bf16 v[24:39], v[152:155], v[192:195], v[24:39]
ds_read_b64_tr_b16 v[164:165], v15 offset:32768
s_add_u32 s101, s101, 4096
v_mfma_f32_32x32x16_bf16 v[40:55], v[152:155], v[196:199], v[40:55]
ds_read_b64_tr_b16 v[166:167], v15 offset:33792
buffer_store_dwordx4 v[120:123], v17, s[20:23], s101 offen offset:0 sc1
v_mfma_f32_32x32x16_bf16 v[56:71], v[156:159], v[192:195], v[56:71]
buffer_store_dwordx4 v[128:131], v17, s[20:23], s101 offen offset:1024 sc1
buffer_store_dwordx4 v[136:139], v17, s[20:23], s101 offen offset:2048 sc1
v_mfma_f32_32x32x16_bf16 v[72:87], v[156:159], v[196:199], v[72:87]
buffer_store_dwordx4 v[144:147], v17, s[20:23], s101 offen offset:3072 sc1
s_waitcnt vmcnt(21) lgkmcnt(0)
ds_read_b64_tr_b16 v[152:153], v8 offset:2048
ds_read_b64_tr_b16 v[154:155], v8 offset:3072
v_mfma_f32_32x32x16_bf16 v[24:39], v[160:163], v[200:203], v[24:39]
ds_read_b64_tr_b16 v[156:157], v9 offset:2048
v_mfma_f32_32x32x16_bf16 v[40:55], v[160:163], v[204:207], v[40:55]
ds_read_b64_tr_b16 v[158:159], v9 offset:3072
v_mfma_f32_32x32x16_bf16 v[56:71], v[164:167], v[200:203], v[56:71]
buffer_load_dword v22, v11, s[20:23], s96 offen sc1
v_mfma_f32_32x32x16_bf16 v[72:87], v[164:167], v[204:207], v[72:87]
buffer_load_dword v23, v11, s[20:23], s97 offen sc1
s_waitcnt vmcnt(21) lgkmcnt(0)
ds_read_b64_tr_b16 v[160:161], v8 offset:4096
ds_read_b64_tr_b16 v[162:163], v8 offset:5120
v_mfma_f32_32x32x16_bf16 v[24:39], v[152:155], v[208:211], v[24:39]
ds_read_b64_tr_b16 v[164:165], v9 offset:4096
v_mfma_f32_32x32x16_bf16 v[40:55], v[152:155], v[212:215], v[40:55]
ds_read_b64_tr_b16 v[166:167], v9 offset:5120
v_mfma_f32_32x32x16_bf16 v[56:71], v[156:159], v[208:211], v[56:71]
buffer_load_dwordx4 v[176:179], v10, s[8:11], s59 offen offset:0
buffer_load_dwordx4 v[180:183], v10, s[8:11], s59 offen offset:32
v_mfma_f32_32x32x16_bf16 v[72:87], v[156:159], v[212:215], v[72:87]
s_waitcnt vmcnt(21) lgkmcnt(0)
ds_read_b64_tr_b16 v[152:153], v8 offset:6144
ds_read_b64_tr_b16 v[154:155], v8 offset:7168
v_mfma_f32_32x32x16_bf16 v[24:39], v[160:163], a[128:131], v[24:39]
ds_read_b64_tr_b16 v[156:157], v9 offset:6144
v_mfma_f32_32x32x16_bf16 v[40:55], v[160:163], a[132:135], v[40:55]
ds_read_b64_tr_b16 v[158:159], v9 offset:7168
v_mfma_f32_32x32x16_bf16 v[56:71], v[164:167], a[128:131], v[56:71]
v_mfma_f32_32x32x16_bf16 v[72:87], v[164:167], a[132:135], v[72:87]
s_waitcnt vmcnt(19) lgkmcnt(0)
ds_read_b64_tr_b16 v[160:161], v8 offset:8192
ds_read_b64_tr_b16 v[162:163], v8 offset:9216
v_mfma_f32_32x32x16_bf16 v[24:39], v[152:155], a[136:139], v[24:39]
ds_read_b64_tr_b16 v[164:165], v9 offset:8192
v_mfma_f32_32x32x16_bf16 v[40:55], v[152:155], a[140:143], v[40:55]
ds_read_b64_tr_b16 v[166:167], v9 offset:9216
v_mfma_f32_32x32x16_bf16 v[56:71], v[156:159], a[136:139], v[56:71]
v_mfma_f32_32x32x16_bf16 v[72:87], v[156:159], a[140:143], v[72:87]
s_waitcnt vmcnt(17) lgkmcnt(0)
ds_read_b64_tr_b16 v[152:153], v14 offset:2048
ds_read_b64_tr_b16 v[154:155], v14 offset:3072
v_mfma_f32_32x32x16_bf16 v[24:39], v[160:163], a[144:147], v[24:39]
ds_read_b64_tr_b16 v[156:157], v15 offset:2048
ds_read_b128 v[216:219], v16 offset:96
ds_read_b128 v[220:223], v16 offset:5728
v_mfma_f32_32x32x16_bf16 v[40:55], v[160:163], a[148:151], v[40:55]
ds_read_b64_tr_b16 v[158:159], v15 offset:3072
v_mfma_f32_32x32x16_bf16 v[56:71], v[164:167], a[144:147], v[56:71]
v_mfma_f32_32x32x16_bf16 v[72:87], v[164:167], a[148:151], v[72:87]
s_waitcnt vmcnt(15) lgkmcnt(0)
ds_read_b64_tr_b16 v[160:161], v6 offset:10240
ds_read_b64_tr_b16 v[162:163], v6 offset:10752
v_mfma_f32_32x32x16_bf16 v[24:39], v[152:155], a[152:155], v[24:39]
ds_read_b64_tr_b16 v[164:165], v7 offset:10240
ds_read_b128 v[224:227], v16 offset:128
ds_read_b128 v[228:231], v16 offset:5760
v_mfma_f32_32x32x16_bf16 v[40:55], v[152:155], a[156:159], v[40:55]
ds_read_b64_tr_b16 v[166:167], v7 offset:10752
v_mfma_f32_32x32x16_bf16 v[56:71], v[156:159], a[152:155], v[56:71]
v_mfma_f32_32x32x16_bf16 v[72:87], v[156:159], a[156:159], v[72:87]
s_waitcnt vmcnt(4)
v_mov_b32 v12, s39
v_mov_b32 v13, 0
v_cmp_eq_u32 vcc, 0, v1
s_and_saveexec_b64 s[0:1], vcc
buffer_store_dword v12, v13, s[20:23], s91 offen sc1
s_mov_b64 exec, s[0:1]
s_waitcnt lgkmcnt(0)
ds_read_b64_tr_b16 v[152:153], v172 offset:4096
ds_read_b64_tr_b16 v[154:155], v172 offset:4608
v_mfma_f32_32x32x16_bf16 v[24:39], v[160:163], v[216:219], v[24:39]
ds_read_b64_tr_b16 v[156:157], v173 offset:4096
v_mfma_f32_32x32x16_bf16 v[40:55], v[160:163], v[220:223], v[40:55]
ds_read_b64_tr_b16 v[158:159], v173 offset:4608
v_mfma_f32_32x32x16_bf16 v[56:71], v[164:167], v[216:219], v[56:71]
v_mfma_f32_32x32x16_bf16 v[72:87], v[164:167], v[220:223], v[72:87]
s_waitcnt lgkmcnt(0)
v_mfma_f32_32x32x16_bf16 v[24:39], v[152:155], v[224:227], v[24:39]
v_mfma_f32_32x32x16_bf16 v[40:55], v[152:155], v[228:231], v[40:55]
v_mfma_f32_32x32x16_bf16 v[56:71], v[156:159], v[224:227], v[56:71]
v_mfma_f32_32x32x16_bf16 v[72:87], v[156:159], v[228:231], v[72:87]
s_waitcnt vmcnt(3)
v_cmp_ne_u32 vcc, s39, v22
s_and_b32 vcc_lo, vcc_lo, s55
s_mov_b32 vcc_hi, 0
s_cbranch_vccnz L_ce3_slow
L_ce3_ret:
buffer_load_dwordx4 v[88:91], v17, s[20:23], s40 offen offset:0 sc1
buffer_load_dwordx4 v[92:95], v17, s[20:23], s40 offen offset:1024 sc1
buffer_load_dwordx4 v[96:99], v17, s[20:23], s41 offen offset:0 sc1
buffer_load_dwordx4 v[100:103], v17, s[20:23], s41 offen offset:1024 sc1
buffer_load_dwordx4 v[104:107], v17, s[20:23], s42 offen offset:0 sc1
buffer_load_dwordx4 v[108:111], v17, s[20:23], s42 offen offset:1024 sc1
v_cmp_ne_u32 vcc, s39, v23
s_and_b32 vcc_lo, vcc_lo, 0xff
s_mov_b32 vcc_hi, 0
s_cbranch_vccnz L_c8_slow
L_c8_ret:
buffer_load_dwordx4 v[112:115], v17, s[20:23], s47 offen sc1
buffer_load_dwordx4 v[116:119], v17, s[20:23], s48 offen sc1
buffer_load_dwordx4 v[120:123], v17, s[20:23], s49 offen sc1
buffer_load_dwordx4 v[124:127], v17, s[20:23], s50 offen sc1
buffer_load_dwordx4 v[128:131], v17, s[20:23], s51 offen sc1
buffer_load_dwordx4 v[132:135], v17, s[20:23], s52 offen sc1
buffer_load_dwordx4 v[136:139], v17, s[20:23], s53 offen sc1
buffer_load_dwordx4 v[140:143], v17, s[20:23], s54 offen sc1
buffer_load_dwordx4 v[144:147], v10, s[8:11], s60 offen
buffer_load_dword v22, v11, s[20:23], s96 offen sc1
v_add_u32 v21, s38, v17
ds_write_b128 v21, v[24:27] offset:0
ds_write_b128 v21, v[28:31] offset:1024
ds_write_b128 v21, v[32:35] offset:2048
ds_write_b128 v21, v[36:39] offset:3072
ds_write_b128 v21, v[40:43] offset:4096
ds_write_b128 v21, v[44:47] offset:5120
ds_write_b128 v21, v[48:51] offset:6144
ds_write_b128 v21, v[52:55] offset:7168
ds_write_b128 v21, v[56:59] offset:8192
ds_write_b128 v21, v[60:63] offset:9216
ds_write_b128 v21, v[64:67] offset:10240
ds_write_b128 v21, v[68:71] offset:11264
s_waitcnt lgkmcnt(0)
s_barrier
v_add_u32 v21, 0, v17
ds_read_b128 v[184:187], v21 offset:8192
ds_read_b128 v[188:191], v21 offset:9216
ds_read_b128 v[192:195], v21 offset:10240
ds_read_b128 v[196:199], v21 offset:11264
ds_read_b128 v[200:203], v21 offset:20480
ds_read_b128 v[204:207], v21 offset:21504
ds_read_b128 v[208:211], v21 offset:22528
ds_read_b128 v[212:215], v21 offset:23552
ds_read_b128 v[216:219], v21 offset:32768
ds_read_b128 v[220:223], v21 offset:33792
ds_read_b128 v[224:227], v21 offset:34816
ds_read_b128 v[228:231], v21 offset:35840
s_waitcnt lgkmcnt(8)
v_add_f32 v72, v72, v184
v_add_f32 v73, v73, v185
v_add_f32 v74, v74, v186
v_add_f32 v75, v75, v187
v_add_f32 v76, v76, v188
v_add_f32 v77, v77, v189
v_add_f32 v78, v78, v190
v_add_f32 v79, v79, v191
v_add_f32 v80, v80, v192
v_add_f32 v81, v81, v193
v_add_f32 v82, v82, v194
v_add_f32 v83, v83, v195
v_add_f32 v84, v84, v196
v_add_f32 v85, v85, v197
v_add_f32 v86, v86, v198
v_add_f32 v87, v87, v199
s_waitcnt lgkmcnt(4)
v_add_f32 v72, v72, v200
v_add_f32 v73, v73, v201
v_add_f32 v74, v74, v202
v_add_f32 v75, v75, v203
v_add_f32 v76, v76, v204
v_add_f32 v77, v77, v205
v_add_f32 v78, v78, v206
v_add_f32 v79, v79, v207
v_add_f32 v80, v80, v208
v_add_f32 v81, v81, v209
v_add_f32 v82, v82, v210
v_add_f32 v83, v83, v211
v_add_f32 v84, v84, v212
v_add_f32 v85, v85, v213
v_add_f32 v86, v86, v214
v_add_f32 v87, v87, v215
s_waitcnt lgkmcnt(0)
v_add_f32 v72, v72, v216
v_add_f32 v73, v73, v217
v_add_f32 v74, v74, v218
v_add_f32 v75, v75, v219
v_add_f32 v76, v76, v220
v_add_f32 v77, v77, v221
v_add_f32 v78, v78, v222
v_add_f32 v79, v79, v223
v_add_f32 v80, v80, v224
v_add_f32 v81, v81, v225
v_add_f32 v82, v82, v226
v_add_f32 v83, v83, v227
v_add_f32 v84, v84, v228
v_add_f32 v85, v85, v229
v_add_f32 v86, v86, v230
v_add_f32 v87, v87, v231
s_waitcnt vmcnt(10)
v_dot2_f32_bf16 v72, v88, s57, v72
v_dot2_f32_bf16 v73, v88, s58, v73
v_dot2_f32_bf16 v74, v89, s57, v74
v_dot2_f32_bf16 v75, v89, s58, v75
v_dot2_f32_bf16 v76, v90, s57, v76
v_dot2_f32_bf16 v77, v90, s58, v77
v_dot2_f32_bf16 v78, v91, s57, v78
v_dot2_f32_bf16 v79, v91, s58, v79
v_dot2_f32_bf16 v80, v92, s57, v80
v_dot2_f32_bf16 v81, v92, s58, v81
v_dot2_f32_bf16 v82, v93, s57, v82
v_dot2_f32_bf16 v83, v93, s58, v83
v_dot2_f32_bf16 v84, v94, s57, v84
v_dot2_f32_bf16 v85, v94, s58, v85
v_dot2_f32_bf16 v86, v95, s57, v86
v_dot2_f32_bf16 v87, v95, s58, v87
v_dot2_f32_bf16 v72, v96, s57, v72
v_dot2_f32_bf16 v73, v96, s58, v73
v_dot2_f32_bf16 v74, v97, s57, v74
v_dot2_f32_bf16 v75, v97, s58, v75
v_dot2_f32_bf16 v76, v98, s57, v76
v_dot2_f32_bf16 v77, v98, s58, v77
v_dot2_f32_bf16 v78, v99, s57, v78
v_dot2_f32_bf16 v79, v99, s58, v79
v_dot2_f32_bf16 v80, v100, s57, v80
v_dot2_f32_bf16 v81, v100, s58, v81
v_dot2_f32_bf16 v82, v101, s57, v82
v_dot2_f32_bf16 v83, v101, s58, v83
v_dot2_f32_bf16 v84, v102, s57, v84
v_dot2_f32_bf16 v85, v102, s58, v85
v_dot2_f32_bf16 v86, v103, s57, v86
v_dot2_f32_bf16 v87, v103, s58, v87
v_dot2_f32_bf16 v72, v104, s57, v72
v_dot2_f32_bf16 v73, v104, s58, v73
v_dot2_f32_bf16 v74, v105, s57, v74
v_dot2_f32_bf16 v75, v105, s58, v75
v_dot2_f32_bf16 v76, v106, s57, v76
v_dot2_f32_bf16 v77, v106, s58, v77
v_dot2_f32_bf16 v78, v107, s57, v78
v_dot2_f32_bf16 v79, v107, s58, v79
v_dot2_f32_bf16 v80, v108, s57, v80
v_dot2_f32_bf16 v81, v108, s58, v81
v_dot2_f32_bf16 v82, v109, s57, v82
v_dot2_f32_bf16 v83, v109, s58, v83
v_dot2_f32_bf16 v84, v110, s57, v84
v_dot2_f32_bf16 v85, v110, s58, v85
v_dot2_f32_bf16 v86, v111, s57, v86
v_dot2_f32_bf16 v87, v111, s58, v87
s_waitcnt vmcnt(0)
v_cmp_ne_u32 vcc, s39, v22
s_and_b32 vcc_lo, vcc_lo, s56
s_mov_b32 vcc_hi, 0
s_cbranch_vccnz L_cl3_slow
L_cl3_ret:
buffer_load_dwordx4 v[184:187], v17, s[20:23], s43 offen offset:0 sc1
buffer_load_dwordx4 v[188:191], v17, s[20:23], s43 offen offset:1024 sc1
buffer_load_dwordx4 v[192:195], v17, s[20:23], s44 offen offset:0 sc1
buffer_load_dwordx4 v[196:199], v17, s[20:23], s44 offen offset:1024 sc1
buffer_load_dwordx4 v[200:203], v17, s[20:23], s45 offen offset:0 sc1
buffer_load_dwordx4 v[204:207], v17, s[20:23], s45 offen offset:1024 sc1
buffer_load_dwordx4 v[208:211], v17, s[20:23], s46 offen offset:0 sc1
buffer_load_dwordx4 v[212:215], v17, s[20:23], s46 offen offset:1024 sc1
s_waitcnt vmcnt(8)
v_mov_b32 v24, 0
v_mov_b32 v25, 0
v_mov_b32 v26, 0
v_mov_b32 v27, 0
v_mov_b32 v28, 0
v_mov_b32 v29, 0
v_mov_b32 v30, 0
v_mov_b32 v31, 0
v_dot2_f32_bf16 v24, v112, s57, v24
v_dot2_f32_bf16 v25, v112, s58, v25
v_dot2_f32_bf16 v26, v113, s57, v26
v_dot2_f32_bf16 v27, v113, s58, v27
v_dot2_f32_bf16 v28, v114, s57, v28
v_dot2_f32_bf16 v29, v114, s58, v29
v_dot2_f32_bf16 v30, v115, s57, v30
v_dot2_f32_bf16 v31, v115, s58, v31
v_dot2_f32_bf16 v24, v116, s57, v24
v_dot2_f32_bf16 v25, v116, s58, v25
v_dot2_f32_bf16 v26, v117, s57, v26
v_dot2_f32_bf16 v27, v117, s58, v27
v_dot2_f32_bf16 v28, v118, s57, v28
v_dot2_f32_bf16 v29, v118, s58, v29
v_dot2_f32_bf16 v30, v119, s57, v30
v_dot2_f32_bf16 v31, v119, s58, v31
v_dot2_f32_bf16 v24, v120, s57, v24
v_dot2_f32_bf16 v25, v120, s58, v25
v_dot2_f32_bf16 v26, v121, s57, v26
v_dot2_f32_bf16 v27, v121, s58, v27
v_dot2_f32_bf16 v28, v122, s57, v28
v_dot2_f32_bf16 v29, v122, s58, v29
v_dot2_f32_bf16 v30, v123, s57, v30
v_dot2_f32_bf16 v31, v123, s58, v31
v_dot2_f32_bf16 v24, v124, s57, v24
v_dot2_f32_bf16 v25, v124, s58, v25
v_dot2_f32_bf16 v26, v125, s57, v26
v_dot2_f32_bf16 v27, v125, s58, v27
v_dot2_f32_bf16 v28, v126, s57, v28
v_dot2_f32_bf16 v29, v126, s58, v29
v_dot2_f32_bf16 v30, v127, s57, v30
v_dot2_f32_bf16 v31, v127, s58, v31
v_dot2_f32_bf16 v24, v128, s57, v24
v_dot2_f32_bf16 v25, v128, s58, v25
v_dot2_f32_bf16 v26, v129, s57, v26
v_dot2_f32_bf16 v27, v129, s58, v27
v_dot2_f32_bf16 v28, v130, s57, v28
v_dot2_f32_bf16 v29, v130, s58, v29
v_dot2_f32_bf16 v30, v131, s57, v30
v_dot2_f32_bf16 v31, v131, s58, v31
v_dot2_f32_bf16 v24, v132, s57, v24
v_dot2_f32_bf16 v25, v132, s58, v25
v_dot2_f32_bf16 v26, v133, s57, v26
v_dot2_f32_bf16 v27, v133, s58, v27
v_dot2_f32_bf16 v28, v134, s57, v28
v_dot2_f32_bf16 v29, v134, s58, v29
v_dot2_f32_bf16 v30, v135, s57, v30
v_dot2_f32_bf16 v31, v135, s58, v31
v_dot2_f32_bf16 v24, v136, s57, v24
v_dot2_f32_bf16 v25, v136, s58, v25
v_dot2_f32_bf16 v26, v137, s57, v26
v_dot2_f32_bf16 v27, v137, s58, v27
v_dot2_f32_bf16 v28, v138, s57, v28
v_dot2_f32_bf16 v29, v138, s58, v29
v_dot2_f32_bf16 v30, v139, s57, v30
v_dot2_f32_bf16 v31, v139, s58, v31
v_dot2_f32_bf16 v24, v140, s57, v24
v_dot2_f32_bf16 v25, v140, s58, v25
v_dot2_f32_bf16 v26, v141, s57, v26
v_dot2_f32_bf16 v27, v141, s58, v27
v_dot2_f32_bf16 v28, v142, s57, v28
v_dot2_f32_bf16 v29, v142, s58, v29
v_dot2_f32_bf16 v30, v143, s57, v30
v_dot2_f32_bf16 v31, v143, s58, v31
s_nop 3
v_permlane32_swap_b32 v24, v28
v_permlane32_swap_b32 v25, v29
v_permlane32_swap_b32 v26, v30
v_permlane32_swap_b32 v27, v31
s_nop 1
v_dot2_f32_bf16 v24, v144, s57, v24
v_dot2_f32_bf16 v25, v144, s58, v25
v_dot2_f32_bf16 v26, v145, s57, v26
v_dot2_f32_bf16 v27, v145, s58, v27
v_dot2_f32_bf16 v28, v146, s57, v28
v_dot2_f32_bf16 v29, v146, s58, v29
v_dot2_f32_bf16 v30, v147, s57, v30
v_dot2_f32_bf16 v31, v147, s58, v31
s_nop 3
v_cvt_pk_bf16_f32 v144, v24, v25
v_cvt_pk_bf16_f32 v145, v26, v27
v_cvt_pk_bf16_f32 v146, v28, v29
v_cvt_pk_bf16_f32 v147, v30, v31
buffer_store_dwordx4 v[144:147], v10, s[24:27], s60 offen offset:0
s_waitcnt vmcnt(7)
v_dot2_f32_bf16 v72, v184, s57, v72
v_dot2_f32_bf16 v73, v184, s58, v73
v_dot2_f32_bf16 v74, v185, s57, v74
v_dot2_f32_bf16 v75, v185, s58, v75
v_dot2_f32_bf16 v76, v186, s57, v76
v_dot2_f32_bf16 v77, v186, s58, v77
v_dot2_f32_bf16 v78, v187, s57, v78
v_dot2_f32_bf16 v79, v187, s58, v79
v_dot2_f32_bf16 v80, v188, s57, v80
v_dot2_f32_bf16 v81, v188, s58, v81
v_dot2_f32_bf16 v82, v189, s57, v82
v_dot2_f32_bf16 v83, v189, s58, v83
v_dot2_f32_bf16 v84, v190, s57, v84
v_dot2_f32_bf16 v85, v190, s58, v85
v_dot2_f32_bf16 v86, v191, s57, v86
v_dot2_f32_bf16 v87, v191, s58, v87
s_waitcnt vmcnt(5)
v_dot2_f32_bf16 v72, v192, s57, v72
v_dot2_f32_bf16 v73, v192, s58, v73
v_dot2_f32_bf16 v74, v193, s57, v74
v_dot2_f32_bf16 v75, v193, s58, v75
v_dot2_f32_bf16 v76, v194, s57, v76
v_dot2_f32_bf16 v77, v194, s58, v77
v_dot2_f32_bf16 v78, v195, s57, v78
v_dot2_f32_bf16 v79, v195, s58, v79
v_dot2_f32_bf16 v80, v196, s57, v80
v_dot2_f32_bf16 v81, v196, s58, v81
v_dot2_f32_bf16 v82, v197, s57, v82
v_dot2_f32_bf16 v83, v197, s58, v83
v_dot2_f32_bf16 v84, v198, s57, v84
v_dot2_f32_bf16 v85, v198, s58, v85
v_dot2_f32_bf16 v86, v199, s57, v86
v_dot2_f32_bf16 v87, v199, s58, v87
s_waitcnt vmcnt(3)
v_dot2_f32_bf16 v72, v200, s57, v72
v_dot2_f32_bf16 v73, v200, s58, v73
v_dot2_f32_bf16 v74, v201, s57, v74
v_dot2_f32_bf16 v75, v201, s58, v75
v_dot2_f32_bf16 v76, v202, s57, v76
v_dot2_f32_bf16 v77, v202, s58, v77
v_dot2_f32_bf16 v78, v203, s57, v78
v_dot2_f32_bf16 v79, v203, s58, v79
v_dot2_f32_bf16 v80, v204, s57, v80
v_dot2_f32_bf16 v81, v204, s58, v81
v_dot2_f32_bf16 v82, v205, s57, v82
v_dot2_f32_bf16 v83, v205, s58, v83
v_dot2_f32_bf16 v84, v206, s57, v84
v_dot2_f32_bf16 v85, v206, s58, v85
v_dot2_f32_bf16 v86, v207, s57, v86
v_dot2_f32_bf16 v87, v207, s58, v87
s_waitcnt vmcnt(1)
v_dot2_f32_bf16 v72, v208, s57, v72
v_dot2_f32_bf16 v73, v208, s58, v73
v_dot2_f32_bf16 v74, v209, s57, v74
v_dot2_f32_bf16 v75, v209, s58, v75
v_dot2_f32_bf16 v76, v210, s57, v76
v_dot2_f32_bf16 v77, v210, s58, v77
v_dot2_f32_bf16 v78, v211, s57, v78
v_dot2_f32_bf16 v79, v211, s58, v79
v_dot2_f32_bf16 v80, v212, s57, v80
v_dot2_f32_bf16 v81, v212, s58, v81
v_dot2_f32_bf16 v82, v213, s57, v82
v_dot2_f32_bf16 v83, v213, s58, v83
v_dot2_f32_bf16 v84, v214, s57, v84
v_dot2_f32_bf16 v85, v214, s58, v85
v_dot2_f32_bf16 v86, v215, s57, v86
v_dot2_f32_bf16 v87, v215, s58, v87
s_nop 3
v_permlane32_swap_b32 v72, v76
v_permlane32_swap_b32 v73, v77
v_permlane32_swap_b32 v74, v78
v_permlane32_swap_b32 v75, v79
v_permlane32_swap_b32 v80, v84
v_permlane32_swap_b32 v81, v85
v_permlane32_swap_b32 v82, v86
v_permlane32_swap_b32 v83, v87
s_nop 1
v_dot2_f32_bf16 v72, v176, s57, v72
v_dot2_f32_bf16 v73, v176, s58, v73
v_dot2_f32_bf16 v74, v177, s57, v74
v_dot2_f32_bf16 v75, v177, s58, v75
v_dot2_f32_bf16 v76, v178, s57, v76
v_dot2_f32_bf16 v77, v178, s58, v77
v_dot2_f32_bf16 v78, v179, s57, v78
v_dot2_f32_bf16 v79, v179, s58, v79
v_dot2_f32_bf16 v80, v180, s57, v80
v_dot2_f32_bf16 v81, v180, s58, v81
v_dot2_f32_bf16 v82, v181, s57, v82
v_dot2_f32_bf16 v83, v181, s58, v83
v_dot2_f32_bf16 v84, v182, s57, v84
v_dot2_f32_bf16 v85, v182, s58, v85
v_dot2_f32_bf16 v86, v183, s57, v86
v_dot2_f32_bf16 v87, v183, s58, v87
s_nop 3
v_cvt_pk_bf16_f32 v176, v72, v73
v_cvt_pk_bf16_f32 v177, v74, v75
v_cvt_pk_bf16_f32 v178, v76, v77
v_cvt_pk_bf16_f32 v179, v78, v79
buffer_store_dwordx4 v[176:179], v10, s[24:27], s59 offen offset:0
v_cvt_pk_bf16_f32 v180, v80, v81
v_cvt_pk_bf16_f32 v181, v82, v83
v_cvt_pk_bf16_f32 v182, v84, v85
v_cvt_pk_bf16_f32 v183, v86, v87
buffer_store_dwordx4 v[180:183], v10, s[24:27], s59 offen offset:32
L_fin:
L_end:
s_endpgm
L_c1_0_slow:
s_mov_b32 s94, 0
L_c1_0_loop:
buffer_load_dword v169, v168, s[20:23], s96 offen sc1
s_add_u32 s94, s94, 1
s_waitcnt vmcnt(0)
v_cmp_ne_u32 vcc, s39, v169
s_and_b32 vcc_lo, vcc_lo, 0xffffffff
s_mov_b32 vcc_hi, 0
s_cbranch_vccz L_c1_0_ret
s_cmp_gt_u32 s94, 20000
s_cbranch_scc0 L_c1_0_loop
s_branch L_c1_0_ret
L_c1_1_slow:
s_mov_b32 s94, 0
L_c1_1_loop:
buffer_load_dword v169, v168, s[20:23], s96 offen sc1
s_add_u32 s94, s94, 1
s_waitcnt vmcnt(0)
v_cmp_ne_u32 vcc, s39, v169
s_and_b32 vcc_lo, vcc_lo, 0xffffffff
s_mov_b32 vcc_hi, 0
s_cbranch_vccz L_c1_1_ret
s_cmp_gt_u32 s94, 20000
s_cbranch_scc0 L_c1_1_loop
s_branch L_c1_1_ret
L_c2_slow:
s_mov_b32 s94, 0
L_c2_loop:
buffer_load_dword v22, v21, s[20:23], s96 offen sc1
s_add_u32 s94, s94, 1
s_waitcnt vmcnt(0)
v_cmp_ne_u32 vcc, s39, v22
s_and_b32 vcc_lo, vcc_lo, 0xffff
s_mov_b32 vcc_hi, 0
s_cbranch_vccz L_c2_ret
s_cmp_gt_u32 s94, 20000
s_cbranch_scc0 L_c2_loop
s_branch L_c2_ret
L_ce0_slow:
s_mov_b32 s94, 0
L_ce0_loop:
buffer_load_dword v22, v11, s[20:23], s96 offen sc1
s_add_u32 s94, s94, 1
s_waitcnt vmcnt(0)
v_cmp_ne_u32 vcc, s39, v22
s_and_b32 vcc_lo, vcc_lo, s55
s_mov_b32 vcc_hi, 0
s_cbranch_vccz L_ce0_ret
s_cmp_gt_u32 s94, 20000
s_cbranch_scc0 L_ce0_loop
s_branch L_ce0_ret
L_cl0_slow:
s_mov_b32 s94, 0
L_cl0_loop:
buffer_load_dword v22, v11, s[20:23], s96 offen sc1
s_add_u32 s94, s94, 1
s_waitcnt vmcnt(0)
v_cmp_ne_u32 vcc, s39, v22
s_and_b32 vcc_lo, vcc_lo, s56
s_mov_b32 vcc_hi, 0
s_cbranch_vccz L_cl0_ret
s_cmp_gt_u32 s94, 20000
s_cbranch_scc0 L_cl0_loop
s_branch L_cl0_ret
L_ce1_slow:
s_mov_b32 s94, 0
L_ce1_loop:
buffer_load_dword v22, v11, s[20:23], s96 offen sc1
s_add_u32 s94, s94, 1
s_waitcnt vmcnt(0)
v_cmp_ne_u32 vcc, s39, v22
s_and_b32 vcc_lo, vcc_lo, s55
s_mov_b32 vcc_hi, 0
s_cbranch_vccz L_ce1_ret
s_cmp_gt_u32 s94, 20000
s_cbranch_scc0 L_ce1_loop
s_branch L_ce1_ret
L_cl1_slow:
s_mov_b32 s94, 0
L_cl1_loop:
buffer_load_dword v22, v11, s[20:23], s96 offen sc1
s_add_u32 s94, s94, 1
s_waitcnt vmcnt(0)
v_cmp_ne_u32 vcc, s39, v22
s_and_b32 vcc_lo, vcc_lo, s56
s_mov_b32 vcc_hi, 0
s_cbranch_vccz L_cl1_ret
s_cmp_gt_u32 s94, 20000
s_cbranch_scc0 L_cl1_loop
s_branch L_cl1_ret
L_ce2_slow:
s_mov_b32 s94, 0
L_ce2_loop:
buffer_load_dword v22, v11, s[20:23], s96 offen sc1
s_add_u32 s94, s94, 1
s_waitcnt vmcnt(0)
v_cmp_ne_u32 vcc, s39, v22
s_and_b32 vcc_lo, vcc_lo, s55
s_mov_b32 vcc_hi, 0
s_cbranch_vccz L_ce2_ret
s_cmp_gt_u32 s94, 20000
s_cbranch_scc0 L_ce2_loop
s_branch L_ce2_ret
L_cl2_slow:
s_mov_b32 s94, 0
L_cl2_loop:
buffer_load_dword v22, v11, s[20:23], s96 offen sc1
s_add_u32 s94, s94, 1
s_waitcnt vmcnt(0)
v_cmp_ne_u32 vcc, s39, v22
s_and_b32 vcc_lo, vcc_lo, s56
s_mov_b32 vcc_hi, 0
s_cbranch_vccz L_cl2_ret
s_cmp_gt_u32 s94, 20000
s_cbranch_scc0 L_cl2_loop
s_branch L_cl2_ret
L_ce3_slow:
s_mov_b32 s94, 0
L_ce3_loop:
buffer_load_dword v22, v11, s[20:23], s96 offen sc1
s_add_u32 s94, s94, 1
s_waitcnt vmcnt(0)
v_cmp_ne_u32 vcc, s39, v22
s_and_b32 vcc_lo, vcc_lo, s55
s_mov_b32 vcc_hi, 0
s_cbranch_vccz L_ce3_ret
s_cmp_gt_u32 s94, 20000
s_cbranch_scc0 L_ce3_loop
s_branch L_ce3_ret
L_c8_slow:
s_mov_b32 s94, 0
L_c8_loop:
buffer_load_dword v23, v11, s[20:23], s97 offen sc1
s_add_u32 s94, s94, 1
s_waitcnt vmcnt(0)
v_cmp_ne_u32 vcc, s39, v23
s_and_b32 vcc_lo, vcc_lo, 0xff
s_mov_b32 vcc_hi, 0
s_cbranch_vccz L_c8_ret
s_cmp_gt_u32 s94, 20000
s_cbranch_scc0 L_c8_loop
s_branch L_c8_ret
L_cl3_slow:
s_mov_b32 s94, 0
L_cl3_loop:
buffer_load_dword v22, v11, s[20:23], s96 offen sc1
s_add_u32 s94, s94, 1
s_waitcnt vmcnt(0)
v_cmp_ne_u32 vcc, s39, v22
s_and_b32 vcc_lo, vcc_lo, s56
s_mov_b32 vcc_hi, 0
s_cbranch_vccz L_cl3_ret
s_cmp_gt_u32 s94, 20000
s_cbranch_scc0 L_cl3_loop
s_branch L_cl3_ret
L_code_end:
s_endpgm
.section .rodata,"a"
.p2align 6
.amdhsa_kernel parallel_sum__linear_attn_block__dense_activation_silu__prompt_kernel
  .amdhsa_next_free_vgpr 512
  .amdhsa_next_free_sgpr 102
  .amdhsa_accum_offset 256
  .amdhsa_group_segment_fixed_size 0
  .amdhsa_kernarg_size 72
  .amdhsa_user_sgpr_count 2
  .amdhsa_user_sgpr_kernarg_segment_ptr 1
  .amdhsa_system_sgpr_workgroup_id_x 1
.end_amdhsa_kernel
```
